```python
import torch

def _softmax(x, axis=-1):
    return torch.softmax(x, dim=axis)
def _gelu(x):
    return torch.nn.functional.gelu(x, approximate="tanh")
def _silu(x):
    return torch.nn.functional.silu(x)
def _sigmoid(x):
    return torch.sigmoid(x)
def _layernorm(x, axis=-1, eps=1e-5):
    m = x.mean(dim=axis, keepdim=True)
    v = x.var(dim=axis, keepdim=True, unbiased=False)
    return (x - m) / torch.sqrt(v + eps)
def _scatter_add(tgt, idx, src, axis=0):
    return tgt.clone().index_add_(axis, idx, src)
def _segment_sum(src, seg, n):
    out = torch.zeros((n,) + src.shape[1:], dtype=src.dtype)
    return out.index_add_(0, seg, src)
def _pad(x, pw):
    flat = tuple(v for pair in reversed(pw) for v in pair)
    return torch.nn.functional.pad(x, flat)

kernel_name = 'standalone__mha_block_cached__near_ridge'

def setup_inputs():

    _w = (lambda a: (lambda t: t.to(torch.bfloat16) if t.is_floating_point() else t)(torch.as_tensor(a)))
    B, Sq, D = 8, 192, 512
    H, Sk, Dh = 32, 512, 128
    return {
        "x": _w((lambda *s: torch.randn(*s, dtype=torch.bfloat16) * 0.8)(B, Sq, D)),
        "k_cache": _w((lambda *s: torch.randn(*s, dtype=torch.bfloat16) * 0.8)(B, H, Sk, Dh)),
        "v_cache": _w((lambda *s: torch.randn(*s, dtype=torch.bfloat16) * 0.05)(B, H, Sk, Dh)),
        "wq": _w((lambda *s: torch.randn(*s, dtype=torch.bfloat16) * 0.8)(D, H * Dh) * (D ** -0.5)),
        "wo": _w((lambda *s: torch.randn(*s, dtype=torch.bfloat16) * 0.05)(H * Dh, D) * ((H * Dh) ** -0.5)),
    }

def reference(x, k_cache, v_cache, wq, wo):
    B, Sq, D = x.shape
    H, Dh = 32, 128
    q = (lambda x, *d: x.permute(*d))((x @ wq).reshape(B, Sq, H, Dh), 0, 2, 1, 3)
    scores = torch.einsum("bhqd,bhkd->bhqk", q, k_cache) * (Dh ** -0.5)
    p = _softmax(scores, axis=-1)
    o = torch.einsum("bhqk,bhkd->bhqd", p, v_cache)
    return (lambda x, *d: x.permute(*d))(o, 0, 2, 1, 3).reshape(B, Sq, H * Dh) @ wo
```

```asm
; @launch grid=(256,1,1) block=(256,1,1) lds=163840
.amdgcn_target "amdgcn-amd-amdhsa--gfx950"
.text
.globl standalone__mha_block_cached__near_ridge_kernel
.p2align 8
.type standalone__mha_block_cached__near_ridge_kernel,@function
standalone__mha_block_cached__near_ridge_kernel:
  s_cmp_ge_u32 s2, 256
  s_cbranch_scc1 L_k1_end
  s_load_dwordx8 s[64:71], s[0:1], 0
  s_load_dwordx8 s[72:79], s[0:1], 32
  s_getpc_b64 s[28:29]
  L_pc:
  s_mov_b32 s30, L_codeend - L_pc
  s_mov_b32 s31, 0x20000
  s_bfe_u32 s7, s2, 0x30003
  s_mul_i32 s7, s7, 6144
  v_lshrrev_b32 v249, 6, v0
  v_and_b32 v248, 63, v0
  v_mad_u32_u24 v249, v249, 12, v248
  v_add_u32 v248, 52, v248
  v_lshrrev_b32 v248, 6, v248
  v_lshl_add_u32 v249, v248, 13, v249
  v_lshlrev_b32 v248, 7, v249
  buffer_load_dword v161, v248, s[28:31], s7 offen
  v_lshrrev_b32 v244, 6, v0
  v_and_b32 v245, 63, v0
  v_readfirstlane_b32 s3, v244
  v_lshrrev_b32 v246, 4, v245
  v_and_b32 v247, 15, v0
  v_lshlrev_b32 v1, 4, v245
  s_and_b32 s7, s2, 7
  s_lshl_b32 s5, s7, 2
  s_bfe_u32 s58, s2, 0x20003
  s_add_u32 s5, s5, s58
  s_lshr_b32 s4, s2, 5
  s_lshl_b32 s58, s58, 1
  s_add_u32 s6, s58, s4
  s_and_b32 s6, s2, 7
  s_add_u32 s40, s6, 0
  s_and_b32 s40, s40, 7
  s_lshl_b32 s48, s40, 19
  s_lshl_b32 s40, s40, 7
  s_add_u32 s41, s6, 1
  s_and_b32 s41, s41, 7
  s_lshl_b32 s49, s41, 19
  s_lshl_b32 s41, s41, 7
  s_add_u32 s42, s6, 2
  s_and_b32 s42, s42, 7
  s_lshl_b32 s50, s42, 19
  s_lshl_b32 s42, s42, 7
  s_add_u32 s43, s6, 3
  s_and_b32 s43, s43, 7
  s_lshl_b32 s51, s43, 19
  s_lshl_b32 s43, s43, 7
  s_add_u32 s44, s6, 4
  s_and_b32 s44, s44, 7
  s_lshl_b32 s52, s44, 19
  s_lshl_b32 s44, s44, 7
  s_add_u32 s45, s6, 5
  s_and_b32 s45, s45, 7
  s_lshl_b32 s53, s45, 19
  s_lshl_b32 s45, s45, 7
  s_add_u32 s46, s6, 6
  s_and_b32 s46, s46, 7
  s_lshl_b32 s54, s46, 19
  s_lshl_b32 s46, s46, 7
  s_add_u32 s47, s6, 7
  s_and_b32 s47, s47, 7
  s_lshl_b32 s55, s47, 19
  s_lshl_b32 s47, s47, 7
  s_lshl_b32 s36, s3, 11
  s_lshl_b32 s37, s3, 12
  s_mul_i32 s61, s3, 12288
  s_lshl_b32 s7, s3, 17
  v_lshlrev_b32 v248, 2, v246
  v_xor_b32 v248, v248, v247
  v_lshlrev_b32 v248, 4, v248
  v_lshl_add_u32 v248, v246, 13, v248
  v_add_u32 v216, s7, v248
  v_add_u32 v217, 31744, v216
  v_add_u32 v218, 65536, v216
  v_add_u32 v219, 97280, v216
  s_mul_i32 s58, s3, 49152
  v_and_b32 v249, 7, v0
  v_xor_b32 v249, v249, v246
  v_lshlrev_b32 v249, 4, v249
  v_bfe_u32 v250, v0, 3, 3
  v_lshl_add_u32 v249, v250, 10, v249
  v_add_u32 v212, s58, v249
  v_xor_b32 v213, 64, v212
  v_add_u32 v213, 7168, v213
  s_waitcnt lgkmcnt(0)
  s_lshl_b32 s7, s5, 8
  s_add_u32 s12, s70, s7
  s_addc_u32 s13, s71, 0
  s_sub_u32 s14, 0x400000, s7
  s_mov_b32 s15, 0x20000
  s_mul_i32 s7, s4, 196608
  s_add_u32 s8, s64, s7
  s_addc_u32 s9, s65, 0
  s_mov_b32 s10, 196608
  s_mov_b32 s11, 0x20000
  s_add_u32 m0, s36, 49152
  s_nop 0
  buffer_load_dwordx4 v216, s[12:15], s48 offen offset:0 lds
  buffer_load_dwordx4 v217, s[12:15], s48 offen offset:1024 lds
  s_add_u32 m0, s36, 73736
  s_nop 0
  buffer_load_dwordx4 v218, s[12:15], s48 offen offset:0 lds
  buffer_load_dwordx4 v219, s[12:15], s48 offen offset:1024 lds
  s_add_u32 m0, s61, 0
  s_add_u32 s62, s40, 0
  buffer_load_dwordx4 v212, s[8:11], s62 offen offset:0 lds
  buffer_load_dwordx4 v213, s[8:11], s62 offen offset:1024 lds
  s_add_u32 m0, s61, 2048
  s_add_u32 s62, s40, 16384
  buffer_load_dwordx4 v212, s[8:11], s62 offen offset:0 lds
  buffer_load_dwordx4 v213, s[8:11], s62 offen offset:1024 lds
  s_add_u32 m0, s61, 4096
  s_add_u32 s62, s40, 32768
  buffer_load_dwordx4 v212, s[8:11], s62 offen offset:0 lds
  buffer_load_dwordx4 v213, s[8:11], s62 offen offset:1024 lds
  s_lshl_b32 s7, s4, 5
  s_add_u32 s7, s7, s5
  s_lshl_b32 s7, s7, 17
  s_lshl_b32 s6, s2, 11
  s_add_u32 s16, s66, s7
  s_addc_u32 s17, s67, 0
  s_mov_b32 s18, 131072
  s_mov_b32 s19, 0x20000
  s_add_u32 s20, s68, s7
  s_addc_u32 s21, s69, 0
  s_mov_b32 s22, 131072
  s_mov_b32 s23, 0x20000
  s_lshl_b32 s58, s3, 2
  v_add_u32 v248, s58, v246
  v_xor_b32 v248, v248, v247
  v_lshlrev_b32 v249, 8, v246
  v_add_u32 v249, s37, v249
  v_lshl_add_u32 v2, v248, 4, v249
  s_and_b32 s58, s3, 1
  s_lshl_b32 s58, s58, 2
  v_add_u32 v248, s58, v246
  v_lshlrev_b32 v248, 1, v248
  v_xor_b32 v248, v248, v247
  v_lshl_add_u32 v3, v248, 4, v249
  v_bfe_u32 v250, v0, 2, 2
  v_and_b32 v251, 3, v0
  v_and_b32 v252, 1, v246
  v_lshrrev_b32 v248, 1, v247
  v_xor_b32 v248, v248, v246
  v_lshlrev_b32 v248, 4, v248
  v_lshl_add_u32 v248, v247, 7, v248
  v_add_u32 v214, s61, v248
  v_xor_b32 v215, 64, v214
  v_lshrrev_b32 v248, 1, v246
  v_lshlrev_b32 v248, 11, v248
  v_mul_u32_u24 v249, 24584, v252
  v_add_u32 v248, v248, v249
  v_add_u32 v248, 49152, v248
  v_lshl_add_u32 v248, v250, 8, v248
  v_lshl_add_u32 v248, v251, 4, v248
  v_xor_b32 v249, 0, v250
  v_lshl_add_u32 v208, v249, 6, v248
  v_xor_b32 v249, 1, v250
  v_lshl_add_u32 v209, v249, 6, v248
  v_xor_b32 v249, 2, v250
  v_lshl_add_u32 v210, v249, 6, v248
  v_xor_b32 v249, 3, v250
  v_lshl_add_u32 v211, v249, 6, v248
  s_add_u32 m0, s36, 57344
  s_nop 0
  buffer_load_dwordx4 v216, s[12:15], s49 offen offset:0 lds
  buffer_load_dwordx4 v217, s[12:15], s49 offen offset:1024 lds
  s_add_u32 m0, s36, 81928
  s_nop 0
  buffer_load_dwordx4 v218, s[12:15], s49 offen offset:0 lds
  buffer_load_dwordx4 v219, s[12:15], s49 offen offset:1024 lds
  s_add_u32 m0, s61, 6144
  s_add_u32 s62, s41, 0
  buffer_load_dwordx4 v212, s[8:11], s62 offen offset:0 lds
  buffer_load_dwordx4 v213, s[8:11], s62 offen offset:1024 lds
  v_lshlrev_b32 v248, 8, v251
  v_lshl_add_u32 v248, v250, 12, v248
  v_add_u32 v248, 114688, v248
  v_add_u32 v249, 0, v246
  v_xor_b32 v249, v249, v247
  v_lshl_add_u32 v4, v249, 4, v248
  v_add_u32 v249, 4, v246
  v_xor_b32 v249, v249, v247
  v_lshl_add_u32 v5, v249, 4, v248
  v_add_u32 v249, 8, v246
  v_xor_b32 v249, v249, v247
  v_lshl_add_u32 v6, v249, 4, v248
  v_add_u32 v249, 12, v246
  v_xor_b32 v249, v249, v247
  v_lshl_add_u32 v7, v249, 4, v248
  v_lshlrev_b32 v248, 12, v246
  v_lshl_add_u32 v248, v250, 8, v248
  v_and_b32 v249, 1, v0
  v_lshl_add_u32 v248, v249, 3, v248
  v_add_u32 v248, 98304, v248
  v_lshl_add_u32 v253, v252, 2, v250
  v_lshlrev_b32 v253, 1, v253
  v_bfe_u32 v254, v0, 1, 1
  v_or_b32 v253, v253, v254
  v_xor_b32 v249, 0, v253
  v_lshl_add_u32 v8, v249, 4, v248
  v_xor_b32 v249, 2, v253
  v_lshl_add_u32 v9, v249, 4, v248
  v_xor_b32 v249, 4, v253
  v_lshl_add_u32 v10, v249, 4, v248
  v_xor_b32 v249, 6, v253
  v_lshl_add_u32 v11, v249, 4, v248
  v_xor_b32 v249, 8, v253
  v_lshl_add_u32 v12, v249, 4, v248
  v_xor_b32 v249, 10, v253
  v_lshl_add_u32 v13, v249, 4, v248
  v_xor_b32 v249, 12, v253
  v_lshl_add_u32 v14, v249, 4, v248
  v_xor_b32 v249, 14, v253
  v_lshl_add_u32 v15, v249, 4, v248
  s_lshl_b32 s7, s3, 14
  v_lshlrev_b32 v248, 1, v246
  v_xor_b32 v248, v248, v247
  v_lshlrev_b32 v248, 4, v248
  v_lshl_add_u32 v248, v246, 10, v248
  v_add_u32 v250, s7, v248
  v_xor_b32 v251, 128, v250
  v_add_u32 v251, 3072, v251
  v_add_u32 v252, 6144, v250
  v_add_u32 v253, 6144, v251
  s_and_b32 s58, s2, 7
  s_lshl_b32 s7, s58, 19
  s_bfe_u32 s59, s2, 0x20003
  s_lshl_b32 s60, s59, 8
  s_add_u32 s7, s7, s60
  s_add_u32 s24, s72, s7
  s_addc_u32 s25, s73, 0
  s_sub_u32 s26, 0x400000, s7
  s_mov_b32 s27, 0x20000
  s_mul_i32 s63, s4, 196608
  s_add_u32 s63, s63, s60
  s_lshl_b32 s7, s58, 5
  s_add_u32 s63, s63, s7
  s_mul_i32 s7, s3, 49152
  s_add_u32 s63, s63, s7
  s_lshl_b32 s7, s4, 2
  s_add_u32 s59, s59, s7
  s_lshl_b32 s7, s59, 5
  s_add_u32 s7, s7, s3
  s_lshl_b32 s7, s7, 3
  s_add_u32 s7, s7, s58
  s_mul_i32 s7, s7, 1536
  s_add_u32 s7, s7, 14680064
  s_add_u32 s32, s78, s7
  s_addc_u32 s33, s79, 0
  s_mov_b32 s34, 345600
  s_mov_b32 s35, 0x20000
  s_lshl_b32 s7, s59, 3
  s_add_u32 s7, s7, s58
  s_lshl_b32 s7, s7, 2
  s_add_u32 s7, s7, s3
  s_mul_i32 s60, s7, 12288
  s_add_u32 s60, s60, 14680064
  s_mov_b32 s7, 524288
  s_add_u32 s64, s78, s7
  s_addc_u32 s65, s79, 0
  s_mov_b32 s66, 393216
  s_mov_b32 s67, 0x20000
  s_mov_b32 s101, 262144
  s_mov_b32 s68, s76
  s_mov_b32 s69, s77
  s_mov_b32 s70, 256
  s_mov_b32 s71, 0x20000
  s_bfe_u32 s7, s2, 0x50003
  s_lshl_b32 s7, s7, 2
  s_add_u32 s7, s7, s3
  s_lshl_b32 s7, s7, 3
  s_add_u32 s7, s7, s58
  s_add_u32 s7, s7, 1024
  s_lshl_b32 s7, s7, 7
  v_lshrrev_b32 v232, 7, v1
  v_lshl_add_u32 v232, v232, 20, s7
  v_add_u32 v232, v232, v1
  s_lshl_b32 s7, s4, 5
  s_add_u32 s7, s7, s5
  s_lshl_b32 s7, s7, 2
  s_add_u32 s59, s7, s3
  s_lshl_b32 s7, s59, 7
  v_lshrrev_b32 v254, 3, v245
  v_lshl_add_u32 v254, v254, 20, s7
  v_add_u32 v254, v254, v1
  s_and_b32 s7, s7, 0xfffff9ff
  v_lshrrev_b32 v249, 2, v245
  v_lshl_add_u32 v249, v249, 20, s7
  v_lshl_add_u32 v255, v245, 9, v249
  s_mul_i32 s7, s59, 12288
  s_add_u32 s7, s7, 1048576
  s_add_u32 s28, s78, s7
  s_addc_u32 s29, s79, 0
  s_mov_b32 s30, 12288
  s_mov_b32 s31, 0x20000
  s_and_b32 s59, s59, 0xfffffff3
  s_mul_i32 s59, s59, 12288
  s_add_u32 s59, s59, 1048576
  s_mov_b32 s39, 0x3e0293ee
  s_mov_b32 s56, 4096
  s_mov_b32 s57, 8192
  v_bfe_u32 v248, v0, 1, 4
  v_and_b32 v249, 1, v0
  v_lshlrev_b32 v249, 7, v249
  v_lshl_add_u32 v248, v248, 13, v249
  s_lshl_b32 s7, s4, 2
  s_add_u32 s7, s7, s3
  s_lshl_b32 s7, s7, 17
  buffer_load_dword v160, v248, s[12:15], s7 offen
  s_waitcnt vmcnt(13)
  s_barrier
  s_waitcnt vmcnt(11)
  ds_read_b128 a[0:3], v214 offset:0
  ds_read_b64_tr_b16 a[192:193], v208 offset:0
  ds_read_b64_tr_b16 a[194:195], v208 offset:1024
  ds_read_b128 a[12:15], v215 offset:0
  s_waitcnt vmcnt(9)
  ds_read_b128 a[4:7], v214 offset:2048
  ds_read_b128 a[16:19], v215 offset:2048
  s_waitcnt vmcnt(7)
  ds_read_b128 a[8:11], v214 offset:4096
  ds_read_b64_tr_b16 a[196:197], v208 offset:8
  ds_read_b64_tr_b16 a[198:199], v208 offset:1032
  ds_read_b64_tr_b16 a[200:201], v209 offset:0
  ds_read_b64_tr_b16 a[202:203], v209 offset:1024
  ds_read_b64_tr_b16 a[204:205], v209 offset:8
  ds_read_b64_tr_b16 a[206:207], v209 offset:1032
  s_waitcnt lgkmcnt(10)
  v_mfma_f32_16x16x32_bf16 v[16:19], a[192:195], a[0:3], 0
  s_add_u32 m0, s61, 8192
  ds_read_b128 a[20:23], v215 offset:4096
  ds_read_b64_tr_b16 a[208:209], v210 offset:0
  ds_read_b64_tr_b16 a[210:211], v210 offset:1024
  v_mov_b32 v246, 0
  s_waitcnt lgkmcnt(8)
  v_mfma_f32_16x16x32_bf16 v[20:23], a[192:195], a[4:7], 0
  s_add_u32 s62, s41, 16384
  v_mov_b32 v247, 0
  v_mov_b32 v248, 0
  v_mfma_f32_16x16x32_bf16 v[24:27], a[192:195], a[8:11], 0
  s_waitcnt lgkmcnt(3)
  buffer_load_dwordx4 v212, s[8:11], s62 offen offset:0 lds
  v_mfma_f32_16x16x32_bf16 v[28:31], a[196:199], a[0:3], 0
  buffer_load_dwordx4 v213, s[8:11], s62 offen offset:1024 lds
  ds_read_b64_tr_b16 a[212:213], v210 offset:8
  ds_read_b64_tr_b16 a[214:215], v210 offset:1032
  v_mfma_f32_16x16x32_bf16 v[32:35], a[196:199], a[4:7], 0
  s_add_u32 m0, s36, 65536
  v_mov_b32 v249, 0
  v_mov_b32 v245, 1
  v_mfma_f32_16x16x32_bf16 v[36:39], a[196:199], a[8:11], 0
  buffer_load_dwordx4 v216, s[12:15], s50 offen offset:0 lds
  v_mfma_f32_16x16x32_bf16 v[40:43], a[200:203], a[0:3], 0
  buffer_load_dwordx4 v217, s[12:15], s50 offen offset:1024 lds
  ds_read_b64_tr_b16 a[216:217], v211 offset:0
  ds_read_b64_tr_b16 a[218:219], v211 offset:1024
  v_mfma_f32_16x16x32_bf16 v[44:47], a[200:203], a[4:7], 0
  s_add_u32 m0, s61, 10240
  ds_read_b64_tr_b16 a[220:221], v211 offset:8
  ds_read_b64_tr_b16 a[222:223], v211 offset:1032
  v_mfma_f32_16x16x32_bf16 v[48:51], a[200:203], a[8:11], 0
  s_add_u32 s62, s41, 32768
  ds_read_b64_tr_b16 a[224:225], v208 offset:4096
  v_mfma_f32_16x16x32_bf16 v[52:55], a[204:207], a[0:3], 0
  buffer_load_dwordx4 v212, s[8:11], s62 offen offset:0 lds
  v_mfma_f32_16x16x32_bf16 v[56:59], a[204:207], a[4:7], 0
  buffer_load_dwordx4 v213, s[8:11], s62 offen offset:1024 lds
  v_mfma_f32_16x16x32_bf16 v[60:63], a[204:207], a[8:11], 0
  s_waitcnt lgkmcnt(3)
  s_add_u32 m0, s36, 90120
  ds_read_b64_tr_b16 a[226:227], v208 offset:5120
  v_mfma_f32_16x16x32_bf16 v[64:67], a[208:211], a[0:3], 0
  buffer_load_dwordx4 v218, s[12:15], s50 offen offset:0 lds
  v_mfma_f32_16x16x32_bf16 v[68:71], a[208:211], a[4:7], 0
  buffer_load_dwordx4 v219, s[12:15], s50 offen offset:1024 lds
  v_mfma_f32_16x16x32_bf16 v[72:75], a[208:211], a[8:11], 0
  s_add_u32 m0, s61, 0
  ds_read_b64_tr_b16 a[228:229], v208 offset:4104
  ds_read_b64_tr_b16 a[230:231], v208 offset:5128
  v_mfma_f32_16x16x32_bf16 v[76:79], a[212:215], a[0:3], 0
  s_add_u32 s62, s42, 0
  ds_read_b64_tr_b16 a[232:233], v209 offset:4096
  ds_read_b64_tr_b16 a[234:235], v209 offset:5120
  v_mfma_f32_16x16x32_bf16 v[80:83], a[212:215], a[4:7], 0
  buffer_load_dwordx4 v212, s[8:11], s62 offen offset:0 lds
  v_mfma_f32_16x16x32_bf16 v[84:87], a[212:215], a[8:11], 0
  buffer_load_dwordx4 v213, s[8:11], s62 offen offset:1024 lds
  v_mfma_f32_16x16x32_bf16 v[88:91], a[216:219], a[0:3], 0
  s_add_u32 m0, s61, 2048
  ds_read_b64_tr_b16 a[236:237], v209 offset:4104
  ds_read_b64_tr_b16 a[238:239], v209 offset:5128
  v_mfma_f32_16x16x32_bf16 v[92:95], a[216:219], a[4:7], 0
  s_add_u32 s62, s42, 16384
  ds_read_b64_tr_b16 a[192:193], v210 offset:4096
  v_mfma_f32_16x16x32_bf16 v[96:99], a[216:219], a[8:11], 0
  s_waitcnt lgkmcnt(3)
  buffer_load_dwordx4 v212, s[8:11], s62 offen offset:0 lds
  v_mfma_f32_16x16x32_bf16 v[100:103], a[220:223], a[0:3], 0
  buffer_load_dwordx4 v213, s[8:11], s62 offen offset:1024 lds
  v_mfma_f32_16x16x32_bf16 v[104:107], a[220:223], a[4:7], 0
  s_add_u32 m0, s61, 4096
  ds_read_b64_tr_b16 a[194:195], v210 offset:5120
  v_mfma_f32_16x16x32_bf16 v[108:111], a[220:223], a[8:11], 0
  s_add_u32 s62, s42, 32768
  ds_read_b64_tr_b16 a[196:197], v210 offset:4104
  v_mfma_f32_16x16x32_bf16 v[16:19], a[224:227], a[12:15], v[16:19]
  buffer_load_dwordx4 v212, s[8:11], s62 offen offset:0 lds
  v_mfma_f32_16x16x32_bf16 v[20:23], a[224:227], a[16:19], v[20:23]
  buffer_load_dwordx4 v213, s[8:11], s62 offen offset:1024 lds
  v_mfma_f32_16x16x32_bf16 v[24:27], a[224:227], a[20:23], v[24:27]
  ds_read_b64_tr_b16 a[198:199], v210 offset:5128
  v_mfma_f32_16x16x32_bf16 v[28:31], a[228:231], a[12:15], v[28:31]
  ds_read_b64_tr_b16 a[200:201], v211 offset:4096
  ds_read_b64_tr_b16 a[202:203], v211 offset:5120
  v_mfma_f32_16x16x32_bf16 v[32:35], a[228:231], a[16:19], v[32:35]
  s_waitcnt vmcnt(15)
  ds_read_b128 a[24:27], v214 offset:6144
  ds_read_b128 a[36:39], v215 offset:6144
  v_mfma_f32_16x16x32_bf16 v[36:39], a[228:231], a[20:23], v[36:39]
  ds_read_b64_tr_b16 a[204:205], v211 offset:4104
  ds_read_b64_tr_b16 a[206:207], v211 offset:5128
  v_mfma_f32_16x16x32_bf16 v[40:43], a[232:235], a[12:15], v[40:43]
  v_mfma_f32_16x16x32_bf16 v[44:47], a[232:235], a[16:19], v[44:47]
  v_mfma_f32_16x16x32_bf16 v[48:51], a[232:235], a[20:23], v[48:51]
  s_waitcnt lgkmcnt(6)
  v_mfma_f32_16x16x32_bf16 v[52:55], a[236:239], a[12:15], v[52:55]
  s_waitcnt vmcnt(12)
  ds_read_b128 a[28:31], v214 offset:8192
  ds_read_b128 a[40:43], v215 offset:8192
  v_mfma_f32_16x16x32_bf16 v[56:59], a[236:239], a[16:19], v[56:59]
  s_waitcnt lgkmcnt(2)
  s_barrier
  s_add_u32 m0, s36, 49152
  ds_read_b64_tr_b16 a[208:209], v208 offset:8192
  v_mfma_f32_16x16x32_bf16 v[60:63], a[236:239], a[20:23], v[60:63]
  buffer_load_dwordx4 v216, s[12:15], s51 offen offset:0 lds
  v_mfma_f32_16x16x32_bf16 v[64:67], a[192:195], a[12:15], v[64:67]
  buffer_load_dwordx4 v217, s[12:15], s51 offen offset:1024 lds
  ds_read_b64_tr_b16 a[210:211], v208 offset:9216
  v_mfma_f32_16x16x32_bf16 v[68:71], a[192:195], a[16:19], v[68:71]
  s_add_u32 m0, s61, 6144
  ds_read_b64_tr_b16 a[212:213], v208 offset:12288
  ds_read_b64_tr_b16 a[214:215], v208 offset:13312
  v_mfma_f32_16x16x32_bf16 v[72:75], a[192:195], a[20:23], v[72:75]
  s_add_u32 s62, s43, 0
  ds_read_b64_tr_b16 a[216:217], v208 offset:8200
  v_mfma_f32_16x16x32_bf16 v[76:79], a[196:199], a[12:15], v[76:79]
  ds_read_b64_tr_b16 a[218:219], v208 offset:9224
  v_mfma_f32_16x16x32_bf16 v[80:83], a[196:199], a[16:19], v[80:83]
  s_waitcnt vmcnt(10)
  ds_read_b128 a[32:35], v214 offset:10240
  ds_read_b128 a[44:47], v215 offset:10240
  v_mfma_f32_16x16x32_bf16 v[84:87], a[196:199], a[20:23], v[84:87]
  buffer_load_dwordx4 v212, s[8:11], s62 offen offset:0 lds
  v_mfma_f32_16x16x32_bf16 v[88:91], a[200:203], a[12:15], v[88:91]
  buffer_load_dwordx4 v213, s[8:11], s62 offen offset:1024 lds
  v_mfma_f32_16x16x32_bf16 v[92:95], a[200:203], a[16:19], v[92:95]
  s_add_u32 m0, s61, 8192
  ds_read_b64_tr_b16 a[220:221], v208 offset:12296
  ds_read_b64_tr_b16 a[222:223], v208 offset:13320
  v_mfma_f32_16x16x32_bf16 v[96:99], a[200:203], a[20:23], v[96:99]
  s_add_u32 s62, s43, 16384
  ds_read_b64_tr_b16 a[224:225], v209 offset:8192
  v_mfma_f32_16x16x32_bf16 v[100:103], a[204:207], a[12:15], v[100:103]
  s_waitcnt lgkmcnt(3)
  buffer_load_dwordx4 v212, s[8:11], s62 offen offset:0 lds
  v_mfma_f32_16x16x32_bf16 v[104:107], a[204:207], a[16:19], v[104:107]
  buffer_load_dwordx4 v213, s[8:11], s62 offen offset:1024 lds
  v_mfma_f32_16x16x32_bf16 v[108:111], a[204:207], a[20:23], v[108:111]
  s_add_u32 m0, s36, 73736
  ds_read_b64_tr_b16 a[226:227], v209 offset:9216
  ds_read_b64_tr_b16 a[228:229], v209 offset:12288
  v_mfma_f32_16x16x32_bf16 v[16:19], a[208:211], a[24:27], v[16:19]
  buffer_load_dwordx4 v218, s[12:15], s51 offen offset:0 lds
  v_mfma_f32_16x16x32_bf16 v[16:19], a[212:215], a[36:39], v[16:19]
  buffer_load_dwordx4 v219, s[12:15], s51 offen offset:1024 lds
  ds_read_b64_tr_b16 a[230:231], v209 offset:13312
  v_mfma_f32_16x16x32_bf16 v[20:23], a[208:211], a[28:31], v[20:23]
  s_add_u32 m0, s61, 10240
  ds_read_b64_tr_b16 a[232:233], v209 offset:8200
  v_mfma_f32_16x16x32_bf16 v[20:23], a[212:215], a[40:43], v[20:23]
  s_add_u32 s62, s43, 32768
  ds_read_b64_tr_b16 a[234:235], v209 offset:9224
  v_mfma_f32_16x16x32_bf16 v[24:27], a[208:211], a[32:35], v[24:27]
  buffer_load_dwordx4 v212, s[8:11], s62 offen offset:0 lds
  v_mfma_f32_16x16x32_bf16 v[24:27], a[212:215], a[44:47], v[24:27]
  buffer_load_dwordx4 v213, s[8:11], s62 offen offset:1024 lds
  v_mfma_f32_16x16x32_bf16 v[28:31], a[216:219], a[24:27], v[28:31]
  s_waitcnt lgkmcnt(3)
  ds_read_b64_tr_b16 a[236:237], v209 offset:12296
  ds_read_b64_tr_b16 a[238:239], v209 offset:13320
  v_mfma_f32_16x16x32_bf16 v[28:31], a[220:223], a[36:39], v[28:31]
  ds_read_b64_tr_b16 a[192:193], v210 offset:8192
  v_mfma_f32_16x16x32_bf16 v[32:35], a[216:219], a[28:31], v[32:35]
  s_waitcnt vmcnt(14)
  ds_read_b128 a[48:51], v214 offset:0
  ds_read_b128 a[60:63], v215 offset:0
  v_mfma_f32_16x16x32_bf16 v[32:35], a[220:223], a[40:43], v[32:35]
  ds_read_b64_tr_b16 a[194:195], v210 offset:9216
  v_mfma_f32_16x16x32_bf16 v[36:39], a[216:219], a[32:35], v[36:39]
  ds_read_b64_tr_b16 a[196:197], v210 offset:12288
  ds_read_b64_tr_b16 a[198:199], v210 offset:13312
  v_mfma_f32_16x16x32_bf16 v[36:39], a[220:223], a[44:47], v[36:39]
  ds_read_b64_tr_b16 a[200:201], v210 offset:8200
  v_mfma_f32_16x16x32_bf16 v[40:43], a[224:227], a[24:27], v[40:43]
  s_waitcnt lgkmcnt(6)
  buffer_store_dwordx4 v[246:249], v232, s[64:67], 0 offen sc1
  v_mfma_f32_16x16x32_bf16 v[40:43], a[228:231], a[36:39], v[40:43]
  ds_read_b64_tr_b16 a[202:203], v210 offset:9224
  v_mfma_f32_16x16x32_bf16 v[44:47], a[224:227], a[28:31], v[44:47]
  buffer_store_dwordx4 v[246:249], v254, s[64:67], s101 offen sc1
  v_mfma_f32_16x16x32_bf16 v[44:47], a[228:231], a[40:43], v[44:47]
  s_add_u32 m0, s61, 0
  ds_read_b64_tr_b16 a[204:205], v210 offset:12296
  v_mfma_f32_16x16x32_bf16 v[48:51], a[224:227], a[32:35], v[48:51]
  s_add_u32 s62, s44, 0
  ds_read_b64_tr_b16 a[206:207], v210 offset:13320
  v_mfma_f32_16x16x32_bf16 v[48:51], a[228:231], a[44:47], v[48:51]
  buffer_store_dwordx4 v[246:249], v254, s[64:67], 0 offen sc1
  v_mfma_f32_16x16x32_bf16 v[52:55], a[232:235], a[24:27], v[52:55]
  ds_read_b64_tr_b16 a[208:209], v211 offset:8192
  v_mov_b32 v248, 0x3f803f80
  v_mfma_f32_16x16x32_bf16 v[52:55], a[236:239], a[36:39], v[52:55]
  ds_read_b64_tr_b16 a[210:211], v211 offset:9216
  v_mfma_f32_16x16x32_bf16 v[56:59], a[232:235], a[28:31], v[56:59]
  s_waitcnt lgkmcnt(4)
  buffer_load_dwordx4 v212, s[8:11], s62 offen offset:0 lds
  v_mfma_f32_16x16x32_bf16 v[56:59], a[236:239], a[40:43], v[56:59]
  buffer_load_dwordx4 v213, s[8:11], s62 offen offset:1024 lds
  v_mfma_f32_16x16x32_bf16 v[60:63], a[232:235], a[32:35], v[60:63]
  ds_read_b64_tr_b16 a[212:213], v211 offset:12288
  ds_read_b64_tr_b16 a[214:215], v211 offset:13312
  v_mfma_f32_16x16x32_bf16 v[60:63], a[236:239], a[44:47], v[60:63]
  ds_read_b64_tr_b16 a[216:217], v211 offset:8200
  v_mfma_f32_16x16x32_bf16 v[64:67], a[192:195], a[24:27], v[64:67]
  s_waitcnt vmcnt(17)
  ds_read_b128 a[52:55], v214 offset:2048
  ds_read_b128 a[64:67], v215 offset:2048
  v_mfma_f32_16x16x32_bf16 v[64:67], a[196:199], a[36:39], v[64:67]
  ds_read_b64_tr_b16 a[218:219], v211 offset:9224
  v_mfma_f32_16x16x32_bf16 v[68:71], a[192:195], a[28:31], v[68:71]
  ds_read_b64_tr_b16 a[220:221], v211 offset:12296
  v_mfma_f32_16x16x32_bf16 v[68:71], a[196:199], a[40:43], v[68:71]
  ds_read_b64_tr_b16 a[222:223], v211 offset:13320
  v_mfma_f32_16x16x32_bf16 v[72:75], a[192:195], a[32:35], v[72:75]
  v_mfma_f32_16x16x32_bf16 v[72:75], a[196:199], a[44:47], v[72:75]
  v_mfma_f32_16x16x32_bf16 v[76:79], a[200:203], a[24:27], v[76:79]
  s_waitcnt lgkmcnt(5)
  v_mfma_f32_16x16x32_bf16 v[76:79], a[204:207], a[36:39], v[76:79]
  s_waitcnt lgkmcnt(0)
  s_barrier
  s_add_u32 m0, s36, 57344
  ds_read_b64_tr_b16 a[224:225], v208 offset:16384
  v_mfma_f32_16x16x32_bf16 v[80:83], a[200:203], a[28:31], v[80:83]
  buffer_load_dwordx4 v216, s[12:15], s52 offen offset:0 lds
  v_mfma_f32_16x16x32_bf16 v[80:83], a[204:207], a[40:43], v[80:83]
  buffer_load_dwordx4 v217, s[12:15], s52 offen offset:1024 lds
  v_mfma_f32_16x16x32_bf16 v[84:87], a[200:203], a[32:35], v[84:87]
  s_add_u32 m0, s61, 2048
  ds_read_b64_tr_b16 a[226:227], v208 offset:17408
  ds_read_b64_tr_b16 a[228:229], v208 offset:20480
  v_mfma_f32_16x16x32_bf16 v[84:87], a[204:207], a[44:47], v[84:87]
  s_add_u32 s62, s44, 16384
  ds_read_b64_tr_b16 a[230:231], v208 offset:21504
  v_mfma_f32_16x16x32_bf16 v[88:91], a[208:211], a[24:27], v[88:91]
  buffer_load_dwordx4 v212, s[8:11], s62 offen offset:0 lds
  v_mfma_f32_16x16x32_bf16 v[88:91], a[212:215], a[36:39], v[88:91]
  buffer_load_dwordx4 v213, s[8:11], s62 offen offset:1024 lds
  v_mfma_f32_16x16x32_bf16 v[92:95], a[208:211], a[28:31], v[92:95]
  ds_read_b64_tr_b16 a[232:233], v208 offset:16392
  v_mfma_f32_16x16x32_bf16 v[92:95], a[212:215], a[40:43], v[92:95]
  ds_read_b64_tr_b16 a[234:235], v208 offset:17416
  v_mfma_f32_16x16x32_bf16 v[96:99], a[208:211], a[32:35], v[96:99]
  s_waitcnt vmcnt(19)
  ds_read_b128 a[56:59], v214 offset:4096
  ds_read_b128 a[68:71], v215 offset:4096
  v_mfma_f32_16x16x32_bf16 v[96:99], a[212:215], a[44:47], v[96:99]
  s_add_u32 m0, s36, 81928
  ds_read_b64_tr_b16 a[236:237], v208 offset:20488
  ds_read_b64_tr_b16 a[238:239], v208 offset:21512
  v_mfma_f32_16x16x32_bf16 v[100:103], a[216:219], a[24:27], v[100:103]
  buffer_load_dwordx4 v218, s[12:15], s52 offen offset:0 lds
  v_mfma_f32_16x16x32_bf16 v[100:103], a[220:223], a[36:39], v[100:103]
  buffer_load_dwordx4 v219, s[12:15], s52 offen offset:1024 lds
  v_mfma_f32_16x16x32_bf16 v[104:107], a[216:219], a[28:31], v[104:107]
  ds_read_b64_tr_b16 a[192:193], v209 offset:16384
  v_mfma_f32_16x16x32_bf16 v[104:107], a[220:223], a[40:43], v[104:107]
  ds_read_b64_tr_b16 a[194:195], v209 offset:17408
  v_mfma_f32_16x16x32_bf16 v[108:111], a[216:219], a[32:35], v[108:111]
  ds_read_b64_tr_b16 a[196:197], v209 offset:20480
  ds_read_b64_tr_b16 a[198:199], v209 offset:21504
  v_mfma_f32_16x16x32_bf16 v[108:111], a[220:223], a[44:47], v[108:111]
  s_waitcnt lgkmcnt(4)
  s_add_u32 m0, s61, 4096
  ds_read_b64_tr_b16 a[200:201], v209 offset:16392
  v_mfma_f32_16x16x32_bf16 v[16:19], a[224:227], a[48:51], v[16:19]
  s_add_u32 s62, s44, 32768
  ds_read_b64_tr_b16 a[202:203], v209 offset:17416
  v_mfma_f32_16x16x32_bf16 v[16:19], a[228:231], a[60:63], v[16:19]
  ds_read_b64_tr_b16 a[204:205], v209 offset:20488
  v_mfma_f32_16x16x32_bf16 v[20:23], a[224:227], a[52:55], v[20:23]
  ds_read_b64_tr_b16 a[206:207], v209 offset:21512
  v_mfma_f32_16x16x32_bf16 v[20:23], a[228:231], a[64:67], v[20:23]
  ds_read_b64_tr_b16 a[208:209], v210 offset:16384
  v_mfma_f32_16x16x32_bf16 v[24:27], a[224:227], a[56:59], v[24:27]
  buffer_load_dwordx4 v212, s[8:11], s62 offen offset:0 lds
  v_mfma_f32_16x16x32_bf16 v[24:27], a[228:231], a[68:71], v[24:27]
  buffer_load_dwordx4 v213, s[8:11], s62 offen offset:1024 lds
  v_mfma_f32_16x16x32_bf16 v[28:31], a[232:235], a[48:51], v[28:31]
  s_add_u32 m0, s37, 131072
  ds_read_b64_tr_b16 a[210:211], v210 offset:17408
  v_mfma_f32_16x16x32_bf16 v[28:31], a[236:239], a[60:63], v[28:31]
  s_add_u32 s38, s6, 0
  ds_read_b64_tr_b16 a[212:213], v210 offset:20480
  v_mfma_f32_16x16x32_bf16 v[32:35], a[232:235], a[52:55], v[32:35]
  s_and_b32 s38, s38, 0x1c000
  s_waitcnt vmcnt(19)
  ds_read_b128 a[72:75], v214 offset:6144
  ds_read_b128 a[84:87], v215 offset:6144
  v_mfma_f32_16x16x32_bf16 v[32:35], a[236:239], a[64:67], v[32:35]
  buffer_load_dwordx4 v2, s[16:19], s38 offen offset:0 nt lds
  v_mfma_f32_16x16x32_bf16 v[36:39], a[232:235], a[56:59], v[36:39]
  buffer_load_dwordx4 v2, s[16:19], s38 offen offset:1024 nt lds
  v_mfma_f32_16x16x32_bf16 v[36:39], a[236:239], a[68:71], v[36:39]
  s_waitcnt lgkmcnt(3)
  ds_read_b64_tr_b16 a[214:215], v210 offset:21504
  v_mfma_f32_16x16x32_bf16 v[40:43], a[192:195], a[48:51], v[40:43]
  ds_read_b64_tr_b16 a[216:217], v210 offset:16392
  v_mfma_f32_16x16x32_bf16 v[40:43], a[196:199], a[60:63], v[40:43]
  ds_read_b64_tr_b16 a[218:219], v210 offset:17416
  v_mfma_f32_16x16x32_bf16 v[44:47], a[192:195], a[52:55], v[44:47]
  s_add_u32 m0, s37, 131072
  ds_read_b64_tr_b16 a[220:221], v210 offset:20488
  v_mfma_f32_16x16x32_bf16 v[44:47], a[196:199], a[64:67], v[44:47]
  ds_read_b64_tr_b16 a[222:223], v210 offset:21512
  v_mfma_f32_16x16x32_bf16 v[48:51], a[192:195], a[56:59], v[48:51]
  buffer_load_dwordx4 v2, s[16:19], s38 offen offset:2048 nt lds
  v_mfma_f32_16x16x32_bf16 v[48:51], a[196:199], a[68:71], v[48:51]
  buffer_load_dwordx4 v2, s[16:19], s38 offen offset:3072 nt lds
  v_mfma_f32_16x16x32_bf16 v[52:55], a[200:203], a[48:51], v[52:55]
  s_add_u32 m0, s61, 6144
  ds_read_b64_tr_b16 a[224:225], v211 offset:16384
  v_mfma_f32_16x16x32_bf16 v[52:55], a[204:207], a[60:63], v[52:55]
  s_add_u32 s62, s45, 0
  ds_read_b64_tr_b16 a[226:227], v211 offset:17408
  v_mfma_f32_16x16x32_bf16 v[56:59], a[200:203], a[52:55], v[56:59]
  s_waitcnt lgkmcnt(3)
  buffer_load_dwordx4 v212, s[8:11], s62 offen offset:0 lds
  v_mfma_f32_16x16x32_bf16 v[56:59], a[204:207], a[64:67], v[56:59]
  buffer_load_dwordx4 v213, s[8:11], s62 offen offset:1024 lds
  v_mfma_f32_16x16x32_bf16 v[60:63], a[200:203], a[56:59], v[60:63]
  ds_read_b64_tr_b16 a[228:229], v211 offset:20480
  ds_read_b64_tr_b16 a[230:231], v211 offset:21504
  v_mfma_f32_16x16x32_bf16 v[60:63], a[204:207], a[68:71], v[60:63]
  ds_read_b64_tr_b16 a[232:233], v211 offset:16392
  v_mfma_f32_16x16x32_bf16 v[64:67], a[208:211], a[48:51], v[64:67]
  s_waitcnt vmcnt(23)
  ds_read_b128 a[76:79], v214 offset:8192
  ds_read_b128 a[88:91], v215 offset:8192
  v_mfma_f32_16x16x32_bf16 v[64:67], a[212:215], a[60:63], v[64:67]
  ds_read_b64_tr_b16 a[234:235], v211 offset:17416
  v_mfma_f32_16x16x32_bf16 v[68:71], a[208:211], a[52:55], v[68:71]
  ds_read_b64_tr_b16 a[236:237], v211 offset:20488
  v_mfma_f32_16x16x32_bf16 v[68:71], a[212:215], a[64:67], v[68:71]
  ds_read_b64_tr_b16 a[238:239], v211 offset:21512
  v_mfma_f32_16x16x32_bf16 v[72:75], a[208:211], a[56:59], v[72:75]
  v_mfma_f32_16x16x32_bf16 v[72:75], a[212:215], a[68:71], v[72:75]
  v_mfma_f32_16x16x32_bf16 v[76:79], a[216:219], a[48:51], v[76:79]
  s_waitcnt lgkmcnt(5)
  v_mfma_f32_16x16x32_bf16 v[76:79], a[220:223], a[60:63], v[76:79]
  s_waitcnt lgkmcnt(0)
  s_waitcnt vmcnt(21)
  s_barrier
  s_add_u32 m0, s36, 65536
  ds_read_b64_tr_b16 a[192:193], v208 offset:0
  v_mfma_f32_16x16x32_bf16 v[80:83], a[216:219], a[52:55], v[80:83]
  buffer_load_dwordx4 v216, s[12:15], s53 offen offset:0 lds
  v_mfma_f32_16x16x32_bf16 v[80:83], a[220:223], a[64:67], v[80:83]
  buffer_load_dwordx4 v217, s[12:15], s53 offen offset:1024 lds
  v_mfma_f32_16x16x32_bf16 v[84:87], a[216:219], a[56:59], v[84:87]
  s_add_u32 m0, s61, 8192
  ds_read_b64_tr_b16 a[194:195], v208 offset:1024
  ds_read_b64_tr_b16 a[196:197], v208 offset:4096
  v_mfma_f32_16x16x32_bf16 v[84:87], a[220:223], a[68:71], v[84:87]
  s_add_u32 s62, s45, 16384
  ds_read_b64_tr_b16 a[198:199], v208 offset:5120
  v_mfma_f32_16x16x32_bf16 v[88:91], a[224:227], a[48:51], v[88:91]
  s_waitcnt vmcnt(21)
  ds_read_b128 a[80:83], v214 offset:10240
  ds_read_b128 a[92:95], v215 offset:10240
  v_mfma_f32_16x16x32_bf16 v[88:91], a[228:231], a[60:63], v[88:91]
  buffer_load_dwordx4 v212, s[8:11], s62 offen offset:0 lds
  v_mfma_f32_16x16x32_bf16 v[92:95], a[224:227], a[52:55], v[92:95]
  buffer_load_dwordx4 v213, s[8:11], s62 offen offset:1024 lds
  v_mfma_f32_16x16x32_bf16 v[92:95], a[228:231], a[64:67], v[92:95]
  ds_read_b64_tr_b16 a[200:201], v208 offset:8
  ds_read_b64_tr_b16 a[202:203], v208 offset:1032
  v_mfma_f32_16x16x32_bf16 v[96:99], a[224:227], a[56:59], v[96:99]
  ds_read_b64_tr_b16 a[204:205], v208 offset:4104
  ds_read_b64_tr_b16 a[206:207], v208 offset:5128
  v_mfma_f32_16x16x32_bf16 v[96:99], a[228:231], a[68:71], v[96:99]
  s_add_u32 m0, s36, 90120
  ds_read_b64_tr_b16 a[208:209], v209 offset:0
  v_mfma_f32_16x16x32_bf16 v[100:103], a[232:235], a[48:51], v[100:103]
  buffer_load_dwordx4 v218, s[12:15], s53 offen offset:0 lds
  v_mfma_f32_16x16x32_bf16 v[100:103], a[236:239], a[60:63], v[100:103]
  buffer_load_dwordx4 v219, s[12:15], s53 offen offset:1024 lds
  v_mfma_f32_16x16x32_bf16 v[104:107], a[232:235], a[52:55], v[104:107]
  s_add_u32 m0, s61, 10240
  ds_read_b64_tr_b16 a[210:211], v209 offset:1024
  v_accvgpr_write_b32 a60, v248
  v_mfma_f32_16x16x32_bf16 v[104:107], a[236:239], a[64:67], v[104:107]
  s_add_u32 s62, s45, 32768
  ds_read_b64_tr_b16 a[212:213], v209 offset:4096
  v_accvgpr_write_b32 a61, v248
  v_mfma_f32_16x16x32_bf16 v[108:111], a[232:235], a[56:59], v[108:111]
  ds_read_b64_tr_b16 a[214:215], v209 offset:5120
  v_accvgpr_write_b32 a62, v248
  v_mfma_f32_16x16x32_bf16 v[108:111], a[236:239], a[68:71], v[108:111]
  s_waitcnt lgkmcnt(3)
  ds_read_b64_tr_b16 a[216:217], v209 offset:8
  v_accvgpr_write_b32 a63, v248
  v_mfma_f32_16x16x32_bf16 v[16:19], a[192:195], a[72:75], v[16:19]
  s_waitcnt vmcnt(20)
  ds_read_b128 a[96:99], v214 offset:0
  ds_read_b128 a[108:111], v215 offset:0
  v_mfma_f32_16x16x32_bf16 v[16:19], a[196:199], a[84:87], v[16:19]
  buffer_load_dwordx4 v212, s[8:11], s62 offen offset:0 lds
  v_mfma_f32_16x16x32_bf16 v[20:23], a[192:195], a[76:79], v[20:23]
  buffer_load_dwordx4 v213, s[8:11], s62 offen offset:1024 lds
  v_mfma_f32_16x16x32_bf16 v[20:23], a[196:199], a[88:91], v[20:23]
  ds_read_b64_tr_b16 a[218:219], v209 offset:1032
  v_mfma_f32_16x16x32_bf16 v[24:27], a[192:195], a[80:83], v[24:27]
  ds_read_b64_tr_b16 a[220:221], v209 offset:4104
  ds_read_b64_tr_b16 a[222:223], v209 offset:5128
  v_mfma_f32_16x16x32_bf16 v[24:27], a[196:199], a[92:95], v[24:27]
  ds_read_b64_tr_b16 a[224:225], v210 offset:0
  v_mfma_f32_16x16x32_bf16 v[28:31], a[200:203], a[72:75], v[28:31]
  ds_read_b64_tr_b16 a[226:227], v210 offset:1024
  v_mfma_f32_16x16x32_bf16 v[28:31], a[204:207], a[84:87], v[28:31]
  s_add_u32 m0, s61, 0
  ds_read_b64_tr_b16 a[228:229], v210 offset:4096
  v_mfma_f32_16x16x32_bf16 v[32:35], a[200:203], a[76:79], v[32:35]
  s_add_u32 s62, s46, 0
  ds_read_b64_tr_b16 a[230:231], v210 offset:5120
  v_mfma_f32_16x16x32_bf16 v[32:35], a[204:207], a[88:91], v[32:35]
  ds_read_b64_tr_b16 a[232:233], v210 offset:8
  v_mfma_f32_16x16x32_bf16 v[36:39], a[200:203], a[80:83], v[36:39]
  ds_read_b64_tr_b16 a[234:235], v210 offset:1032
  v_mfma_f32_16x16x32_bf16 v[36:39], a[204:207], a[92:95], v[36:39]
  s_waitcnt lgkmcnt(5)
  ds_read_b64_tr_b16 a[236:237], v210 offset:4104
  v_mfma_f32_16x16x32_bf16 v[40:43], a[208:211], a[72:75], v[40:43]
  s_waitcnt vmcnt(18)
  ds_read_b128 a[100:103], v214 offset:2048
  ds_read_b128 a[112:115], v215 offset:2048
  v_mfma_f32_16x16x32_bf16 v[40:43], a[212:215], a[84:87], v[40:43]
  buffer_load_dwordx4 v212, s[8:11], s62 offen offset:0 lds
  v_mfma_f32_16x16x32_bf16 v[44:47], a[208:211], a[76:79], v[44:47]
  buffer_load_dwordx4 v213, s[8:11], s62 offen offset:1024 lds
  v_mfma_f32_16x16x32_bf16 v[44:47], a[212:215], a[88:91], v[44:47]
  ds_read_b64_tr_b16 a[238:239], v210 offset:5128
  v_mfma_f32_16x16x32_bf16 v[48:51], a[208:211], a[80:83], v[48:51]
  ds_read_b64_tr_b16 a[192:193], v211 offset:0
  v_mfma_f32_16x16x32_bf16 v[48:51], a[212:215], a[92:95], v[48:51]
  ds_read_b64_tr_b16 a[194:195], v211 offset:1024
  v_mfma_f32_16x16x32_bf16 v[52:55], a[216:219], a[72:75], v[52:55]
  ds_read_b64_tr_b16 a[196:197], v211 offset:4096
  v_mfma_f32_16x16x32_bf16 v[52:55], a[220:223], a[84:87], v[52:55]
  s_add_u32 m0, s61, 2048
  ds_read_b64_tr_b16 a[198:199], v211 offset:5120
  v_mfma_f32_16x16x32_bf16 v[56:59], a[216:219], a[76:79], v[56:59]
  s_add_u32 s62, s46, 16384
  ds_read_b64_tr_b16 a[200:201], v211 offset:8
  v_mfma_f32_16x16x32_bf16 v[56:59], a[220:223], a[88:91], v[56:59]
  ds_read_b64_tr_b16 a[202:203], v211 offset:1032
  v_mfma_f32_16x16x32_bf16 v[60:63], a[216:219], a[80:83], v[60:63]
  ds_read_b64_tr_b16 a[204:205], v211 offset:4104
  v_mfma_f32_16x16x32_bf16 v[60:63], a[220:223], a[92:95], v[60:63]
  s_waitcnt lgkmcnt(5)
  ds_read_b64_tr_b16 a[206:207], v211 offset:5128
  v_mfma_f32_16x16x32_bf16 v[64:67], a[224:227], a[72:75], v[64:67]
  s_waitcnt vmcnt(16)
  ds_read_b128 a[104:107], v214 offset:4096
  ds_read_b128 a[116:119], v215 offset:4096
  v_mfma_f32_16x16x32_bf16 v[64:67], a[228:231], a[84:87], v[64:67]
  buffer_load_dwordx4 v212, s[8:11], s62 offen offset:0 lds
  v_mfma_f32_16x16x32_bf16 v[68:71], a[224:227], a[76:79], v[68:71]
  buffer_load_dwordx4 v213, s[8:11], s62 offen offset:1024 lds
  v_mfma_f32_16x16x32_bf16 v[68:71], a[228:231], a[88:91], v[68:71]
  s_waitcnt lgkmcnt(2)
  s_add_u32 m0, s37, 147456
  s_barrier
  ds_read_b64_tr_b16 a[208:209], v208 offset:8192
  v_mfma_f32_16x16x32_bf16 v[72:75], a[224:227], a[80:83], v[72:75]
  buffer_load_dwordx4 v3, s[20:23], s38 offen offset:0 nt lds
  v_mfma_f32_16x16x32_bf16 v[72:75], a[228:231], a[92:95], v[72:75]
  buffer_load_dwordx4 v3, s[20:23], s38 offen offset:1024 nt lds
  v_mfma_f32_16x16x32_bf16 v[76:79], a[232:235], a[72:75], v[76:79]
  s_add_u32 m0, s36, 49152
  ds_read_b64_tr_b16 a[210:211], v208 offset:9216
  v_mfma_f32_16x16x32_bf16 v[76:79], a[236:239], a[84:87], v[76:79]
  buffer_load_dwordx4 v216, s[12:15], s54 offen offset:0 lds
  v_mfma_f32_16x16x32_bf16 v[80:83], a[232:235], a[76:79], v[80:83]
  buffer_load_dwordx4 v217, s[12:15], s54 offen offset:1024 lds
  v_mfma_f32_16x16x32_bf16 v[80:83], a[236:239], a[88:91], v[80:83]
  s_add_u32 m0, s61, 4096
  ds_read_b64_tr_b16 a[212:213], v208 offset:12288
  v_mfma_f32_16x16x32_bf16 v[84:87], a[232:235], a[80:83], v[84:87]
  s_add_u32 s62, s46, 32768
  ds_read_b64_tr_b16 a[214:215], v208 offset:13312
  v_mfma_f32_16x16x32_bf16 v[84:87], a[236:239], a[92:95], v[84:87]
  ds_read_b64_tr_b16 a[216:217], v208 offset:8200
  v_mfma_f32_16x16x32_bf16 v[88:91], a[192:195], a[72:75], v[88:91]
  s_waitcnt vmcnt(16)
  ds_read_b128 a[120:123], v214 offset:6144
  ds_read_b128 a[132:135], v215 offset:6144
  v_mfma_f32_16x16x32_bf16 v[88:91], a[196:199], a[84:87], v[88:91]
  s_waitcnt lgkmcnt(5)
  buffer_load_dwordx4 v212, s[8:11], s62 offen offset:0 lds
  v_mfma_f32_16x16x32_bf16 v[92:95], a[192:195], a[76:79], v[92:95]
  buffer_load_dwordx4 v213, s[8:11], s62 offen offset:1024 lds
  v_mfma_f32_16x16x32_bf16 v[92:95], a[196:199], a[88:91], v[92:95]
  ds_read_b64_tr_b16 a[218:219], v208 offset:9224
  v_mfma_f32_16x16x32_bf16 v[96:99], a[192:195], a[80:83], v[96:99]
  ds_read_b64_tr_b16 a[220:221], v208 offset:12296
  ds_read_b64_tr_b16 a[222:223], v208 offset:13320
  v_mfma_f32_16x16x32_bf16 v[96:99], a[196:199], a[92:95], v[96:99]
  s_add_u32 m0, s36, 73736
  ds_read_b64_tr_b16 a[224:225], v209 offset:8192
  v_mfma_f32_16x16x32_bf16 v[100:103], a[200:203], a[72:75], v[100:103]
  buffer_load_dwordx4 v218, s[12:15], s54 offen offset:0 lds
  v_mfma_f32_16x16x32_bf16 v[100:103], a[204:207], a[84:87], v[100:103]
  buffer_load_dwordx4 v219, s[12:15], s54 offen offset:1024 lds
  v_mfma_f32_16x16x32_bf16 v[104:107], a[200:203], a[76:79], v[104:107]
  s_add_u32 m0, s61, 6144
  ds_read_b64_tr_b16 a[226:227], v209 offset:9216
  v_mfma_f32_16x16x32_bf16 v[104:107], a[204:207], a[88:91], v[104:107]
  s_add_u32 s62, s47, 0
  ds_read_b64_tr_b16 a[228:229], v209 offset:12288
  v_mfma_f32_16x16x32_bf16 v[108:111], a[200:203], a[80:83], v[108:111]
  ds_read_b64_tr_b16 a[230:231], v209 offset:13312
  v_mfma_f32_16x16x32_bf16 v[108:111], a[204:207], a[92:95], v[108:111]
  ds_read_b64_tr_b16 a[232:233], v209 offset:8200
  v_mfma_f32_16x16x32_bf16 v[16:19], a[208:211], a[96:99], v[16:19]
  s_waitcnt lgkmcnt(4)
  s_waitcnt vmcnt(16)
  ds_read_b128 a[124:127], v214 offset:8192
  ds_read_b128 a[136:139], v215 offset:8192
  v_mfma_f32_16x16x32_bf16 v[16:19], a[212:215], a[108:111], v[16:19]
  buffer_load_dwordx4 v212, s[8:11], s62 offen offset:0 lds
  v_mfma_f32_16x16x32_bf16 v[20:23], a[208:211], a[100:103], v[20:23]
  buffer_load_dwordx4 v213, s[8:11], s62 offen offset:1024 lds
  v_mfma_f32_16x16x32_bf16 v[20:23], a[212:215], a[112:115], v[20:23]
  s_add_u32 m0, s37, 147456
  ds_read_b64_tr_b16 a[234:235], v209 offset:9224
  v_mfma_f32_16x16x32_bf16 v[24:27], a[208:211], a[104:107], v[24:27]
  buffer_load_dwordx4 v3, s[20:23], s38 offen offset:2048 nt lds
  v_mfma_f32_16x16x32_bf16 v[24:27], a[212:215], a[116:119], v[24:27]
  buffer_load_dwordx4 v3, s[20:23], s38 offen offset:3072 nt lds
  v_mfma_f32_16x16x32_bf16 v[28:31], a[216:219], a[96:99], v[28:31]
  ds_read_b64_tr_b16 a[236:237], v209 offset:12296
  ds_read_b64_tr_b16 a[238:239], v209 offset:13320
  v_mfma_f32_16x16x32_bf16 v[28:31], a[220:223], a[108:111], v[28:31]
  s_add_u32 m0, s61, 8192
  ds_read_b64_tr_b16 a[192:193], v210 offset:8192
  v_mfma_f32_16x16x32_bf16 v[32:35], a[216:219], a[100:103], v[32:35]
  s_add_u32 s62, s47, 16384
  ds_read_b64_tr_b16 a[194:195], v210 offset:9216
  v_mfma_f32_16x16x32_bf16 v[32:35], a[220:223], a[112:115], v[32:35]
  ds_read_b64_tr_b16 a[196:197], v210 offset:12288
  v_mfma_f32_16x16x32_bf16 v[36:39], a[216:219], a[104:107], v[36:39]
  ds_read_b64_tr_b16 a[198:199], v210 offset:13312
  v_mfma_f32_16x16x32_bf16 v[36:39], a[220:223], a[116:119], v[36:39]
  s_waitcnt lgkmcnt(5)
  ds_read_b64_tr_b16 a[200:201], v210 offset:8200
  v_mfma_f32_16x16x32_bf16 v[40:43], a[224:227], a[96:99], v[40:43]
  s_waitcnt vmcnt(16)
  ds_read_b128 a[128:131], v214 offset:10240
  ds_read_b128 a[140:143], v215 offset:10240
  v_mfma_f32_16x16x32_bf16 v[40:43], a[228:231], a[108:111], v[40:43]
  buffer_load_dwordx4 v212, s[8:11], s62 offen offset:0 lds
  v_mfma_f32_16x16x32_bf16 v[44:47], a[224:227], a[100:103], v[44:47]
  buffer_load_dwordx4 v213, s[8:11], s62 offen offset:1024 lds
  v_mfma_f32_16x16x32_bf16 v[44:47], a[228:231], a[112:115], v[44:47]
  ds_read_b64_tr_b16 a[202:203], v210 offset:9224
  v_mfma_f32_16x16x32_bf16 v[48:51], a[224:227], a[104:107], v[48:51]
  ds_read_b64_tr_b16 a[204:205], v210 offset:12296
  ds_read_b64_tr_b16 a[206:207], v210 offset:13320
  v_mfma_f32_16x16x32_bf16 v[48:51], a[228:231], a[116:119], v[48:51]
  ds_read_b64_tr_b16 a[208:209], v211 offset:8192
  v_mfma_f32_16x16x32_bf16 v[52:55], a[232:235], a[96:99], v[52:55]
  s_waitcnt lgkmcnt(4)
  ds_read_b64_tr_b16 a[210:211], v211 offset:9216
  v_mfma_f32_16x16x32_bf16 v[52:55], a[236:239], a[108:111], v[52:55]
  s_add_u32 m0, s61, 10240
  ds_read_b64_tr_b16 a[212:213], v211 offset:12288
  v_mfma_f32_16x16x32_bf16 v[56:59], a[232:235], a[100:103], v[56:59]
  s_add_u32 s62, s47, 32768
  ds_read_b64_tr_b16 a[214:215], v211 offset:13312
  v_mfma_f32_16x16x32_bf16 v[56:59], a[236:239], a[112:115], v[56:59]
  ds_read_b64_tr_b16 a[216:217], v211 offset:8200
  v_mfma_f32_16x16x32_bf16 v[60:63], a[232:235], a[104:107], v[60:63]
  ds_read_b64_tr_b16 a[218:219], v211 offset:9224
  v_mfma_f32_16x16x32_bf16 v[60:63], a[236:239], a[116:119], v[60:63]
  ds_read_b64_tr_b16 a[220:221], v211 offset:12296
  v_mfma_f32_16x16x32_bf16 v[64:67], a[192:195], a[96:99], v[64:67]
  s_waitcnt vmcnt(16)
  ds_read_b128 a[144:147], v214 offset:0
  ds_read_b128 a[156:159], v215 offset:0
  v_mfma_f32_16x16x32_bf16 v[64:67], a[196:199], a[108:111], v[64:67]
  buffer_load_dwordx4 v212, s[8:11], s62 offen offset:0 lds
  v_mfma_f32_16x16x32_bf16 v[68:71], a[192:195], a[100:103], v[68:71]
  buffer_load_dwordx4 v213, s[8:11], s62 offen offset:1024 lds
  v_mfma_f32_16x16x32_bf16 v[68:71], a[196:199], a[112:115], v[68:71]
  ds_read_b64_tr_b16 a[222:223], v211 offset:13320
  v_mfma_f32_16x16x32_bf16 v[72:75], a[192:195], a[104:107], v[72:75]
  v_mfma_f32_16x16x32_bf16 v[72:75], a[196:199], a[116:119], v[72:75]
  s_waitcnt lgkmcnt(3)
  v_mfma_f32_16x16x32_bf16 v[76:79], a[200:203], a[96:99], v[76:79]
  v_mfma_f32_16x16x32_bf16 v[76:79], a[204:207], a[108:111], v[76:79]
  s_waitcnt lgkmcnt(0)
  s_barrier
  s_add_u32 m0, s36, 57344
  ds_read_b64_tr_b16 a[224:225], v208 offset:16384
  v_mfma_f32_16x16x32_bf16 v[80:83], a[200:203], a[100:103], v[80:83]
  buffer_load_dwordx4 v216, s[12:15], s55 offen offset:0 lds
  v_mfma_f32_16x16x32_bf16 v[80:83], a[204:207], a[112:115], v[80:83]
  buffer_load_dwordx4 v217, s[12:15], s55 offen offset:1024 lds
  v_mfma_f32_16x16x32_bf16 v[84:87], a[200:203], a[104:107], v[84:87]
  s_add_u32 m0, s37, 114688
  ds_read_b64_tr_b16 a[226:227], v208 offset:17408
  ds_read_b64_tr_b16 a[228:229], v208 offset:20480
  v_mfma_f32_16x16x32_bf16 v[84:87], a[204:207], a[116:119], v[84:87]
  s_add_u32 s38, s6, 16384
  ds_read_b64_tr_b16 a[230:231], v208 offset:21504
  v_mfma_f32_16x16x32_bf16 v[88:91], a[208:211], a[96:99], v[88:91]
  s_and_b32 s38, s38, 0x1c000
  s_waitcnt vmcnt(18)
  ds_read_b128 a[148:151], v214 offset:2048
  ds_read_b128 a[160:163], v215 offset:2048
  v_mfma_f32_16x16x32_bf16 v[88:91], a[212:215], a[108:111], v[88:91]
  buffer_load_dwordx4 v2, s[16:19], s38 offen offset:0 nt lds
  v_mfma_f32_16x16x32_bf16 v[92:95], a[208:211], a[100:103], v[92:95]
  buffer_load_dwordx4 v2, s[16:19], s38 offen offset:1024 nt lds
  v_mfma_f32_16x16x32_bf16 v[92:95], a[212:215], a[112:115], v[92:95]
  ds_read_b64_tr_b16 a[232:233], v208 offset:16392
  ds_read_b64_tr_b16 a[234:235], v208 offset:17416
  v_mfma_f32_16x16x32_bf16 v[96:99], a[208:211], a[104:107], v[96:99]
  ds_read_b64_tr_b16 a[236:237], v208 offset:20488
  ds_read_b64_tr_b16 a[238:239], v208 offset:21512
  v_mfma_f32_16x16x32_bf16 v[96:99], a[212:215], a[116:119], v[96:99]
  s_add_u32 m0, s36, 81928
  ds_read_b64_tr_b16 a[192:193], v209 offset:16384
  v_mfma_f32_16x16x32_bf16 v[100:103], a[216:219], a[96:99], v[100:103]
  buffer_load_dwordx4 v218, s[12:15], s55 offen offset:0 lds
  v_mfma_f32_16x16x32_bf16 v[100:103], a[220:223], a[108:111], v[100:103]
  buffer_load_dwordx4 v219, s[12:15], s55 offen offset:1024 lds
  v_mfma_f32_16x16x32_bf16 v[104:107], a[216:219], a[100:103], v[104:107]
  ds_read_b64_tr_b16 a[194:195], v209 offset:17408
  v_mfma_f32_16x16x32_bf16 v[104:107], a[220:223], a[112:115], v[104:107]
  ds_read_b64_tr_b16 a[196:197], v209 offset:20480
  v_mfma_f32_16x16x32_bf16 v[108:111], a[216:219], a[104:107], v[108:111]
  ds_read_b64_tr_b16 a[198:199], v209 offset:21504
  v_mfma_f32_16x16x32_bf16 v[108:111], a[220:223], a[116:119], v[108:111]
  s_waitcnt lgkmcnt(4)
  ds_read_b64_tr_b16 a[200:201], v209 offset:16392
  v_mfma_f32_16x16x32_bf16 v[16:19], a[224:227], a[120:123], v[16:19]
  s_waitcnt vmcnt(16)
  ds_read_b128 a[152:155], v214 offset:4096
  ds_read_b128 a[164:167], v215 offset:4096
  v_mfma_f32_16x16x32_bf16 v[16:19], a[228:231], a[132:135], v[16:19]
  ds_read_b64_tr_b16 a[202:203], v209 offset:17416
  v_mfma_f32_16x16x32_bf16 v[20:23], a[224:227], a[124:127], v[20:23]
  ds_read_b64_tr_b16 a[204:205], v209 offset:20488
  v_mfma_f32_16x16x32_bf16 v[20:23], a[228:231], a[136:139], v[20:23]
  ds_read_b64_tr_b16 a[206:207], v209 offset:21512
  v_mfma_f32_16x16x32_bf16 v[24:27], a[224:227], a[128:131], v[24:27]
  ds_read_b64_tr_b16 a[208:209], v210 offset:16384
  v_mfma_f32_16x16x32_bf16 v[24:27], a[228:231], a[140:143], v[24:27]
  ds_read_b64_tr_b16 a[210:211], v210 offset:17408
  v_mfma_f32_16x16x32_bf16 v[28:31], a[232:235], a[120:123], v[28:31]
  ds_read_b64_tr_b16 a[212:213], v210 offset:20480
  v_mfma_f32_16x16x32_bf16 v[28:31], a[236:239], a[132:135], v[28:31]
  s_add_u32 m0, s37, 114688
  ds_read_b64_tr_b16 a[214:215], v210 offset:21504
  v_mfma_f32_16x16x32_bf16 v[32:35], a[232:235], a[124:127], v[32:35]
  ds_read_b64_tr_b16 a[216:217], v210 offset:16392
  v_mfma_f32_16x16x32_bf16 v[32:35], a[236:239], a[136:139], v[32:35]
  buffer_load_dwordx4 v2, s[16:19], s38 offen offset:2048 nt lds
  v_mfma_f32_16x16x32_bf16 v[36:39], a[232:235], a[128:131], v[36:39]
  buffer_load_dwordx4 v2, s[16:19], s38 offen offset:3072 nt lds
  v_mfma_f32_16x16x32_bf16 v[36:39], a[236:239], a[140:143], v[36:39]
  s_waitcnt lgkmcnt(3)
  ds_read_b64_tr_b16 a[218:219], v210 offset:17416
  v_mfma_f32_16x16x32_bf16 v[40:43], a[192:195], a[120:123], v[40:43]
  s_waitcnt vmcnt(14)
  ds_read_b128 a[168:171], v214 offset:6144
  ds_read_b128 a[180:183], v215 offset:6144
  v_mfma_f32_16x16x32_bf16 v[40:43], a[196:199], a[132:135], v[40:43]
  ds_read_b64_tr_b16 a[220:221], v210 offset:20488
  v_mfma_f32_16x16x32_bf16 v[44:47], a[192:195], a[124:127], v[44:47]
  ds_read_b64_tr_b16 a[222:223], v210 offset:21512
  v_mfma_f32_16x16x32_bf16 v[44:47], a[196:199], a[136:139], v[44:47]
  ds_read_b64_tr_b16 a[224:225], v211 offset:16384
  v_mfma_f32_16x16x32_bf16 v[48:51], a[192:195], a[128:131], v[48:51]
  ds_read_b64_tr_b16 a[226:227], v211 offset:17408
  v_mfma_f32_16x16x32_bf16 v[48:51], a[196:199], a[140:143], v[48:51]
  ds_read_b64_tr_b16 a[228:229], v211 offset:20480
  v_mfma_f32_16x16x32_bf16 v[52:55], a[200:203], a[120:123], v[52:55]
  ds_read_b64_tr_b16 a[230:231], v211 offset:21504
  v_mfma_f32_16x16x32_bf16 v[52:55], a[204:207], a[132:135], v[52:55]
  ds_read_b64_tr_b16 a[232:233], v211 offset:16392
  v_mfma_f32_16x16x32_bf16 v[56:59], a[200:203], a[124:127], v[56:59]
  ds_read_b64_tr_b16 a[234:235], v211 offset:17416
  v_mfma_f32_16x16x32_bf16 v[56:59], a[204:207], a[136:139], v[56:59]
  ds_read_b64_tr_b16 a[236:237], v211 offset:20488
  v_mfma_f32_16x16x32_bf16 v[60:63], a[200:203], a[128:131], v[60:63]
  ds_read_b64_tr_b16 a[238:239], v211 offset:21512
  v_mfma_f32_16x16x32_bf16 v[60:63], a[204:207], a[140:143], v[60:63]
  v_mfma_f32_16x16x32_bf16 v[64:67], a[208:211], a[120:123], v[64:67]
  s_waitcnt lgkmcnt(5)
  s_waitcnt vmcnt(10)
  ds_read_b128 a[172:175], v214 offset:8192
  ds_read_b128 a[184:187], v215 offset:8192
  v_mfma_f32_16x16x32_bf16 v[64:67], a[212:215], a[132:135], v[64:67]
  v_mfma_f32_16x16x32_bf16 v[68:71], a[208:211], a[124:127], v[68:71]
  s_waitcnt lgkmcnt(2)
  s_barrier
  ds_read_b64_tr_b16 a[192:193], v208 offset:0
  v_mfma_f32_16x16x32_bf16 v[68:71], a[212:215], a[136:139], v[68:71]
  ds_read_b64_tr_b16 a[194:195], v208 offset:1024
  v_mfma_f32_16x16x32_bf16 v[72:75], a[208:211], a[128:131], v[72:75]
  ds_read_b64_tr_b16 a[196:197], v208 offset:4096
  v_mfma_f32_16x16x32_bf16 v[72:75], a[212:215], a[140:143], v[72:75]
  ds_read_b64_tr_b16 a[198:199], v208 offset:5120
  v_mfma_f32_16x16x32_bf16 v[76:79], a[216:219], a[120:123], v[76:79]
  ds_read_b64_tr_b16 a[200:201], v208 offset:8
  v_mfma_f32_16x16x32_bf16 v[76:79], a[220:223], a[132:135], v[76:79]
  ds_read_b64_tr_b16 a[202:203], v208 offset:1032
  v_mfma_f32_16x16x32_bf16 v[80:83], a[216:219], a[124:127], v[80:83]
  ds_read_b64_tr_b16 a[204:205], v208 offset:4104
  v_mfma_f32_16x16x32_bf16 v[80:83], a[220:223], a[136:139], v[80:83]
  s_add_u32 m0, s37, 98304
  ds_read_b64_tr_b16 a[206:207], v208 offset:5128
  v_mfma_f32_16x16x32_bf16 v[84:87], a[216:219], a[128:131], v[84:87]
  ds_read_b64_tr_b16 a[208:209], v209 offset:0
  v_mfma_f32_16x16x32_bf16 v[84:87], a[220:223], a[140:143], v[84:87]
  buffer_load_dwordx4 v3, s[20:23], s38 offen offset:0 nt lds
  v_mfma_f32_16x16x32_bf16 v[88:91], a[224:227], a[120:123], v[88:91]
  s_waitcnt vmcnt(9)
  ds_read_b128 a[176:179], v214 offset:10240
  ds_read_b128 a[188:191], v215 offset:10240
  v_mfma_f32_16x16x32_bf16 v[88:91], a[228:231], a[132:135], v[88:91]
  buffer_load_dwordx4 v3, s[20:23], s38 offen offset:1024 nt lds
  v_mfma_f32_16x16x32_bf16 v[92:95], a[224:227], a[124:127], v[92:95]
  ds_read_b64_tr_b16 a[210:211], v209 offset:1024
  v_mfma_f32_16x16x32_bf16 v[92:95], a[228:231], a[136:139], v[92:95]
  ds_read_b64_tr_b16 a[212:213], v209 offset:4096
  v_mfma_f32_16x16x32_bf16 v[96:99], a[224:227], a[128:131], v[96:99]
  ds_read_b64_tr_b16 a[214:215], v209 offset:5120
  v_mfma_f32_16x16x32_bf16 v[96:99], a[228:231], a[140:143], v[96:99]
  ds_read_b64_tr_b16 a[216:217], v209 offset:8
  v_mfma_f32_16x16x32_bf16 v[100:103], a[232:235], a[120:123], v[100:103]
  ds_read_b64_tr_b16 a[218:219], v209 offset:1032
  v_mfma_f32_16x16x32_bf16 v[100:103], a[236:239], a[132:135], v[100:103]
  ds_read_b64_tr_b16 a[220:221], v209 offset:4104
  v_mfma_f32_16x16x32_bf16 v[104:107], a[232:235], a[124:127], v[104:107]
  ds_read_b64_tr_b16 a[222:223], v209 offset:5128
  v_mfma_f32_16x16x32_bf16 v[104:107], a[236:239], a[136:139], v[104:107]
  ds_read_b64_tr_b16 a[224:225], v210 offset:0
  v_mfma_f32_16x16x32_bf16 v[108:111], a[232:235], a[128:131], v[108:111]
  ds_read_b64_tr_b16 a[226:227], v210 offset:1024
  v_mfma_f32_16x16x32_bf16 v[108:111], a[236:239], a[140:143], v[108:111]
  s_waitcnt lgkmcnt(6)
  ds_read_b64_tr_b16 a[228:229], v210 offset:4096
  v_mfma_f32_16x16x32_bf16 v[16:19], a[192:195], a[144:147], v[16:19]
  ds_read_b64_tr_b16 a[230:231], v210 offset:5120
  v_mfma_f32_16x16x32_bf16 v[16:19], a[196:199], a[156:159], v[16:19]
  v_mfma_f32_16x16x32_bf16 v[20:23], a[192:195], a[148:151], v[20:23]
  v_mfma_f32_16x16x32_bf16 v[20:23], a[196:199], a[160:163], v[20:23]
  ds_read_b64_tr_b16 a[232:233], v210 offset:8
  v_mfma_f32_16x16x32_bf16 v[24:27], a[192:195], a[152:155], v[24:27]
  ds_read_b64_tr_b16 a[234:235], v210 offset:1032
  v_mfma_f32_16x16x32_bf16 v[24:27], a[196:199], a[164:167], v[24:27]
  ds_read_b64_tr_b16 a[236:237], v210 offset:4104
  v_mfma_f32_16x16x32_bf16 v[28:31], a[200:203], a[144:147], v[28:31]
  ds_read_b64_tr_b16 a[238:239], v210 offset:5128
  v_mfma_f32_16x16x32_bf16 v[28:31], a[204:207], a[156:159], v[28:31]
  v_mfma_f32_16x16x32_bf16 v[32:35], a[200:203], a[148:151], v[32:35]
  v_mfma_f32_16x16x32_bf16 v[32:35], a[204:207], a[160:163], v[32:35]
  ds_read_b64_tr_b16 a[192:193], v211 offset:0
  v_mfma_f32_16x16x32_bf16 v[36:39], a[200:203], a[152:155], v[36:39]
  ds_read_b64_tr_b16 a[194:195], v211 offset:1024
  v_mfma_f32_16x16x32_bf16 v[36:39], a[204:207], a[164:167], v[36:39]
  s_add_u32 m0, s37, 98304
  ds_read_b64_tr_b16 a[196:197], v211 offset:4096
  v_mfma_f32_16x16x32_bf16 v[40:43], a[208:211], a[144:147], v[40:43]
  ds_read_b64_tr_b16 a[198:199], v211 offset:5120
  v_mfma_f32_16x16x32_bf16 v[40:43], a[212:215], a[156:159], v[40:43]
  buffer_load_dwordx4 v3, s[20:23], s38 offen offset:2048 nt lds
  v_mfma_f32_16x16x32_bf16 v[44:47], a[208:211], a[148:151], v[44:47]
  buffer_load_dwordx4 v3, s[20:23], s38 offen offset:3072 nt lds
  v_mfma_f32_16x16x32_bf16 v[44:47], a[212:215], a[160:163], v[44:47]
  ds_read_b64_tr_b16 a[200:201], v211 offset:8
  v_mfma_f32_16x16x32_bf16 v[48:51], a[208:211], a[152:155], v[48:51]
  ds_read_b64_tr_b16 a[202:203], v211 offset:1032
  v_mfma_f32_16x16x32_bf16 v[48:51], a[212:215], a[164:167], v[48:51]
  s_waitcnt lgkmcnt(4)
  ds_read_b64_tr_b16 a[204:205], v211 offset:4104
  v_mfma_f32_16x16x32_bf16 v[52:55], a[216:219], a[144:147], v[52:55]
  ds_read_b64_tr_b16 a[206:207], v211 offset:5128
  v_mfma_f32_16x16x32_bf16 v[52:55], a[220:223], a[156:159], v[52:55]
  v_mfma_f32_16x16x32_bf16 v[56:59], a[216:219], a[148:151], v[56:59]
  v_mfma_f32_16x16x32_bf16 v[56:59], a[220:223], a[160:163], v[56:59]
  v_mfma_f32_16x16x32_bf16 v[60:63], a[216:219], a[152:155], v[60:63]
  s_waitcnt lgkmcnt(0)
  s_waitcnt vmcnt(6)
  s_barrier
  ds_read_b64_tr_b16 a[208:209], v208 offset:8192
  v_mfma_f32_16x16x32_bf16 v[60:63], a[220:223], a[164:167], v[60:63]
  ds_read_b64_tr_b16 a[210:211], v208 offset:9216
  v_mfma_f32_16x16x32_bf16 v[64:67], a[224:227], a[144:147], v[64:67]
  ds_read_b64_tr_b16 a[212:213], v208 offset:12288
  v_mfma_f32_16x16x32_bf16 v[64:67], a[228:231], a[156:159], v[64:67]
  ds_read_b64_tr_b16 a[214:215], v208 offset:13312
  v_mfma_f32_16x16x32_bf16 v[68:71], a[224:227], a[148:151], v[68:71]
  v_mfma_f32_16x16x32_bf16 v[68:71], a[228:231], a[160:163], v[68:71]
  ds_read_b64_tr_b16 a[216:217], v208 offset:8200
  v_mfma_f32_16x16x32_bf16 v[72:75], a[224:227], a[152:155], v[72:75]
  ds_read_b64_tr_b16 a[218:219], v208 offset:9224
  v_mfma_f32_16x16x32_bf16 v[72:75], a[228:231], a[164:167], v[72:75]
  ds_read_b64_tr_b16 a[220:221], v208 offset:12296
  v_mfma_f32_16x16x32_bf16 v[76:79], a[232:235], a[144:147], v[76:79]
  ds_read_b64_tr_b16 a[222:223], v208 offset:13320
  v_mfma_f32_16x16x32_bf16 v[76:79], a[236:239], a[156:159], v[76:79]
  v_mfma_f32_16x16x32_bf16 v[80:83], a[232:235], a[148:151], v[80:83]
  v_mfma_f32_16x16x32_bf16 v[80:83], a[236:239], a[160:163], v[80:83]
  ds_read_b64_tr_b16 a[224:225], v209 offset:8192
  v_mfma_f32_16x16x32_bf16 v[84:87], a[232:235], a[152:155], v[84:87]
  ds_read_b64_tr_b16 a[226:227], v209 offset:9216
  v_mfma_f32_16x16x32_bf16 v[84:87], a[236:239], a[164:167], v[84:87]
  ds_read_b64_tr_b16 a[228:229], v209 offset:12288
  v_mfma_f32_16x16x32_bf16 v[88:91], a[192:195], a[144:147], v[88:91]
  ds_read_b64_tr_b16 a[230:231], v209 offset:13312
  v_mfma_f32_16x16x32_bf16 v[88:91], a[196:199], a[156:159], v[88:91]
  v_mfma_f32_16x16x32_bf16 v[92:95], a[192:195], a[148:151], v[92:95]
  s_add_u32 m0, s37, 0
  v_mfma_f32_16x16x32_bf16 v[92:95], a[196:199], a[160:163], v[92:95]
  s_add_u32 s38, s6, 32768
  ds_read_b64_tr_b16 a[232:233], v209 offset:8200
  v_mfma_f32_16x16x32_bf16 v[96:99], a[192:195], a[152:155], v[96:99]
  s_and_b32 s38, s38, 0x1c000
  ds_read_b64_tr_b16 a[234:235], v209 offset:9224
  v_mfma_f32_16x16x32_bf16 v[96:99], a[196:199], a[164:167], v[96:99]
  buffer_load_dwordx4 v2, s[16:19], s38 offen offset:0 nt lds
  v_mfma_f32_16x16x32_bf16 v[100:103], a[200:203], a[144:147], v[100:103]
  ds_read_b64_tr_b16 a[236:237], v209 offset:12296
  v_mfma_f32_16x16x32_bf16 v[100:103], a[204:207], a[156:159], v[100:103]
  ds_read_b64_tr_b16 a[238:239], v209 offset:13320
  v_mfma_f32_16x16x32_bf16 v[104:107], a[200:203], a[148:151], v[104:107]
  v_mfma_f32_16x16x32_bf16 v[104:107], a[204:207], a[160:163], v[104:107]
  ds_read_b64_tr_b16 a[192:193], v210 offset:8192
  v_mfma_f32_16x16x32_bf16 v[108:111], a[200:203], a[152:155], v[108:111]
  ds_read_b64_tr_b16 a[194:195], v210 offset:9216
  v_mfma_f32_16x16x32_bf16 v[108:111], a[204:207], a[164:167], v[108:111]
  s_waitcnt lgkmcnt(4)
  ds_read_b64_tr_b16 a[196:197], v210 offset:12288
  v_mfma_f32_16x16x32_bf16 v[16:19], a[208:211], a[168:171], v[16:19]
  ds_read_b64_tr_b16 a[198:199], v210 offset:13312
  v_mfma_f32_16x16x32_bf16 v[16:19], a[212:215], a[180:183], v[16:19]
  v_mfma_f32_16x16x32_bf16 v[20:23], a[208:211], a[172:175], v[20:23]
  v_mfma_f32_16x16x32_bf16 v[20:23], a[212:215], a[184:187], v[20:23]
  s_add_u32 m0, s37, 0
  ds_read_b64_tr_b16 a[200:201], v210 offset:8200
  v_mfma_f32_16x16x32_bf16 v[24:27], a[208:211], a[176:179], v[24:27]
  ds_read_b64_tr_b16 a[202:203], v210 offset:9224
  v_mfma_f32_16x16x32_bf16 v[24:27], a[212:215], a[188:191], v[24:27]
  buffer_load_dwordx4 v2, s[16:19], s38 offen offset:1024 nt lds
  v_mfma_f32_16x16x32_bf16 v[28:31], a[216:219], a[168:171], v[28:31]
  ds_read_b64_tr_b16 a[204:205], v210 offset:12296
  v_mul_f32 v16, s39, v16
  v_mfma_f32_16x16x32_bf16 v[28:31], a[220:223], a[180:183], v[28:31]
  ds_read_b64_tr_b16 a[206:207], v210 offset:13320
  v_mul_f32 v17, s39, v17
  v_mfma_f32_16x16x32_bf16 v[32:35], a[216:219], a[172:175], v[32:35]
  v_mul_f32 v18, s39, v18
  v_mul_f32 v19, s39, v19
  v_mfma_f32_16x16x32_bf16 v[32:35], a[220:223], a[184:187], v[32:35]
  ds_read_b64_tr_b16 a[208:209], v211 offset:8192
  v_cvt_pk_bf16_f32 v112, v16, v17
  v_mfma_f32_16x16x32_bf16 v[36:39], a[216:219], a[176:179], v[36:39]
  ds_read_b64_tr_b16 a[210:211], v211 offset:9216
  v_cvt_pk_bf16_f32 v113, v18, v19
  v_mfma_f32_16x16x32_bf16 v[36:39], a[220:223], a[188:191], v[36:39]
  ds_read_b64_tr_b16 a[212:213], v211 offset:12288
  v_mul_f32 v28, s39, v28
  v_mfma_f32_16x16x32_bf16 v[40:43], a[224:227], a[168:171], v[40:43]
  ds_read_b64_tr_b16 a[214:215], v211 offset:13312
  v_mul_f32 v29, s39, v29
  v_mfma_f32_16x16x32_bf16 v[40:43], a[228:231], a[180:183], v[40:43]
  v_mul_f32 v30, s39, v30
  v_mul_f32 v31, s39, v31
  v_mfma_f32_16x16x32_bf16 v[44:47], a[224:227], a[172:175], v[44:47]
  v_cvt_pk_bf16_f32 v114, v28, v29
  v_cvt_pk_bf16_f32 v115, v30, v31
  v_mfma_f32_16x16x32_bf16 v[44:47], a[228:231], a[184:187], v[44:47]
  ds_read_b64_tr_b16 a[216:217], v211 offset:8200
  v_mul_f32 v20, s39, v20
  v_mfma_f32_16x16x32_bf16 v[48:51], a[224:227], a[176:179], v[48:51]
  s_add_u32 m0, s37, 0
  ds_read_b64_tr_b16 a[218:219], v211 offset:9224
  v_mul_f32 v21, s39, v21
  v_mfma_f32_16x16x32_bf16 v[48:51], a[228:231], a[188:191], v[48:51]
  ds_read_b64_tr_b16 a[220:221], v211 offset:12296
  v_mul_f32 v22, s39, v22
  v_mfma_f32_16x16x32_bf16 v[52:55], a[232:235], a[168:171], v[52:55]
  s_waitcnt lgkmcnt(3)
  buffer_load_dwordx4 v2, s[16:19], s38 offen offset:2048 nt lds
  v_mfma_f32_16x16x32_bf16 v[52:55], a[236:239], a[180:183], v[52:55]
  ds_read_b64_tr_b16 a[222:223], v211 offset:13320
  v_mul_f32 v23, s39, v23
  v_mfma_f32_16x16x32_bf16 v[56:59], a[232:235], a[172:175], v[56:59]
  v_cvt_pk_bf16_f32 v116, v20, v21
  v_cvt_pk_bf16_f32 v117, v22, v23
  v_mfma_f32_16x16x32_bf16 v[56:59], a[236:239], a[184:187], v[56:59]
  v_mul_f32 v32, s39, v32
  v_mul_f32 v33, s39, v33
  v_mfma_f32_16x16x32_bf16 v[60:63], a[232:235], a[176:179], v[60:63]
  v_mul_f32 v34, s39, v34
  v_mul_f32 v35, s39, v35
  v_mfma_f32_16x16x32_bf16 v[60:63], a[236:239], a[188:191], v[60:63]
  v_cvt_pk_bf16_f32 v118, v32, v33
  v_cvt_pk_bf16_f32 v119, v34, v35
  v_mfma_f32_16x16x32_bf16 v[64:67], a[192:195], a[168:171], v[64:67]
  v_mul_f32 v24, s39, v24
  v_mul_f32 v25, s39, v25
  v_mfma_f32_16x16x32_bf16 v[64:67], a[196:199], a[180:183], v[64:67]
  v_mul_f32 v26, s39, v26
  v_mul_f32 v27, s39, v27
  v_mfma_f32_16x16x32_bf16 v[68:71], a[192:195], a[172:175], v[68:71]
  v_cvt_pk_bf16_f32 v120, v24, v25
  v_cvt_pk_bf16_f32 v121, v26, v27
  v_mfma_f32_16x16x32_bf16 v[68:71], a[196:199], a[184:187], v[68:71]
  v_mul_f32 v36, s39, v36
  v_mul_f32 v37, s39, v37
  v_mfma_f32_16x16x32_bf16 v[72:75], a[192:195], a[176:179], v[72:75]
  v_mul_f32 v38, s39, v38
  v_mul_f32 v39, s39, v39
  v_mfma_f32_16x16x32_bf16 v[72:75], a[196:199], a[188:191], v[72:75]
  s_add_u32 m0, s37, 0
  v_cvt_pk_bf16_f32 v122, v36, v37
  v_cvt_pk_bf16_f32 v123, v38, v39
  v_mfma_f32_16x16x32_bf16 v[76:79], a[200:203], a[168:171], v[76:79]
  s_and_b32 s7, s2, 1
  v_mul_f32 v40, s39, v40
  v_mul_f32 v41, s39, v41
  v_mfma_f32_16x16x32_bf16 v[76:79], a[204:207], a[180:183], v[76:79]
  s_lshl_b32 s7, s7, 7
  v_lshl_add_u32 v244, v0, 12, s7
  v_mul_f32 v42, s39, v42
  v_mfma_f32_16x16x32_bf16 v[80:83], a[200:203], a[172:175], v[80:83]
  buffer_load_dwordx4 v2, s[16:19], s38 offen offset:3072 nt lds
  v_mfma_f32_16x16x32_bf16 v[80:83], a[204:207], a[184:187], v[80:83]
  v_mul_f32 v43, s39, v43
  v_cvt_pk_bf16_f32 v124, v40, v41
  v_mfma_f32_16x16x32_bf16 v[84:87], a[200:203], a[176:179], v[84:87]
  s_waitcnt lgkmcnt(0)
  s_barrier
  ds_read_b128 a[64:67], v4 offset:16384
  v_mfma_f32_16x16x32_bf16 v[84:87], a[204:207], a[188:191], v[84:87]
  ds_read_b128 a[68:71], v4 offset:17408
  v_cvt_pk_bf16_f32 v125, v42, v43
  v_mfma_f32_16x16x32_bf16 v[88:91], a[208:211], a[168:171], v[88:91]
  ds_read_b128 a[72:75], v5 offset:16384
  v_mul_f32 v52, s39, v52
  v_mfma_f32_16x16x32_bf16 v[88:91], a[212:215], a[180:183], v[88:91]
  ds_read_b128 a[76:79], v5 offset:17408
  v_mul_f32 v53, s39, v53
  v_mfma_f32_16x16x32_bf16 v[92:95], a[208:211], a[172:175], v[92:95]
  ds_read_b128 a[80:83], v6 offset:16384
  v_mul_f32 v54, s39, v54
  v_mfma_f32_16x16x32_bf16 v[92:95], a[212:215], a[184:187], v[92:95]
  ds_read_b128 a[84:87], v6 offset:17408
  v_mul_f32 v55, s39, v55
  v_mfma_f32_16x16x32_bf16 v[96:99], a[208:211], a[176:179], v[96:99]
  buffer_atomic_add v245, v244, s[68:71], 0 offen sc1
  v_mfma_f32_16x16x32_bf16 v[96:99], a[212:215], a[188:191], v[96:99]
  ds_read_b128 a[88:91], v7 offset:16384
  v_cvt_pk_bf16_f32 v126, v52, v53
  v_mfma_f32_16x16x32_bf16 v[100:103], a[216:219], a[168:171], v[100:103]
  s_add_u32 m0, s37, 16384
  ds_read_b128 a[92:95], v7 offset:17408
  v_cvt_pk_bf16_f32 v127, v54, v55
  v_mfma_f32_16x16x32_bf16 v[100:103], a[220:223], a[180:183], v[100:103]
  ds_read_b128 a[96:99], v4 offset:18432
  v_mul_f32 v44, s39, v44
  v_mfma_f32_16x16x32_bf16 v[104:107], a[216:219], a[172:175], v[104:107]
  buffer_load_dwordx4 v3, s[20:23], s38 offen offset:0 nt lds
  v_mfma_f32_16x16x32_bf16 v[104:107], a[220:223], a[184:187], v[104:107]
  ds_read_b128 a[100:103], v5 offset:18432
  v_mul_f32 v45, s39, v45
  v_mfma_f32_16x16x32_bf16 v[108:111], a[216:219], a[176:179], v[108:111]
  ds_read_b128 a[104:107], v6 offset:18432
  v_mul_f32 v46, s39, v46
  v_mfma_f32_16x16x32_bf16 v[108:111], a[220:223], a[188:191], v[108:111]
  s_waitcnt lgkmcnt(3)
  ds_read_b128 a[108:111], v7 offset:18432
  v_mul_f32 v47, s39, v47
  v_mfma_f32_16x16x32_bf16 v[160:163], a[64:67], v[112:115], 0
  v_cvt_pk_bf16_f32 v128, v44, v45
  v_cvt_pk_bf16_f32 v129, v46, v47
  v_mfma_f32_16x16x32_bf16 v[164:167], a[64:67], v[116:119], 0
  v_mul_f32 v56, s39, v56
  v_mul_f32 v57, s39, v57
  v_mfma_f32_16x16x32_bf16 v[168:171], a[64:67], v[120:123], 0
  v_mul_f32 v58, s39, v58
  v_mul_f32 v59, s39, v59
  v_mfma_f32_16x16x32_bf16 v[172:175], a[68:71], v[112:115], 0
  v_cvt_pk_bf16_f32 v130, v56, v57
  v_cvt_pk_bf16_f32 v131, v58, v59
  v_mfma_f32_16x16x32_bf16 v[176:179], a[68:71], v[116:119], 0
  v_mul_f32 v48, s39, v48
  v_mul_f32 v49, s39, v49
  v_mfma_f32_16x16x32_bf16 v[180:183], a[68:71], v[120:123], 0
  v_mul_f32 v50, s39, v50
  v_mul_f32 v51, s39, v51
  v_mfma_f32_16x16x32_bf16 v[160:163], a[72:75], v[124:127], v[160:163]
  v_cvt_pk_bf16_f32 v132, v48, v49
  v_cvt_pk_bf16_f32 v133, v50, v51
  v_mul_f32 v60, s39, v60
  v_mul_f32 v61, s39, v61
  v_mul_f32 v62, s39, v62
  v_mul_f32 v63, s39, v63
  v_cvt_pk_bf16_f32 v134, v60, v61
  v_cvt_pk_bf16_f32 v135, v62, v63
  v_mfma_f32_16x16x32_bf16 v[164:167], a[72:75], v[128:131], v[164:167]
  s_add_u32 m0, s37, 16384
  v_mul_f32 v64, s39, v64
  v_mul_f32 v65, s39, v65
  v_mfma_f32_16x16x32_bf16 v[168:171], a[72:75], v[132:135], v[168:171]
  v_mul_f32 v66, s39, v66
  v_mul_f32 v67, s39, v67
  v_mfma_f32_16x16x32_bf16 v[172:175], a[76:79], v[124:127], v[172:175]
  buffer_load_dwordx4 v3, s[20:23], s38 offen offset:1024 nt lds
  v_mfma_f32_16x16x32_bf16 v[176:179], a[76:79], v[128:131], v[176:179]
  v_cvt_pk_bf16_f32 v136, v64, v65
  v_cvt_pk_bf16_f32 v137, v66, v67
  v_mul_f32 v76, s39, v76
  v_mul_f32 v77, s39, v77
  v_mul_f32 v78, s39, v78
  v_mul_f32 v79, s39, v79
  v_cvt_pk_bf16_f32 v138, v76, v77
  v_cvt_pk_bf16_f32 v139, v78, v79
  v_mfma_f32_16x16x32_bf16 v[180:183], a[76:79], v[132:135], v[180:183]
  v_mul_f32 v68, s39, v68
  v_mul_f32 v69, s39, v69
  v_mul_f32 v70, s39, v70
  v_mul_f32 v71, s39, v71
  v_cvt_pk_bf16_f32 v140, v68, v69
  v_cvt_pk_bf16_f32 v141, v70, v71
  v_mul_f32 v80, s39, v80
  v_mul_f32 v81, s39, v81
  v_mul_f32 v82, s39, v82
  v_mul_f32 v83, s39, v83
  v_cvt_pk_bf16_f32 v142, v80, v81
  v_cvt_pk_bf16_f32 v143, v82, v83
  v_mfma_f32_16x16x32_bf16 v[160:163], a[80:83], v[136:139], v[160:163]
  v_mul_f32 v72, s39, v72
  v_mul_f32 v73, s39, v73
  v_mul_f32 v74, s39, v74
  v_mul_f32 v75, s39, v75
  v_cvt_pk_bf16_f32 v144, v72, v73
  v_cvt_pk_bf16_f32 v145, v74, v75
  v_mul_f32 v84, s39, v84
  v_mul_f32 v85, s39, v85
  v_mul_f32 v86, s39, v86
  v_mul_f32 v87, s39, v87
  v_cvt_pk_bf16_f32 v146, v84, v85
  v_cvt_pk_bf16_f32 v147, v86, v87
  v_mfma_f32_16x16x32_bf16 v[164:167], a[80:83], v[140:143], v[164:167]
  v_mul_f32 v88, s39, v88
  v_mul_f32 v89, s39, v89
  v_mfma_f32_16x16x32_bf16 v[168:171], a[80:83], v[144:147], v[168:171]
  v_mul_f32 v90, s39, v90
  v_mul_f32 v91, s39, v91
  v_mfma_f32_16x16x32_bf16 v[172:175], a[84:87], v[136:139], v[172:175]
  v_cvt_pk_bf16_f32 v148, v88, v89
  v_cvt_pk_bf16_f32 v149, v90, v91
  v_mfma_f32_16x16x32_bf16 v[176:179], a[84:87], v[140:143], v[176:179]
  v_mul_f32 v100, s39, v100
  v_mul_f32 v101, s39, v101
  v_mul_f32 v102, s39, v102
  v_mul_f32 v103, s39, v103
  v_cvt_pk_bf16_f32 v150, v100, v101
  v_cvt_pk_bf16_f32 v151, v102, v103
  v_mfma_f32_16x16x32_bf16 v[180:183], a[84:87], v[144:147], v[180:183]
  v_mul_f32 v92, s39, v92
  v_mul_f32 v93, s39, v93
  v_mul_f32 v94, s39, v94
  v_mul_f32 v95, s39, v95
  v_cvt_pk_bf16_f32 v152, v92, v93
  v_cvt_pk_bf16_f32 v153, v94, v95
  v_mul_f32 v104, s39, v104
  v_mul_f32 v105, s39, v105
  v_mul_f32 v106, s39, v106
  v_mul_f32 v107, s39, v107
  v_cvt_pk_bf16_f32 v154, v104, v105
  v_cvt_pk_bf16_f32 v155, v106, v107
  v_mfma_f32_16x16x32_bf16 v[160:163], a[88:91], v[148:151], v[160:163]
  v_mul_f32 v96, s39, v96
  v_mul_f32 v97, s39, v97
  v_mul_f32 v98, s39, v98
  v_mul_f32 v99, s39, v99
  v_cvt_pk_bf16_f32 v156, v96, v97
  v_cvt_pk_bf16_f32 v157, v98, v99
  v_mul_f32 v108, s39, v108
  v_mul_f32 v109, s39, v109
  v_mul_f32 v110, s39, v110
  v_mul_f32 v111, s39, v111
  v_cvt_pk_bf16_f32 v158, v108, v109
  v_cvt_pk_bf16_f32 v159, v110, v111
  v_mfma_f32_16x16x32_bf16 v[164:167], a[88:91], v[152:155], v[164:167]
  ds_read_b128 a[64:67], v4 offset:19456
  v_mfma_f32_16x16x32_bf16 v[168:171], a[88:91], v[156:159], v[168:171]
  s_add_u32 m0, s37, 16384
  ds_read_b128 a[68:71], v5 offset:19456
  v_mfma_f32_16x16x32_bf16 v[172:175], a[92:95], v[148:151], v[172:175]
  ds_read_b128 a[72:75], v6 offset:19456
  v_mfma_f32_16x16x32_bf16 v[176:179], a[92:95], v[152:155], v[176:179]
  buffer_load_dwordx4 v3, s[20:23], s38 offen offset:2048 nt lds
  v_mfma_f32_16x16x32_bf16 v[180:183], a[92:95], v[156:159], v[180:183]
  s_waitcnt lgkmcnt(3)
  ds_read_b128 a[76:79], v7 offset:19456
  v_max3_f32 v244, v160, v161, v162
  v_mfma_f32_16x16x32_bf16 v[184:187], a[96:99], v[112:115], 0
  v_max3_f32 v246, v164, v165, v166
  v_max3_f32 v248, v168, v169, v170
  v_mfma_f32_16x16x32_bf16 v[184:187], a[100:103], v[124:127], v[184:187]
  v_max3_f32 v244, v244, v163, v172
  v_max3_f32 v244, v244, v173, v174
  v_mfma_f32_16x16x32_bf16 v[184:187], a[104:107], v[136:139], v[184:187]
  v_max_f32 v244, v244, v175
  v_mov_b32 v245, v244
  v_mfma_f32_16x16x32_bf16 v[184:187], a[108:111], v[148:151], v[184:187]
  s_nop 0
  v_permlane32_swap_b32 v245, v244
  v_max_f32 v244, v244, v245
  v_mfma_f32_16x16x32_bf16 v[188:191], a[96:99], v[116:119], 0
  v_mov_b32 v245, v244
  v_max3_f32 v246, v246, v167, v176
  v_mfma_f32_16x16x32_bf16 v[188:191], a[100:103], v[128:131], v[188:191]
  v_permlane16_swap_b32 v245, v244
  v_max_f32 v244, v244, v245
  v_mfma_f32_16x16x32_bf16 v[188:191], a[104:107], v[140:143], v[188:191]
  v_sub_f32 v232, 0, v244
  v_add_f32 v160, v160, v232
  v_mfma_f32_16x16x32_bf16 v[188:191], a[108:111], v[152:155], v[188:191]
  v_exp_f32 v160, v160
  v_mfma_f32_16x16x32_bf16 v[192:195], a[96:99], v[120:123], 0
  v_add_f32 v161, v161, v232
  v_add_f32 v162, v162, v232
  v_mfma_f32_16x16x32_bf16 v[192:195], a[100:103], v[132:135], v[192:195]
  v_exp_f32 v161, v161
  v_mfma_f32_16x16x32_bf16 v[192:195], a[104:107], v[144:147], v[192:195]
  s_add_u32 m0, s37, 16384
  s_waitcnt vmcnt(12)
  s_barrier
  ds_read_b64_tr_b16 a[112:113], v8 offset:49152
  v_mfma_f32_16x16x32_bf16 v[192:195], a[108:111], v[156:159], v[192:195]
  s_waitcnt lgkmcnt(1)
  ds_read_b64_tr_b16 a[114:115], v8 offset:50176
  v_add_f32 v163, v163, v232
  v_mfma_f32_16x16x32_bf16 v[196:199], a[64:67], v[112:115], 0
  buffer_load_dwordx4 v3, s[20:23], s38 offen offset:3072 nt lds
  v_mfma_f32_16x16x32_bf16 v[196:199], a[68:71], v[124:127], v[196:199]
  ds_read_b64_tr_b16 a[116:117], v9 offset:49152
  ds_read_b64_tr_b16 a[118:119], v9 offset:50176
  v_mfma_f32_16x16x32_bf16 v[196:199], a[72:75], v[136:139], v[196:199]
  ds_read_b64_tr_b16 a[120:121], v10 offset:49152
  ds_read_b64_tr_b16 a[122:123], v10 offset:50176
  v_mfma_f32_16x16x32_bf16 v[196:199], a[76:79], v[148:151], v[196:199]
  ds_read_b64_tr_b16 a[124:125], v11 offset:49152
  ds_read_b64_tr_b16 a[126:127], v11 offset:50176
  v_mfma_f32_16x16x32_bf16 v[200:203], a[64:67], v[116:119], 0
  ds_read_b64_tr_b16 a[128:129], v12 offset:49152
  ds_read_b64_tr_b16 a[130:131], v12 offset:50176
  v_mfma_f32_16x16x32_bf16 v[200:203], a[68:71], v[128:131], v[200:203]
  ds_read_b64_tr_b16 a[132:133], v13 offset:49152
  ds_read_b64_tr_b16 a[134:135], v13 offset:50176
  v_mfma_f32_16x16x32_bf16 v[200:203], a[72:75], v[140:143], v[200:203]
  ds_read_b64_tr_b16 a[136:137], v14 offset:49152
  ds_read_b64_tr_b16 a[138:139], v14 offset:50176
  v_mfma_f32_16x16x32_bf16 v[200:203], a[76:79], v[152:155], v[200:203]
  ds_read_b64_tr_b16 a[140:141], v15 offset:49152
  ds_read_b64_tr_b16 a[142:143], v15 offset:50176
  v_mfma_f32_16x16x32_bf16 v[204:207], a[64:67], v[120:123], 0
  v_exp_f32 v162, v162
  v_mfma_f32_16x16x32_bf16 v[204:207], a[68:71], v[132:135], v[204:207]
  v_exp_f32 v163, v163
  v_add_f32 v172, v172, v232
  v_exp_f32 v172, v172
  v_add_f32 v173, v173, v232
  v_exp_f32 v173, v173
  v_add_f32 v174, v174, v232
  v_exp_f32 v174, v174
  v_add_f32 v175, v175, v232
  v_exp_f32 v175, v175
  v_mfma_f32_16x16x32_bf16 v[204:207], a[72:75], v[144:147], v[204:207]
  v_cvt_pk_bf16_f32 v208, v160, v161
  v_cvt_pk_bf16_f32 v209, v162, v163
  v_cvt_pk_bf16_f32 v210, v172, v173
  v_cvt_pk_bf16_f32 v211, v174, v175
  v_mfma_f32_16x16x32_bf16 v[204:207], a[76:79], v[156:159], v[204:207]
  s_waitcnt lgkmcnt(0)
  s_add_u32 m0, s37, 32768
  ds_read_b128 a[80:83], v4 offset:0
  v_max3_f32 v246, v246, v177, v178
  v_mfma_f32_16x16x32_bf16 v[16:19], a[112:115], v[208:211], 0
  s_add_u32 s38, s6, 49152
  v_max_f32 v246, v246, v179
  v_mov_b32 v247, v246
  v_mfma_f32_16x16x32_bf16 v[28:31], a[116:119], v[208:211], 0
  s_and_b32 s38, s38, 0x1c000
  v_permlane32_swap_b32 v247, v246
  v_max_f32 v246, v246, v247
  v_mfma_f32_16x16x32_bf16 v[40:43], a[120:123], v[208:211], 0
  buffer_load_dwordx4 v2, s[16:19], s38 offen offset:0 nt lds
  v_mfma_f32_16x16x32_bf16 v[52:55], a[124:127], v[208:211], 0
  v_mov_b32 v247, v246
  v_max3_f32 v248, v248, v171, v180
  v_mfma_f32_16x16x32_bf16 v[64:67], a[128:131], v[208:211], 0
  v_permlane16_swap_b32 v247, v246
  v_max_f32 v246, v246, v247
  v_mfma_f32_16x16x32_bf16 v[76:79], a[132:135], v[208:211], 0
  v_sub_f32 v236, 0, v246
  v_add_f32 v164, v164, v236
  v_mfma_f32_16x16x32_bf16 v[88:91], a[136:139], v[208:211], 0
  v_exp_f32 v164, v164
  v_add_f32 v165, v165, v236
  v_exp_f32 v165, v165
  v_add_f32 v166, v166, v236
  v_exp_f32 v166, v166
  v_add_f32 v167, v167, v236
  v_exp_f32 v167, v167
  v_add_f32 v176, v176, v236
  v_exp_f32 v176, v176
  v_add_f32 v177, v177, v236
  v_exp_f32 v177, v177
  v_add_f32 v178, v178, v236
  v_exp_f32 v178, v178
  v_add_f32 v179, v179, v236
  v_exp_f32 v179, v179
  v_mfma_f32_16x16x32_bf16 v[100:103], a[140:143], v[208:211], 0
  v_cvt_pk_bf16_f32 v212, v164, v165
  v_cvt_pk_bf16_f32 v213, v166, v167
  v_cvt_pk_bf16_f32 v214, v176, v177
  v_cvt_pk_bf16_f32 v215, v178, v179
  v_mfma_f32_16x16x32_bf16 a[48:51], a[60:63], v[208:211], 0
  ds_read_b128 a[84:87], v5 offset:0
  v_max3_f32 v248, v248, v181, v182
  v_mfma_f32_16x16x32_bf16 v[20:23], a[112:115], v[212:215], 0
  v_max_f32 v248, v248, v183
  v_mov_b32 v249, v248
  v_mfma_f32_16x16x32_bf16 v[32:35], a[116:119], v[212:215], 0
  s_nop 0
  v_permlane32_swap_b32 v249, v248
  v_max_f32 v248, v248, v249
  v_mfma_f32_16x16x32_bf16 v[44:47], a[120:123], v[212:215], 0
  v_mov_b32 v249, v248
  v_sub_f32 v233, 0, v244
  v_mfma_f32_16x16x32_bf16 v[56:59], a[124:127], v[212:215], 0
  s_add_u32 m0, s37, 32768
  v_permlane16_swap_b32 v249, v248
  v_max_f32 v248, v248, v249
  v_mfma_f32_16x16x32_bf16 v[68:71], a[128:131], v[212:215], 0
  v_sub_f32 v240, 0, v248
  v_add_f32 v168, v168, v240
  v_mfma_f32_16x16x32_bf16 v[80:83], a[132:135], v[212:215], 0
  buffer_load_dwordx4 v2, s[16:19], s38 offen offset:1024 nt lds
  v_mfma_f32_16x16x32_bf16 v[92:95], a[136:139], v[212:215], 0
  v_exp_f32 v168, v168
  v_add_f32 v169, v169, v240
  v_exp_f32 v169, v169
  v_add_f32 v170, v170, v240
  v_exp_f32 v170, v170
  v_add_f32 v171, v171, v240
  v_exp_f32 v171, v171
  v_add_f32 v180, v180, v240
  v_exp_f32 v180, v180
  v_add_f32 v181, v181, v240
  v_exp_f32 v181, v181
  v_add_f32 v182, v182, v240
  v_exp_f32 v182, v182
  v_add_f32 v183, v183, v240
  v_exp_f32 v183, v183
  v_mfma_f32_16x16x32_bf16 v[104:107], a[140:143], v[212:215], 0
  v_cvt_pk_bf16_f32 v216, v168, v169
  v_cvt_pk_bf16_f32 v217, v170, v171
  v_cvt_pk_bf16_f32 v218, v180, v181
  v_cvt_pk_bf16_f32 v219, v182, v183
  v_mfma_f32_16x16x32_bf16 a[52:55], a[60:63], v[212:215], 0
  ds_read_b128 a[88:91], v6 offset:0
  ds_read_b128 a[92:95], v7 offset:0
  v_mfma_f32_16x16x32_bf16 v[24:27], a[112:115], v[216:219], 0
  ds_read_b128 a[96:99], v4 offset:1024
  v_sub_f32 v234, 0, v244
  v_mfma_f32_16x16x32_bf16 v[36:39], a[116:119], v[216:219], 0
  ds_read_b128 a[100:103], v5 offset:1024
  v_sub_f32 v235, 0, v244
  v_mfma_f32_16x16x32_bf16 v[48:51], a[120:123], v[216:219], 0
  ds_read_b128 a[104:107], v6 offset:1024
  v_sub_f32 v237, 0, v246
  v_mfma_f32_16x16x32_bf16 v[60:63], a[124:127], v[216:219], 0
  ds_read_b128 a[108:111], v7 offset:1024
  v_sub_f32 v238, 0, v246
  v_mfma_f32_16x16x32_bf16 v[72:75], a[128:131], v[216:219], 0
  ds_read_b64_tr_b16 a[144:145], v8 offset:51200
  v_sub_f32 v239, 0, v246
  v_mfma_f32_16x16x32_bf16 v[84:87], a[132:135], v[216:219], 0
  ds_read_b64_tr_b16 a[146:147], v8 offset:52224
  v_sub_f32 v241, 0, v248
  v_mfma_f32_16x16x32_bf16 v[96:99], a[136:139], v[216:219], 0
  ds_read_b64_tr_b16 a[148:149], v9 offset:51200
  v_sub_f32 v242, 0, v248
  v_mfma_f32_16x16x32_bf16 v[108:111], a[140:143], v[216:219], 0
  s_add_u32 m0, s37, 32768
  ds_read_b64_tr_b16 a[150:151], v9 offset:52224
  v_sub_f32 v243, 0, v248
  v_mfma_f32_16x16x32_bf16 a[56:59], a[60:63], v[216:219], 0
  s_waitcnt lgkmcnt(3)
  ds_read_b64_tr_b16 a[152:153], v10 offset:51200
  v_add_f32 v184, v184, v232
  v_mfma_f32_16x16x32_bf16 v[160:163], a[80:83], v[112:115], v[232:235]
  buffer_load_dwordx4 v2, s[16:19], s38 offen offset:2048 nt lds
  v_mfma_f32_16x16x32_bf16 v[160:163], a[84:87], v[124:127], v[160:163]
  ds_read_b64_tr_b16 a[154:155], v10 offset:52224
  v_add_f32 v185, v185, v232
  v_mfma_f32_16x16x32_bf16 v[160:163], a[88:91], v[136:139], v[160:163]
  ds_read_b64_tr_b16 a[156:157], v11 offset:51200
  v_add_f32 v186, v186, v232
  v_mfma_f32_16x16x32_bf16 v[160:163], a[92:95], v[148:151], v[160:163]
  ds_read_b64_tr_b16 a[158:159], v11 offset:52224
  v_add_f32 v187, v187, v232
  v_mfma_f32_16x16x32_bf16 v[164:167], a[80:83], v[116:119], v[236:239]
  ds_read_b64_tr_b16 a[112:113], v12 offset:51200
  v_add_f32 v196, v196, v232
  v_mfma_f32_16x16x32_bf16 v[164:167], a[84:87], v[128:131], v[164:167]
  ds_read_b64_tr_b16 a[114:115], v12 offset:52224
  v_add_f32 v197, v197, v232
  v_mfma_f32_16x16x32_bf16 v[164:167], a[88:91], v[140:143], v[164:167]
  ds_read_b64_tr_b16 a[116:117], v13 offset:51200
  v_add_f32 v198, v198, v232
  v_mfma_f32_16x16x32_bf16 v[164:167], a[92:95], v[152:155], v[164:167]
  ds_read_b64_tr_b16 a[118:119], v13 offset:52224
  v_add_f32 v199, v199, v232
  v_mfma_f32_16x16x32_bf16 v[168:171], a[80:83], v[120:123], v[240:243]
  ds_read_b64_tr_b16 a[120:121], v14 offset:51200
  v_add_f32 v188, v188, v236
  v_mfma_f32_16x16x32_bf16 v[168:171], a[84:87], v[132:135], v[168:171]
  ds_read_b64_tr_b16 a[122:123], v14 offset:52224
  v_add_f32 v189, v189, v236
  v_mfma_f32_16x16x32_bf16 v[168:171], a[88:91], v[144:147], v[168:171]
  ds_read_b64_tr_b16 a[124:125], v15 offset:51200
  v_add_f32 v190, v190, v236
  v_mfma_f32_16x16x32_bf16 v[168:171], a[92:95], v[156:159], v[168:171]
  s_add_u32 m0, s37, 32768
  ds_read_b64_tr_b16 a[126:127], v15 offset:52224
  v_add_f32 v191, v191, v236
  v_mfma_f32_16x16x32_bf16 v[172:175], a[96:99], v[112:115], v[232:235]
  v_exp_f32 v184, v184
  v_mfma_f32_16x16x32_bf16 v[172:175], a[100:103], v[124:127], v[172:175]
  buffer_load_dwordx4 v2, s[16:19], s38 offen offset:3072 nt lds
  v_mfma_f32_16x16x32_bf16 v[172:175], a[104:107], v[136:139], v[172:175]
  v_exp_f32 v185, v185
  v_mfma_f32_16x16x32_bf16 v[172:175], a[108:111], v[148:151], v[172:175]
  v_exp_f32 v186, v186
  v_mfma_f32_16x16x32_bf16 v[176:179], a[96:99], v[116:119], v[236:239]
  v_exp_f32 v187, v187
  v_mfma_f32_16x16x32_bf16 v[176:179], a[100:103], v[128:131], v[176:179]
  v_exp_f32 v196, v196
  v_mfma_f32_16x16x32_bf16 v[176:179], a[104:107], v[140:143], v[176:179]
  v_exp_f32 v197, v197
  v_mfma_f32_16x16x32_bf16 v[176:179], a[108:111], v[152:155], v[176:179]
  v_exp_f32 v198, v198
  v_mfma_f32_16x16x32_bf16 v[180:183], a[96:99], v[120:123], v[240:243]
  v_exp_f32 v199, v199
  v_mfma_f32_16x16x32_bf16 v[180:183], a[100:103], v[132:135], v[180:183]
  v_cvt_pk_bf16_f32 v220, v184, v185
  v_cvt_pk_bf16_f32 v221, v186, v187
  v_mfma_f32_16x16x32_bf16 v[180:183], a[104:107], v[144:147], v[180:183]
  v_cvt_pk_bf16_f32 v222, v196, v197
  v_cvt_pk_bf16_f32 v223, v198, v199
  v_mfma_f32_16x16x32_bf16 v[180:183], a[108:111], v[156:159], v[180:183]
  s_waitcnt lgkmcnt(0)
  v_exp_f32 v188, v188
  v_mfma_f32_16x16x32_bf16 v[16:19], a[144:147], v[220:223], v[16:19]
  v_exp_f32 v189, v189
  v_mfma_f32_16x16x32_bf16 v[28:31], a[148:151], v[220:223], v[28:31]
  s_add_u32 m0, s37, 49152
  v_exp_f32 v190, v190
  v_mfma_f32_16x16x32_bf16 v[40:43], a[152:155], v[220:223], v[40:43]
  v_exp_f32 v191, v191
  v_mfma_f32_16x16x32_bf16 v[52:55], a[156:159], v[220:223], v[52:55]
  buffer_load_dwordx4 v3, s[20:23], s38 offen offset:0 nt lds
  v_mfma_f32_16x16x32_bf16 v[64:67], a[112:115], v[220:223], v[64:67]
  v_add_f32 v200, v200, v236
  v_add_f32 v201, v201, v236
  v_mfma_f32_16x16x32_bf16 v[76:79], a[116:119], v[220:223], v[76:79]
  v_exp_f32 v200, v200
  v_mfma_f32_16x16x32_bf16 v[88:91], a[120:123], v[220:223], v[88:91]
  v_exp_f32 v201, v201
  v_add_f32 v202, v202, v236
  v_exp_f32 v202, v202
  v_add_f32 v203, v203, v236
  v_exp_f32 v203, v203
  v_mfma_f32_16x16x32_bf16 v[100:103], a[124:127], v[220:223], v[100:103]
  v_cvt_pk_bf16_f32 v224, v188, v189
  v_cvt_pk_bf16_f32 v225, v190, v191
  v_cvt_pk_bf16_f32 v226, v200, v201
  v_cvt_pk_bf16_f32 v227, v202, v203
  v_mfma_f32_16x16x32_bf16 a[48:51], a[60:63], v[220:223], a[48:51]
  ds_read_b128 a[64:67], v4 offset:2048
  v_add_f32 v192, v192, v240
  v_mfma_f32_16x16x32_bf16 v[20:23], a[144:147], v[224:227], v[20:23]
  v_exp_f32 v192, v192
  v_mfma_f32_16x16x32_bf16 v[32:35], a[148:151], v[224:227], v[32:35]
  ds_read_b128 a[68:71], v5 offset:2048
  v_add_f32 v193, v193, v240
  v_mfma_f32_16x16x32_bf16 v[44:47], a[152:155], v[224:227], v[44:47]
  v_exp_f32 v193, v193
  v_mfma_f32_16x16x32_bf16 v[56:59], a[156:159], v[224:227], v[56:59]
  v_add_f32 v194, v194, v240
  v_add_f32 v195, v195, v240
  v_mfma_f32_16x16x32_bf16 v[68:71], a[112:115], v[224:227], v[68:71]
  v_exp_f32 v194, v194
  v_mfma_f32_16x16x32_bf16 v[80:83], a[116:119], v[224:227], v[80:83]
  s_add_u32 m0, s37, 49152
  v_exp_f32 v195, v195
  v_mfma_f32_16x16x32_bf16 v[92:95], a[120:123], v[224:227], v[92:95]
  v_add_f32 v204, v204, v240
  v_exp_f32 v204, v204
  v_add_f32 v205, v205, v240
  v_exp_f32 v205, v205
  v_add_f32 v206, v206, v240
  v_exp_f32 v206, v206
  v_add_f32 v207, v207, v240
  v_exp_f32 v207, v207
  v_mfma_f32_16x16x32_bf16 v[104:107], a[124:127], v[224:227], v[104:107]
  buffer_load_dwordx4 v3, s[20:23], s38 offen offset:1024 nt lds
  v_cvt_pk_bf16_f32 v228, v192, v193
  v_cvt_pk_bf16_f32 v229, v194, v195
  v_cvt_pk_bf16_f32 v230, v204, v205
  v_cvt_pk_bf16_f32 v231, v206, v207
  v_mfma_f32_16x16x32_bf16 a[52:55], a[60:63], v[224:227], a[52:55]
  ds_read_b128 a[72:75], v6 offset:2048
  ds_read_b128 a[76:79], v7 offset:2048
  v_mfma_f32_16x16x32_bf16 v[24:27], a[144:147], v[228:231], v[24:27]
  ds_read_b128 a[80:83], v4 offset:3072
  v_add_u32 v4, -114688, v4
  v_mfma_f32_16x16x32_bf16 v[36:39], a[148:151], v[228:231], v[36:39]
  ds_read_b128 a[84:87], v5 offset:3072
  v_add_u32 v5, -114688, v5
  v_mfma_f32_16x16x32_bf16 v[48:51], a[152:155], v[228:231], v[48:51]
  ds_read_b128 a[88:91], v6 offset:3072
  v_add_u32 v6, -114688, v6
  v_mfma_f32_16x16x32_bf16 v[60:63], a[156:159], v[228:231], v[60:63]
  ds_read_b128 a[92:95], v7 offset:3072
  v_add_u32 v7, -114688, v7
  v_mfma_f32_16x16x32_bf16 v[72:75], a[112:115], v[228:231], v[72:75]
  v_exp_f32 v160, v160
  v_mfma_f32_16x16x32_bf16 v[84:87], a[116:119], v[228:231], v[84:87]
  v_exp_f32 v161, v161
  v_mfma_f32_16x16x32_bf16 v[96:99], a[120:123], v[228:231], v[96:99]
  v_exp_f32 v162, v162
  v_mfma_f32_16x16x32_bf16 v[108:111], a[124:127], v[228:231], v[108:111]
  v_exp_f32 v163, v163
  v_mfma_f32_16x16x32_bf16 a[56:59], a[60:63], v[228:231], a[56:59]
  s_waitcnt lgkmcnt(1)
  v_exp_f32 v172, v172
  v_mfma_f32_16x16x32_bf16 v[184:187], a[64:67], v[112:115], v[232:235]
  s_add_u32 m0, s37, 49152
  v_exp_f32 v173, v173
  v_mfma_f32_16x16x32_bf16 v[184:187], a[68:71], v[124:127], v[184:187]
  v_exp_f32 v174, v174
  v_mfma_f32_16x16x32_bf16 v[184:187], a[72:75], v[136:139], v[184:187]
  buffer_load_dwordx4 v3, s[20:23], s38 offen offset:2048 nt lds
  v_mfma_f32_16x16x32_bf16 v[184:187], a[76:79], v[148:151], v[184:187]
  v_exp_f32 v175, v175
  v_mfma_f32_16x16x32_bf16 v[188:191], a[64:67], v[116:119], v[236:239]
  v_exp_f32 v164, v164
  v_mfma_f32_16x16x32_bf16 v[188:191], a[68:71], v[128:131], v[188:191]
  v_exp_f32 v165, v165
  v_mfma_f32_16x16x32_bf16 v[188:191], a[72:75], v[140:143], v[188:191]
  v_exp_f32 v166, v166
  v_mfma_f32_16x16x32_bf16 v[188:191], a[76:79], v[152:155], v[188:191]
  v_exp_f32 v167, v167
  v_mfma_f32_16x16x32_bf16 v[192:195], a[64:67], v[120:123], v[240:243]
  v_exp_f32 v176, v176
  v_mfma_f32_16x16x32_bf16 v[192:195], a[68:71], v[132:135], v[192:195]
  v_exp_f32 v177, v177
  v_mfma_f32_16x16x32_bf16 v[192:195], a[72:75], v[144:147], v[192:195]
  s_waitcnt vmcnt(12)
  s_barrier
  ds_read_b64_tr_b16 a[128:129], v8 offset:0
  v_mfma_f32_16x16x32_bf16 v[192:195], a[76:79], v[156:159], v[192:195]
  ds_read_b64_tr_b16 a[130:131], v8 offset:1024
  v_cvt_pk_bf16_f32 v208, v160, v161
  v_mfma_f32_16x16x32_bf16 v[196:199], a[80:83], v[112:115], v[232:235]
  ds_read_b64_tr_b16 a[132:133], v9 offset:0
  v_cvt_pk_bf16_f32 v209, v162, v163
  v_mfma_f32_16x16x32_bf16 v[196:199], a[84:87], v[124:127], v[196:199]
  s_add_u32 m0, s37, 49152
  ds_read_b64_tr_b16 a[134:135], v9 offset:1024
  v_cvt_pk_bf16_f32 v210, v172, v173
  v_mfma_f32_16x16x32_bf16 v[196:199], a[88:91], v[136:139], v[196:199]
  s_waitcnt lgkmcnt(4)
  s_add_u32 s8, s78, s59
  ds_read_b64_tr_b16 a[136:137], v10 offset:0
  v_cvt_pk_bf16_f32 v211, v174, v175
  v_mfma_f32_16x16x32_bf16 v[196:199], a[92:95], v[148:151], v[196:199]
  buffer_load_dwordx4 v3, s[20:23], s38 offen offset:3072 nt lds
  v_mfma_f32_16x16x32_bf16 v[200:203], a[80:83], v[116:119], v[236:239]
  s_addc_u32 s9, s79, 0
  ds_read_b64_tr_b16 a[138:139], v10 offset:1024
  v_cvt_pk_bf16_f32 v212, v164, v165
  v_mfma_f32_16x16x32_bf16 v[200:203], a[84:87], v[128:131], v[200:203]
  s_mov_b32 s10, 159744
  ds_read_b64_tr_b16 a[140:141], v11 offset:0
  v_cvt_pk_bf16_f32 v213, v166, v167
  v_mfma_f32_16x16x32_bf16 v[200:203], a[88:91], v[140:143], v[200:203]
  s_mov_b32 s11, 0x20000
  ds_read_b64_tr_b16 a[142:143], v11 offset:1024
  v_cvt_pk_bf16_f32 v214, v176, v177
  v_mfma_f32_16x16x32_bf16 v[200:203], a[92:95], v[152:155], v[200:203]
  v_exp_f32 v178, v178
  v_mfma_f32_16x16x32_bf16 v[204:207], a[80:83], v[120:123], v[240:243]
  v_exp_f32 v179, v179
  v_mfma_f32_16x16x32_bf16 v[204:207], a[84:87], v[132:135], v[204:207]
  v_cvt_pk_bf16_f32 v215, v178, v179
  v_lshlrev_b32 v244, 3, v1
  v_mfma_f32_16x16x32_bf16 v[204:207], a[88:91], v[144:147], v[204:207]
  v_exp_f32 v168, v168
  v_mfma_f32_16x16x32_bf16 v[204:207], a[92:95], v[156:159], v[204:207]
  v_exp_f32 v169, v169
  v_exp_f32 v170, v170
  v_exp_f32 v171, v171
  v_exp_f32 v180, v180
  v_exp_f32 v181, v181
  v_exp_f32 v182, v182
  v_exp_f32 v183, v183
  s_waitcnt lgkmcnt(0)
  v_mfma_f32_16x16x32_bf16 v[16:19], a[128:131], v[208:211], v[16:19]
  ds_read_b64_tr_b16 a[144:145], v12 offset:0
  ds_read_b64_tr_b16 a[146:147], v12 offset:1024
  v_cvt_pk_bf16_f32 v216, v168, v169
  v_cvt_pk_bf16_f32 v217, v170, v171
  v_cvt_pk_bf16_f32 v218, v180, v181
  v_cvt_pk_bf16_f32 v219, v182, v183
  v_mfma_f32_16x16x32_bf16 v[20:23], a[128:131], v[212:215], v[20:23]
  ds_read_b64_tr_b16 a[148:149], v13 offset:0
  v_and_b32 v246, 31, v0
  v_mfma_f32_16x16x32_bf16 v[24:27], a[128:131], v[216:219], v[24:27]
  s_add_u32 m0, s37, 65536
  ds_read_b64_tr_b16 a[150:151], v13 offset:1024
  v_lshlrev_b32 v246, 7, v246
  v_mfma_f32_16x16x32_bf16 v[28:31], a[132:135], v[208:211], v[28:31]
  s_add_u32 s38, s6, 65536
  ds_read_b64_tr_b16 a[152:153], v14 offset:0
  ds_read_b64_tr_b16 a[154:155], v14 offset:1024
  v_mfma_f32_16x16x32_bf16 v[32:35], a[132:135], v[212:215], v[32:35]
  s_and_b32 s38, s38, 0x1c000
  ds_read_b64_tr_b16 a[156:157], v15 offset:0
  v_mfma_f32_16x16x32_bf16 v[36:39], a[132:135], v[216:219], v[36:39]
  buffer_load_dwordx4 v2, s[16:19], s38 offen offset:0 nt lds
  v_mfma_f32_16x16x32_bf16 v[40:43], a[136:139], v[208:211], v[40:43]
  ds_read_b64_tr_b16 a[158:159], v15 offset:1024
  v_mfma_f32_16x16x32_bf16 v[44:47], a[136:139], v[212:215], v[44:47]
  s_add_u32 s12, s78, s60
  v_exp_f32 v184, v184
  v_mfma_f32_16x16x32_bf16 v[48:51], a[136:139], v[216:219], v[48:51]
  s_addc_u32 s13, s79, 0
  v_exp_f32 v185, v185
  v_mfma_f32_16x16x32_bf16 v[52:55], a[140:143], v[208:211], v[52:55]
  s_mov_b32 s14, 12288
  ds_read_b128 a[96:99], v4 offset:0
  v_cvt_pk_bf16_f32 v220, v184, v185
  v_mfma_f32_16x16x32_bf16 v[56:59], a[140:143], v[212:215], v[56:59]
  ds_read_b128 a[100:103], v5 offset:0
  v_mfma_f32_16x16x32_bf16 v[60:63], a[140:143], v[216:219], v[60:63]
  s_waitcnt lgkmcnt(2)
  ds_read_b128 a[104:107], v6 offset:0
  v_mfma_f32_16x16x32_bf16 v[64:67], a[144:147], v[208:211], v[64:67]
  ds_read_b128 a[108:111], v7 offset:0
  v_mfma_f32_16x16x32_bf16 v[68:71], a[144:147], v[212:215], v[68:71]
  s_mov_b32 s15, 0x20000
  v_exp_f32 v186, v186
  v_mfma_f32_16x16x32_bf16 v[72:75], a[144:147], v[216:219], v[72:75]
  v_exp_f32 v187, v187
  v_mfma_f32_16x16x32_bf16 v[76:79], a[148:151], v[208:211], v[76:79]
  s_add_u32 m0, s37, 65536
  ds_read_b128 a[64:67], v4 offset:1024
  v_cvt_pk_bf16_f32 v221, v186, v187
  v_mfma_f32_16x16x32_bf16 v[80:83], a[148:151], v[212:215], v[80:83]
  s_bfe_u32 s7, s2, 0x20003
  v_exp_f32 v196, v196
  v_mfma_f32_16x16x32_bf16 v[84:87], a[148:151], v[216:219], v[84:87]
  buffer_load_dwordx4 v2, s[16:19], s38 offen offset:1024 nt lds
  v_mfma_f32_16x16x32_bf16 v[88:91], a[152:155], v[208:211], v[88:91]
  s_add_u32 s7, s7, 0
  v_exp_f32 v197, v197
  v_mfma_f32_16x16x32_bf16 v[92:95], a[152:155], v[212:215], v[92:95]
  s_and_b32 s40, s7, 3
  ds_read_b128 a[68:71], v5 offset:1024
  v_cvt_pk_bf16_f32 v222, v196, v197
  v_mfma_f32_16x16x32_bf16 v[96:99], a[152:155], v[216:219], v[96:99]
  s_bfe_u32 s7, s2, 0x20003
  v_exp_f32 v198, v198
  v_mfma_f32_16x16x32_bf16 v[100:103], a[156:159], v[208:211], v[100:103]
  s_add_u32 s7, s7, 1
  v_exp_f32 v199, v199
  v_mfma_f32_16x16x32_bf16 v[104:107], a[156:159], v[212:215], v[104:107]
  s_and_b32 s41, s7, 3
  ds_read_b128 a[72:75], v6 offset:1024
  v_cvt_pk_bf16_f32 v223, v198, v199
  v_mfma_f32_16x16x32_bf16 v[108:111], a[156:159], v[216:219], v[108:111]
  v_exp_f32 v188, v188
  v_mfma_f32_16x16x32_bf16 a[48:51], a[60:63], v[208:211], a[48:51]
  ds_read_b128 a[76:79], v7 offset:1024
  v_mfma_f32_16x16x32_bf16 a[52:55], a[60:63], v[212:215], a[52:55]
  v_exp_f32 v189, v189
  v_mfma_f32_16x16x32_bf16 a[56:59], a[60:63], v[216:219], a[56:59]
  s_waitcnt lgkmcnt(2)
  ds_read_b64_tr_b16 a[112:113], v8 offset:2048
  v_cvt_pk_bf16_f32 v224, v188, v189
  v_mfma_f32_16x16x32_bf16 v[160:163], a[96:99], v[112:115], v[232:235]
  v_exp_f32 v190, v190
  v_mfma_f32_16x16x32_bf16 v[160:163], a[100:103], v[124:127], v[160:163]
  v_exp_f32 v191, v191
  v_mfma_f32_16x16x32_bf16 v[160:163], a[104:107], v[136:139], v[160:163]
  s_add_u32 m0, s37, 65536
  ds_read_b64_tr_b16 a[114:115], v8 offset:3072
  v_cvt_pk_bf16_f32 v225, v190, v191
  v_mfma_f32_16x16x32_bf16 v[160:163], a[108:111], v[148:151], v[160:163]
  s_bfe_u32 s7, s2, 0x20003
  ds_read_b64_tr_b16 a[116:117], v9 offset:2048
  v_add_u32 v8, -81920, v8
  v_mfma_f32_16x16x32_bf16 v[164:167], a[96:99], v[116:119], v[236:239]
  buffer_load_dwordx4 v2, s[16:19], s38 offen offset:2048 nt lds
  v_mfma_f32_16x16x32_bf16 v[164:167], a[100:103], v[128:131], v[164:167]
  s_add_u32 s7, s7, 2
  v_exp_f32 v200, v200
  v_mfma_f32_16x16x32_bf16 v[164:167], a[104:107], v[140:143], v[164:167]
  s_and_b32 s42, s7, 3
  v_exp_f32 v201, v201
  v_mfma_f32_16x16x32_bf16 v[164:167], a[108:111], v[152:155], v[164:167]
  s_bfe_u32 s7, s2, 0x20003
  ds_read_b64_tr_b16 a[118:119], v9 offset:3072
  v_cvt_pk_bf16_f32 v226, v200, v201
  v_mfma_f32_16x16x32_bf16 v[168:171], a[96:99], v[120:123], v[240:243]
  s_add_u32 s7, s7, 3
  ds_read_b64_tr_b16 a[120:121], v10 offset:2048
  v_add_u32 v9, -81920, v9
  v_mfma_f32_16x16x32_bf16 v[168:171], a[100:103], v[132:135], v[168:171]
  s_and_b32 s43, s7, 3
  v_exp_f32 v202, v202
  v_mfma_f32_16x16x32_bf16 v[168:171], a[104:107], v[144:147], v[168:171]
  v_exp_f32 v203, v203
  v_mfma_f32_16x16x32_bf16 v[168:171], a[108:111], v[156:159], v[168:171]
  ds_read_b64_tr_b16 a[122:123], v10 offset:3072
  v_cvt_pk_bf16_f32 v227, v202, v203
  v_mfma_f32_16x16x32_bf16 v[172:175], a[64:67], v[112:115], v[232:235]
  ds_read_b64_tr_b16 a[124:125], v11 offset:2048
  v_add_u32 v10, -81920, v10
  v_mfma_f32_16x16x32_bf16 v[172:175], a[68:71], v[124:127], v[172:175]
  s_waitcnt lgkmcnt(2)
  v_exp_f32 v192, v192
  v_mfma_f32_16x16x32_bf16 v[172:175], a[72:75], v[136:139], v[172:175]
  v_exp_f32 v193, v193
  v_mfma_f32_16x16x32_bf16 v[172:175], a[76:79], v[148:151], v[172:175]
  s_add_u32 m0, s37, 65536
  ds_read_b64_tr_b16 a[126:127], v11 offset:3072
  v_cvt_pk_bf16_f32 v228, v192, v193
  v_mfma_f32_16x16x32_bf16 v[176:179], a[64:67], v[116:119], v[236:239]
  v_exp_f32 v194, v194
  v_mfma_f32_16x16x32_bf16 v[176:179], a[68:71], v[128:131], v[176:179]
  buffer_load_dwordx4 v2, s[16:19], s38 offen offset:3072 nt lds
  v_mfma_f32_16x16x32_bf16 v[176:179], a[72:75], v[140:143], v[176:179]
  v_exp_f32 v195, v195
  v_mfma_f32_16x16x32_bf16 v[176:179], a[76:79], v[152:155], v[176:179]
  v_exp_f32 v204, v204
  v_mfma_f32_16x16x32_bf16 v[180:183], a[64:67], v[120:123], v[240:243]
  v_exp_f32 v205, v205
  v_mfma_f32_16x16x32_bf16 v[180:183], a[68:71], v[132:135], v[180:183]
  v_exp_f32 v206, v206
  v_mfma_f32_16x16x32_bf16 v[180:183], a[72:75], v[144:147], v[180:183]
  v_exp_f32 v207, v207
  v_mfma_f32_16x16x32_bf16 v[180:183], a[76:79], v[156:159], v[180:183]
  v_cvt_pk_bf16_f32 v229, v194, v195
  v_cvt_pk_bf16_f32 v230, v204, v205
  v_mfma_f32_16x16x32_bf16 v[16:19], a[112:115], v[220:223], v[16:19]
  ds_read_b64_tr_b16 a[128:129], v12 offset:2048
  ds_read_b64_tr_b16 a[130:131], v12 offset:3072
  v_cvt_pk_bf16_f32 v231, v206, v207
  v_mfma_f32_16x16x32_bf16 v[20:23], a[112:115], v[224:227], v[20:23]
  ds_read_b64_tr_b16 a[132:133], v13 offset:2048
  v_add_u32 v11, -81920, v11
  v_mfma_f32_16x16x32_bf16 v[24:27], a[112:115], v[228:231], v[24:27]
  ds_read_b64_tr_b16 a[134:135], v13 offset:3072
  v_add_u32 v12, -81920, v12
  v_mfma_f32_16x16x32_bf16 v[28:31], a[116:119], v[220:223], v[28:31]
  ds_read_b64_tr_b16 a[136:137], v14 offset:2048
  v_add_u32 v13, -81920, v13
  v_mfma_f32_16x16x32_bf16 v[32:35], a[116:119], v[224:227], v[32:35]
  s_add_u32 m0, s37, 81920
  ds_read_b64_tr_b16 a[138:139], v14 offset:3072
  v_add_u32 v14, -81920, v14
  v_mfma_f32_16x16x32_bf16 v[36:39], a[116:119], v[228:231], v[36:39]
  s_waitcnt lgkmcnt(3)
  ds_read_b64_tr_b16 a[140:141], v15 offset:2048
  v_mfma_f32_16x16x32_bf16 v[40:43], a[120:123], v[220:223], v[40:43]
  buffer_load_dwordx4 v3, s[20:23], s38 offen offset:0 nt lds
  v_mfma_f32_16x16x32_bf16 v[44:47], a[120:123], v[224:227], v[44:47]
  ds_read_b64_tr_b16 a[142:143], v15 offset:3072
  v_add_u32 v15, -81920, v15
  v_mfma_f32_16x16x32_bf16 v[48:51], a[120:123], v[228:231], v[48:51]
  v_exp_f32 v160, v160
  v_mfma_f32_16x16x32_bf16 v[52:55], a[124:127], v[220:223], v[52:55]
  ds_read_b128 a[80:83], v4 offset:2048
  v_mfma_f32_16x16x32_bf16 v[56:59], a[124:127], v[224:227], v[56:59]
  ds_read_b128 a[84:87], v5 offset:2048
  v_mfma_f32_16x16x32_bf16 v[60:63], a[124:127], v[228:231], v[60:63]
  ds_read_b128 a[88:91], v6 offset:2048
  v_mfma_f32_16x16x32_bf16 v[64:67], a[128:131], v[220:223], v[64:67]
  ds_read_b128 a[92:95], v7 offset:2048
  v_mfma_f32_16x16x32_bf16 v[68:71], a[128:131], v[224:227], v[68:71]
  v_exp_f32 v161, v161
  v_mfma_f32_16x16x32_bf16 v[72:75], a[128:131], v[228:231], v[72:75]
  s_waitcnt lgkmcnt(4)
  ds_read_b128 a[96:99], v4 offset:3072
  v_cvt_pk_bf16_f32 v208, v160, v161
  v_mfma_f32_16x16x32_bf16 v[76:79], a[132:135], v[220:223], v[76:79]
  v_exp_f32 v162, v162
  v_mfma_f32_16x16x32_bf16 v[80:83], a[132:135], v[224:227], v[80:83]
  v_exp_f32 v163, v163
  v_mfma_f32_16x16x32_bf16 v[84:87], a[132:135], v[228:231], v[84:87]
  s_add_u32 m0, s37, 81920
  ds_read_b128 a[100:103], v5 offset:3072
  v_cvt_pk_bf16_f32 v209, v162, v163
  v_mfma_f32_16x16x32_bf16 v[88:91], a[136:139], v[220:223], v[88:91]
  v_exp_f32 v172, v172
  v_mfma_f32_16x16x32_bf16 v[92:95], a[136:139], v[224:227], v[92:95]
  buffer_load_dwordx4 v3, s[20:23], s38 offen offset:1024 nt lds
  v_mfma_f32_16x16x32_bf16 v[96:99], a[136:139], v[228:231], v[96:99]
  v_exp_f32 v173, v173
  v_mfma_f32_16x16x32_bf16 v[100:103], a[140:143], v[220:223], v[100:103]
  ds_read_b128 a[104:107], v6 offset:3072
  v_cvt_pk_bf16_f32 v210, v172, v173
  v_mfma_f32_16x16x32_bf16 v[104:107], a[140:143], v[224:227], v[104:107]
  v_exp_f32 v174, v174
  v_mfma_f32_16x16x32_bf16 v[108:111], a[140:143], v[228:231], v[108:111]
  v_exp_f32 v175, v175
  v_mfma_f32_16x16x32_bf16 a[48:51], a[60:63], v[220:223], a[48:51]
  ds_read_b128 a[108:111], v7 offset:3072
  v_cvt_pk_bf16_f32 v211, v174, v175
  v_mfma_f32_16x16x32_bf16 a[52:55], a[60:63], v[224:227], a[52:55]
  v_exp_f32 v164, v164
  v_mfma_f32_16x16x32_bf16 a[56:59], a[60:63], v[228:231], a[56:59]
  s_waitcnt lgkmcnt(2)
  v_exp_f32 v165, v165
  v_mfma_f32_16x16x32_bf16 v[184:187], a[80:83], v[112:115], v[232:235]
  v_exp_f32 v166, v166
  v_mfma_f32_16x16x32_bf16 v[184:187], a[84:87], v[124:127], v[184:187]
  v_exp_f32 v167, v167
  v_mfma_f32_16x16x32_bf16 v[184:187], a[88:91], v[136:139], v[184:187]
  v_exp_f32 v176, v176
  v_mfma_f32_16x16x32_bf16 v[184:187], a[92:95], v[148:151], v[184:187]
  s_add_u32 m0, s37, 81920
  v_exp_f32 v177, v177
  v_mfma_f32_16x16x32_bf16 v[188:191], a[80:83], v[116:119], v[236:239]
  v_exp_f32 v178, v178
  v_mfma_f32_16x16x32_bf16 v[188:191], a[84:87], v[128:131], v[188:191]
  buffer_load_dwordx4 v3, s[20:23], s38 offen offset:2048 nt lds
  v_mfma_f32_16x16x32_bf16 v[188:191], a[88:91], v[140:143], v[188:191]
  v_exp_f32 v179, v179
  v_mfma_f32_16x16x32_bf16 v[188:191], a[92:95], v[152:155], v[188:191]
  v_exp_f32 v168, v168
  v_mfma_f32_16x16x32_bf16 v[192:195], a[80:83], v[120:123], v[240:243]
  v_exp_f32 v169, v169
  v_mfma_f32_16x16x32_bf16 v[192:195], a[84:87], v[132:135], v[192:195]
  v_exp_f32 v170, v170
  v_mfma_f32_16x16x32_bf16 v[192:195], a[88:91], v[144:147], v[192:195]
  s_waitcnt vmcnt(11)
  s_barrier
  ds_read_b64_tr_b16 a[144:145], v8 offset:0
  v_mfma_f32_16x16x32_bf16 v[192:195], a[92:95], v[156:159], v[192:195]
  ds_read_b64_tr_b16 a[146:147], v8 offset:1024
  v_cvt_pk_bf16_f32 v212, v164, v165
  v_mfma_f32_16x16x32_bf16 v[196:199], a[96:99], v[112:115], v[232:235]
  ds_read_b64_tr_b16 a[148:149], v9 offset:0
  v_cvt_pk_bf16_f32 v213, v166, v167
  v_mfma_f32_16x16x32_bf16 v[196:199], a[100:103], v[124:127], v[196:199]
  s_waitcnt lgkmcnt(3)
  ds_read_b64_tr_b16 a[150:151], v9 offset:1024
  v_cvt_pk_bf16_f32 v214, v176, v177
  v_mfma_f32_16x16x32_bf16 v[196:199], a[104:107], v[136:139], v[196:199]
  ds_read_b64_tr_b16 a[152:153], v10 offset:0
  v_cvt_pk_bf16_f32 v215, v178, v179
  v_mfma_f32_16x16x32_bf16 v[196:199], a[108:111], v[148:151], v[196:199]
  ds_read_b64_tr_b16 a[154:155], v10 offset:1024
  v_cvt_pk_bf16_f32 v216, v168, v169
  v_mfma_f32_16x16x32_bf16 v[200:203], a[96:99], v[116:119], v[236:239]
  s_add_u32 m0, s37, 81920
  ds_read_b64_tr_b16 a[156:157], v11 offset:0
  v_mfma_f32_16x16x32_bf16 v[200:203], a[100:103], v[128:131], v[200:203]
  ds_read_b64_tr_b16 a[158:159], v11 offset:1024
  v_mfma_f32_16x16x32_bf16 v[200:203], a[104:107], v[140:143], v[200:203]
  buffer_load_dwordx4 v3, s[20:23], s38 offen offset:3072 nt lds
  v_mfma_f32_16x16x32_bf16 v[200:203], a[108:111], v[152:155], v[200:203]
  v_exp_f32 v171, v171
  v_mfma_f32_16x16x32_bf16 v[204:207], a[96:99], v[120:123], v[240:243]
  v_exp_f32 v180, v180
  v_mfma_f32_16x16x32_bf16 v[204:207], a[100:103], v[132:135], v[204:207]
  v_exp_f32 v181, v181
  v_mfma_f32_16x16x32_bf16 v[204:207], a[104:107], v[144:147], v[204:207]
  v_exp_f32 v182, v182
  v_mfma_f32_16x16x32_bf16 v[204:207], a[108:111], v[156:159], v[204:207]
  s_waitcnt lgkmcnt(1)
  v_exp_f32 v183, v183
  v_mfma_f32_16x16x32_bf16 v[16:19], a[144:147], v[208:211], v[16:19]
  ds_read_b64_tr_b16 a[112:113], v12 offset:0
  ds_read_b64_tr_b16 a[114:115], v12 offset:1024
  v_cvt_pk_bf16_f32 v217, v170, v171
  v_cvt_pk_bf16_f32 v218, v180, v181
  v_cvt_pk_bf16_f32 v219, v182, v183
  v_mfma_f32_16x16x32_bf16 v[20:23], a[144:147], v[212:215], v[20:23]
  ds_read_b64_tr_b16 a[116:117], v13 offset:0
  ds_read_b64_tr_b16 a[118:119], v13 offset:1024
  v_mfma_f32_16x16x32_bf16 v[24:27], a[144:147], v[216:219], v[24:27]
  ds_read_b64_tr_b16 a[120:121], v14 offset:0
  v_mfma_f32_16x16x32_bf16 v[28:31], a[148:151], v[208:211], v[28:31]
  ds_read_b64_tr_b16 a[122:123], v14 offset:1024
  v_mfma_f32_16x16x32_bf16 v[32:35], a[148:151], v[212:215], v[32:35]
  ds_read_b64_tr_b16 a[124:125], v15 offset:0
  v_mfma_f32_16x16x32_bf16 v[36:39], a[148:151], v[216:219], v[36:39]
  ds_read_b64_tr_b16 a[126:127], v15 offset:1024
  v_mfma_f32_16x16x32_bf16 v[40:43], a[152:155], v[208:211], v[40:43]
  s_add_u32 m0, s37, 131072
  v_exp_f32 v184, v184
  v_mfma_f32_16x16x32_bf16 v[44:47], a[152:155], v[212:215], v[44:47]
  s_add_u32 s38, s6, 81920
  v_exp_f32 v185, v185
  v_mfma_f32_16x16x32_bf16 v[48:51], a[152:155], v[216:219], v[48:51]
  s_waitcnt lgkmcnt(3)
  s_and_b32 s38, s38, 0x1c000
  ds_read_b128 a[64:67], v4 offset:32768
  v_cvt_pk_bf16_f32 v220, v184, v185
  v_mfma_f32_16x16x32_bf16 v[52:55], a[156:159], v[208:211], v[52:55]
  buffer_load_dwordx4 v2, s[16:19], s38 offen offset:0 nt lds
  v_mfma_f32_16x16x32_bf16 v[56:59], a[156:159], v[212:215], v[56:59]
  ds_read_b128 a[68:71], v5 offset:32768
  v_mfma_f32_16x16x32_bf16 v[60:63], a[156:159], v[216:219], v[60:63]
  ds_read_b128 a[72:75], v6 offset:32768
  v_mfma_f32_16x16x32_bf16 v[64:67], a[112:115], v[208:211], v[64:67]
  ds_read_b128 a[76:79], v7 offset:32768
  v_mfma_f32_16x16x32_bf16 v[68:71], a[112:115], v[212:215], v[68:71]
  v_exp_f32 v186, v186
  v_mfma_f32_16x16x32_bf16 v[72:75], a[112:115], v[216:219], v[72:75]
  v_exp_f32 v187, v187
  v_mfma_f32_16x16x32_bf16 v[76:79], a[116:119], v[208:211], v[76:79]
  ds_read_b128 a[80:83], v4 offset:33792
  v_cvt_pk_bf16_f32 v221, v186, v187
  v_mfma_f32_16x16x32_bf16 v[80:83], a[116:119], v[212:215], v[80:83]
  v_exp_f32 v196, v196
  v_mfma_f32_16x16x32_bf16 v[84:87], a[116:119], v[216:219], v[84:87]
  s_waitcnt lgkmcnt(2)
  v_exp_f32 v197, v197
  v_mfma_f32_16x16x32_bf16 v[88:91], a[120:123], v[208:211], v[88:91]
  ds_read_b128 a[84:87], v5 offset:33792
  v_cvt_pk_bf16_f32 v222, v196, v197
  v_mfma_f32_16x16x32_bf16 v[92:95], a[120:123], v[212:215], v[92:95]
  s_add_u32 m0, s37, 131072
  v_exp_f32 v198, v198
  v_mfma_f32_16x16x32_bf16 v[96:99], a[120:123], v[216:219], v[96:99]
  v_exp_f32 v199, v199
  v_mfma_f32_16x16x32_bf16 v[100:103], a[124:127], v[208:211], v[100:103]
  buffer_load_dwordx4 v2, s[16:19], s38 offen offset:1024 nt lds
  v_mfma_f32_16x16x32_bf16 v[104:107], a[124:127], v[212:215], v[104:107]
  ds_read_b128 a[88:91], v6 offset:33792
  v_cvt_pk_bf16_f32 v223, v198, v199
  v_mfma_f32_16x16x32_bf16 v[108:111], a[124:127], v[216:219], v[108:111]
  v_exp_f32 v188, v188
  v_mfma_f32_16x16x32_bf16 a[48:51], a[60:63], v[208:211], a[48:51]
  ds_read_b128 a[92:95], v7 offset:33792
  v_mfma_f32_16x16x32_bf16 a[52:55], a[60:63], v[212:215], a[52:55]
  v_exp_f32 v189, v189
  v_mfma_f32_16x16x32_bf16 a[56:59], a[60:63], v[216:219], a[56:59]
  ds_read_b64_tr_b16 a[128:129], v8 offset:2048
  v_cvt_pk_bf16_f32 v224, v188, v189
  v_mfma_f32_16x16x32_bf16 v[160:163], a[64:67], v[112:115], v[232:235]
  v_exp_f32 v190, v190
  v_mfma_f32_16x16x32_bf16 v[160:163], a[68:71], v[124:127], v[160:163]
  v_exp_f32 v191, v191
  v_mfma_f32_16x16x32_bf16 v[160:163], a[72:75], v[136:139], v[160:163]
  s_waitcnt lgkmcnt(2)
  ds_read_b64_tr_b16 a[130:131], v8 offset:3072
  v_cvt_pk_bf16_f32 v225, v190, v191
  v_mfma_f32_16x16x32_bf16 v[160:163], a[76:79], v[148:151], v[160:163]
  v_exp_f32 v200, v200
  v_mfma_f32_16x16x32_bf16 v[164:167], a[64:67], v[116:119], v[236:239]
  v_exp_f32 v201, v201
  v_mfma_f32_16x16x32_bf16 v[164:167], a[68:71], v[128:131], v[164:167]
  s_add_u32 m0, s37, 131072
  ds_read_b64_tr_b16 a[132:133], v9 offset:2048
  v_cvt_pk_bf16_f32 v226, v200, v201
  v_mfma_f32_16x16x32_bf16 v[164:167], a[72:75], v[140:143], v[164:167]
  v_exp_f32 v202, v202
  v_mfma_f32_16x16x32_bf16 v[164:167], a[76:79], v[152:155], v[164:167]
  buffer_load_dwordx4 v2, s[16:19], s38 offen offset:2048 nt lds
  v_mfma_f32_16x16x32_bf16 v[168:171], a[64:67], v[120:123], v[240:243]
  v_exp_f32 v203, v203
  v_mfma_f32_16x16x32_bf16 v[168:171], a[68:71], v[132:135], v[168:171]
  ds_read_b64_tr_b16 a[134:135], v9 offset:3072
  v_cvt_pk_bf16_f32 v227, v202, v203
  v_mfma_f32_16x16x32_bf16 v[168:171], a[72:75], v[144:147], v[168:171]
  v_exp_f32 v192, v192
  v_mfma_f32_16x16x32_bf16 v[168:171], a[76:79], v[156:159], v[168:171]
  v_exp_f32 v193, v193
  v_mfma_f32_16x16x32_bf16 v[172:175], a[80:83], v[112:115], v[232:235]
  ds_read_b64_tr_b16 a[136:137], v10 offset:2048
  v_cvt_pk_bf16_f32 v228, v192, v193
  v_mfma_f32_16x16x32_bf16 v[172:175], a[84:87], v[124:127], v[172:175]
  ds_read_b64_tr_b16 a[138:139], v10 offset:3072
  v_mfma_f32_16x16x32_bf16 v[172:175], a[88:91], v[136:139], v[172:175]
  s_waitcnt lgkmcnt(3)
  v_exp_f32 v194, v194
  v_mfma_f32_16x16x32_bf16 v[172:175], a[92:95], v[148:151], v[172:175]
  ds_read_b64_tr_b16 a[140:141], v11 offset:2048
  v_mfma_f32_16x16x32_bf16 v[176:179], a[80:83], v[116:119], v[236:239]
  ds_read_b64_tr_b16 a[142:143], v11 offset:3072
  v_mfma_f32_16x16x32_bf16 v[176:179], a[84:87], v[128:131], v[176:179]
  v_exp_f32 v195, v195
  v_mfma_f32_16x16x32_bf16 v[176:179], a[88:91], v[140:143], v[176:179]
  s_add_u32 m0, s37, 131072
  v_exp_f32 v204, v204
  v_mfma_f32_16x16x32_bf16 v[176:179], a[92:95], v[152:155], v[176:179]
  v_exp_f32 v205, v205
  v_mfma_f32_16x16x32_bf16 v[180:183], a[80:83], v[120:123], v[240:243]
  buffer_load_dwordx4 v2, s[16:19], s38 offen offset:3072 nt lds
  v_mfma_f32_16x16x32_bf16 v[180:183], a[84:87], v[132:135], v[180:183]
  v_exp_f32 v206, v206
  v_mfma_f32_16x16x32_bf16 v[180:183], a[88:91], v[144:147], v[180:183]
  v_exp_f32 v207, v207
  v_mfma_f32_16x16x32_bf16 v[180:183], a[92:95], v[156:159], v[180:183]
  v_cvt_pk_bf16_f32 v229, v194, v195
  v_cvt_pk_bf16_f32 v230, v204, v205
  v_mfma_f32_16x16x32_bf16 v[16:19], a[128:131], v[220:223], v[16:19]
  ds_read_b64_tr_b16 a[144:145], v12 offset:2048
  ds_read_b64_tr_b16 a[146:147], v12 offset:3072
  v_cvt_pk_bf16_f32 v231, v206, v207
  v_mfma_f32_16x16x32_bf16 v[20:23], a[128:131], v[224:227], v[20:23]
  ds_read_b64_tr_b16 a[148:149], v13 offset:2048
  ds_read_b64_tr_b16 a[150:151], v13 offset:3072
  v_mfma_f32_16x16x32_bf16 v[24:27], a[128:131], v[228:231], v[24:27]
  s_waitcnt lgkmcnt(4)
  ds_read_b64_tr_b16 a[152:153], v14 offset:2048
  v_mfma_f32_16x16x32_bf16 v[28:31], a[132:135], v[220:223], v[28:31]
  ds_read_b64_tr_b16 a[154:155], v14 offset:3072
  v_mfma_f32_16x16x32_bf16 v[32:35], a[132:135], v[224:227], v[32:35]
  ds_read_b64_tr_b16 a[156:157], v15 offset:2048
  v_mfma_f32_16x16x32_bf16 v[36:39], a[132:135], v[228:231], v[36:39]
  ds_read_b64_tr_b16 a[158:159], v15 offset:3072
  v_mfma_f32_16x16x32_bf16 v[40:43], a[136:139], v[220:223], v[40:43]
  v_exp_f32 v160, v160
  v_mfma_f32_16x16x32_bf16 v[44:47], a[136:139], v[224:227], v[44:47]
  s_add_u32 m0, s37, 147456
  v_exp_f32 v161, v161
  v_mfma_f32_16x16x32_bf16 v[48:51], a[136:139], v[228:231], v[48:51]
  ds_read_b128 a[96:99], v4 offset:34816
  v_cvt_pk_bf16_f32 v208, v160, v161
  v_mfma_f32_16x16x32_bf16 v[52:55], a[140:143], v[220:223], v[52:55]
  buffer_load_dwordx4 v3, s[20:23], s38 offen offset:0 nt lds
  v_mfma_f32_16x16x32_bf16 v[56:59], a[140:143], v[224:227], v[56:59]
  ds_read_b128 a[100:103], v5 offset:34816
  v_mfma_f32_16x16x32_bf16 v[60:63], a[140:143], v[228:231], v[60:63]
  s_waitcnt lgkmcnt(2)
  ds_read_b128 a[104:107], v6 offset:34816
  v_mfma_f32_16x16x32_bf16 v[64:67], a[144:147], v[220:223], v[64:67]
  ds_read_b128 a[108:111], v7 offset:34816
  v_mfma_f32_16x16x32_bf16 v[68:71], a[144:147], v[224:227], v[68:71]
  v_exp_f32 v162, v162
  v_mfma_f32_16x16x32_bf16 v[72:75], a[144:147], v[228:231], v[72:75]
  v_exp_f32 v163, v163
  v_mfma_f32_16x16x32_bf16 v[76:79], a[148:151], v[220:223], v[76:79]
  ds_read_b128 a[64:67], v4 offset:35840
  v_cvt_pk_bf16_f32 v209, v162, v163
  v_mfma_f32_16x16x32_bf16 v[80:83], a[148:151], v[224:227], v[80:83]
  ds_read_b128 a[68:71], v5 offset:35840
  v_add_u32 v4, 65536, v4
  v_mfma_f32_16x16x32_bf16 v[84:87], a[148:151], v[228:231], v[84:87]
  ds_read_b128 a[72:75], v6 offset:35840
  v_add_u32 v5, 65536, v5
  v_mfma_f32_16x16x32_bf16 v[88:91], a[152:155], v[220:223], v[88:91]
  ds_read_b128 a[76:79], v7 offset:35840
  v_add_u32 v6, 65536, v6
  v_mfma_f32_16x16x32_bf16 v[92:95], a[152:155], v[224:227], v[92:95]
  v_exp_f32 v172, v172
  v_mfma_f32_16x16x32_bf16 v[96:99], a[152:155], v[228:231], v[96:99]
  s_add_u32 m0, s37, 147456
  v_exp_f32 v173, v173
  v_mfma_f32_16x16x32_bf16 v[100:103], a[156:159], v[220:223], v[100:103]
  v_exp_f32 v174, v174
  v_mfma_f32_16x16x32_bf16 v[104:107], a[156:159], v[224:227], v[104:107]
  buffer_load_dwordx4 v3, s[20:23], s38 offen offset:1024 nt lds
  v_mfma_f32_16x16x32_bf16 v[108:111], a[156:159], v[228:231], v[108:111]
  v_exp_f32 v175, v175
  v_mfma_f32_16x16x32_bf16 a[48:51], a[60:63], v[220:223], a[48:51]
  v_exp_f32 v164, v164
  v_mfma_f32_16x16x32_bf16 a[52:55], a[60:63], v[224:227], a[52:55]
  v_exp_f32 v165, v165
  v_mfma_f32_16x16x32_bf16 a[56:59], a[60:63], v[228:231], a[56:59]
  s_waitcnt lgkmcnt(0)
  v_exp_f32 v166, v166
  v_mfma_f32_16x16x32_bf16 v[184:187], a[96:99], v[112:115], v[232:235]
  v_exp_f32 v167, v167
  v_mfma_f32_16x16x32_bf16 v[184:187], a[100:103], v[124:127], v[184:187]
  v_exp_f32 v176, v176
  v_mfma_f32_16x16x32_bf16 v[184:187], a[104:107], v[136:139], v[184:187]
  v_exp_f32 v177, v177
  v_mfma_f32_16x16x32_bf16 v[184:187], a[108:111], v[148:151], v[184:187]
  v_exp_f32 v178, v178
  v_mfma_f32_16x16x32_bf16 v[188:191], a[96:99], v[116:119], v[236:239]
  v_exp_f32 v179, v179
  v_mfma_f32_16x16x32_bf16 v[188:191], a[100:103], v[128:131], v[188:191]
  v_exp_f32 v168, v168
  v_mfma_f32_16x16x32_bf16 v[188:191], a[104:107], v[140:143], v[188:191]
  v_exp_f32 v169, v169
  v_mfma_f32_16x16x32_bf16 v[188:191], a[108:111], v[152:155], v[188:191]
  s_add_u32 m0, s37, 147456
  v_exp_f32 v170, v170
  v_mfma_f32_16x16x32_bf16 v[192:195], a[96:99], v[120:123], v[240:243]
  v_exp_f32 v171, v171
  v_mfma_f32_16x16x32_bf16 v[192:195], a[100:103], v[132:135], v[192:195]
  buffer_load_dwordx4 v3, s[20:23], s38 offen offset:2048 nt lds
  v_mfma_f32_16x16x32_bf16 v[192:195], a[104:107], v[144:147], v[192:195]
  s_waitcnt vmcnt(11)
  s_barrier
  ds_read_b64_tr_b16 a[112:113], v8 offset:32768
  v_mfma_f32_16x16x32_bf16 v[192:195], a[108:111], v[156:159], v[192:195]
  ds_read_b64_tr_b16 a[114:115], v8 offset:33792
  v_cvt_pk_bf16_f32 v210, v172, v173
  v_mfma_f32_16x16x32_bf16 v[196:199], a[64:67], v[112:115], v[232:235]
  ds_read_b64_tr_b16 a[116:117], v9 offset:32768
  v_cvt_pk_bf16_f32 v211, v174, v175
  v_mfma_f32_16x16x32_bf16 v[196:199], a[68:71], v[124:127], v[196:199]
  ds_read_b64_tr_b16 a[118:119], v9 offset:33792
  v_cvt_pk_bf16_f32 v212, v164, v165
  v_mfma_f32_16x16x32_bf16 v[196:199], a[72:75], v[136:139], v[196:199]
  ds_read_b64_tr_b16 a[120:121], v10 offset:32768
  v_cvt_pk_bf16_f32 v213, v166, v167
  v_mfma_f32_16x16x32_bf16 v[196:199], a[76:79], v[148:151], v[196:199]
  ds_read_b64_tr_b16 a[122:123], v10 offset:33792
  v_cvt_pk_bf16_f32 v214, v176, v177
  v_mfma_f32_16x16x32_bf16 v[200:203], a[64:67], v[116:119], v[236:239]
  ds_read_b64_tr_b16 a[124:125], v11 offset:32768
  v_cvt_pk_bf16_f32 v215, v178, v179
  v_mfma_f32_16x16x32_bf16 v[200:203], a[68:71], v[128:131], v[200:203]
  ds_read_b64_tr_b16 a[126:127], v11 offset:33792
  v_cvt_pk_bf16_f32 v216, v168, v169
  v_mfma_f32_16x16x32_bf16 v[200:203], a[72:75], v[140:143], v[200:203]
  v_exp_f32 v180, v180
  v_mfma_f32_16x16x32_bf16 v[200:203], a[76:79], v[152:155], v[200:203]
  v_exp_f32 v181, v181
  v_mfma_f32_16x16x32_bf16 v[204:207], a[64:67], v[120:123], v[240:243]
  s_add_u32 m0, s37, 147456
  v_exp_f32 v182, v182
  v_mfma_f32_16x16x32_bf16 v[204:207], a[68:71], v[132:135], v[204:207]
  v_exp_f32 v183, v183
  v_mfma_f32_16x16x32_bf16 v[204:207], a[72:75], v[144:147], v[204:207]
  buffer_load_dwordx4 v3, s[20:23], s38 offen offset:3072 nt lds
  v_mfma_f32_16x16x32_bf16 v[204:207], a[76:79], v[156:159], v[204:207]
  s_waitcnt lgkmcnt(0)
  v_cvt_pk_bf16_f32 v217, v170, v171
  v_cvt_pk_bf16_f32 v218, v180, v181
  v_mfma_f32_16x16x32_bf16 v[16:19], a[112:115], v[208:211], v[16:19]
  ds_read_b64_tr_b16 a[128:129], v12 offset:32768
  ds_read_b64_tr_b16 a[130:131], v12 offset:33792
  v_cvt_pk_bf16_f32 v219, v182, v183
  v_mfma_f32_16x16x32_bf16 v[20:23], a[112:115], v[212:215], v[20:23]
  ds_read_b64_tr_b16 a[132:133], v13 offset:32768
  v_add_u32 v7, 65536, v7
  v_mfma_f32_16x16x32_bf16 v[24:27], a[112:115], v[216:219], v[24:27]
  ds_read_b64_tr_b16 a[134:135], v13 offset:33792
  v_mfma_f32_16x16x32_bf16 v[28:31], a[116:119], v[208:211], v[28:31]
  ds_read_b64_tr_b16 a[136:137], v14 offset:32768
  ds_read_b64_tr_b16 a[138:139], v14 offset:33792
  v_mfma_f32_16x16x32_bf16 v[32:35], a[116:119], v[212:215], v[32:35]
  ds_read_b64_tr_b16 a[140:141], v15 offset:32768
  v_mfma_f32_16x16x32_bf16 v[36:39], a[116:119], v[216:219], v[36:39]
  ds_read_b64_tr_b16 a[142:143], v15 offset:33792
  v_mfma_f32_16x16x32_bf16 v[40:43], a[120:123], v[208:211], v[40:43]
  v_exp_f32 v184, v184
  v_mfma_f32_16x16x32_bf16 v[44:47], a[120:123], v[212:215], v[44:47]
  v_exp_f32 v185, v185
  v_mfma_f32_16x16x32_bf16 v[48:51], a[120:123], v[216:219], v[48:51]
  ds_read_b128 a[80:83], v4 offset:0
  v_cvt_pk_bf16_f32 v220, v184, v185
  v_mfma_f32_16x16x32_bf16 v[52:55], a[124:127], v[208:211], v[52:55]
  s_add_u32 m0, s37, 114688
  v_exp_f32 v186, v186
  v_mfma_f32_16x16x32_bf16 v[56:59], a[124:127], v[212:215], v[56:59]
  s_add_u32 s38, s6, 98304
  ds_read_b128 a[84:87], v5 offset:0
  v_mfma_f32_16x16x32_bf16 v[60:63], a[124:127], v[216:219], v[60:63]
  s_waitcnt lgkmcnt(2)
  s_and_b32 s38, s38, 0x1c000
  ds_read_b128 a[88:91], v6 offset:0
  v_mfma_f32_16x16x32_bf16 v[64:67], a[128:131], v[208:211], v[64:67]
  buffer_load_dwordx4 v2, s[16:19], s38 offen offset:0 nt lds
  v_mfma_f32_16x16x32_bf16 v[68:71], a[128:131], v[212:215], v[68:71]
  ds_read_b128 a[92:95], v7 offset:0
  v_mfma_f32_16x16x32_bf16 v[72:75], a[128:131], v[216:219], v[72:75]
  v_exp_f32 v187, v187
  v_mfma_f32_16x16x32_bf16 v[76:79], a[132:135], v[208:211], v[76:79]
  ds_read_b128 a[96:99], v4 offset:1024
  v_cvt_pk_bf16_f32 v221, v186, v187
  v_mfma_f32_16x16x32_bf16 v[80:83], a[132:135], v[212:215], v[80:83]
  v_exp_f32 v196, v196
  v_mfma_f32_16x16x32_bf16 v[84:87], a[132:135], v[216:219], v[84:87]
  v_exp_f32 v197, v197
  v_mfma_f32_16x16x32_bf16 v[88:91], a[136:139], v[208:211], v[88:91]
  ds_read_b128 a[100:103], v5 offset:1024
  v_cvt_pk_bf16_f32 v222, v196, v197
  v_mfma_f32_16x16x32_bf16 v[92:95], a[136:139], v[212:215], v[92:95]
  v_exp_f32 v198, v198
  v_mfma_f32_16x16x32_bf16 v[96:99], a[136:139], v[216:219], v[96:99]
  v_exp_f32 v199, v199
  v_mfma_f32_16x16x32_bf16 v[100:103], a[140:143], v[208:211], v[100:103]
  ds_read_b128 a[104:107], v6 offset:1024
  v_cvt_pk_bf16_f32 v223, v198, v199
  v_mfma_f32_16x16x32_bf16 v[104:107], a[140:143], v[212:215], v[104:107]
  s_add_u32 m0, s37, 114688
  v_exp_f32 v188, v188
  v_mfma_f32_16x16x32_bf16 v[108:111], a[140:143], v[216:219], v[108:111]
  v_exp_f32 v189, v189
  v_mfma_f32_16x16x32_bf16 a[48:51], a[60:63], v[208:211], a[48:51]
  buffer_load_dwordx4 v2, s[16:19], s38 offen offset:1024 nt lds
  v_mfma_f32_16x16x32_bf16 a[52:55], a[60:63], v[212:215], a[52:55]
  ds_read_b128 a[108:111], v7 offset:1024
  v_cvt_pk_bf16_f32 v224, v188, v189
  v_mfma_f32_16x16x32_bf16 a[56:59], a[60:63], v[216:219], a[56:59]
  s_waitcnt lgkmcnt(1)
  v_exp_f32 v190, v190
  v_mfma_f32_16x16x32_bf16 v[160:163], a[80:83], v[112:115], v[232:235]
  v_exp_f32 v191, v191
  v_mfma_f32_16x16x32_bf16 v[160:163], a[84:87], v[124:127], v[160:163]
  ds_read_b64_tr_b16 a[144:145], v8 offset:34816
  v_cvt_pk_bf16_f32 v225, v190, v191
  v_mfma_f32_16x16x32_bf16 v[160:163], a[88:91], v[136:139], v[160:163]
  v_exp_f32 v200, v200
  v_mfma_f32_16x16x32_bf16 v[160:163], a[92:95], v[148:151], v[160:163]
  v_exp_f32 v201, v201
  v_mfma_f32_16x16x32_bf16 v[164:167], a[80:83], v[116:119], v[236:239]
  ds_read_b64_tr_b16 a[146:147], v8 offset:35840
  v_cvt_pk_bf16_f32 v226, v200, v201
  v_mfma_f32_16x16x32_bf16 v[164:167], a[84:87], v[128:131], v[164:167]
  ds_read_b64_tr_b16 a[148:149], v9 offset:34816
  v_add_u32 v8, 65536, v8
  v_mfma_f32_16x16x32_bf16 v[164:167], a[88:91], v[140:143], v[164:167]
  v_exp_f32 v202, v202
  v_mfma_f32_16x16x32_bf16 v[164:167], a[92:95], v[152:155], v[164:167]
  v_exp_f32 v203, v203
  v_mfma_f32_16x16x32_bf16 v[168:171], a[80:83], v[120:123], v[240:243]
  s_add_u32 m0, s37, 114688
  ds_read_b64_tr_b16 a[150:151], v9 offset:35840
  v_cvt_pk_bf16_f32 v227, v202, v203
  v_mfma_f32_16x16x32_bf16 v[168:171], a[84:87], v[132:135], v[168:171]
  ds_read_b64_tr_b16 a[152:153], v10 offset:34816
  v_add_u32 v9, 65536, v9
  v_mfma_f32_16x16x32_bf16 v[168:171], a[88:91], v[144:147], v[168:171]
  buffer_load_dwordx4 v2, s[16:19], s38 offen offset:2048 nt lds
  v_mfma_f32_16x16x32_bf16 v[168:171], a[92:95], v[156:159], v[168:171]
  v_exp_f32 v192, v192
  v_mfma_f32_16x16x32_bf16 v[172:175], a[96:99], v[112:115], v[232:235]
  ds_read_b64_tr_b16 a[154:155], v10 offset:35840
  v_add_u32 v10, 65536, v10
  v_mfma_f32_16x16x32_bf16 v[172:175], a[100:103], v[124:127], v[172:175]
  v_exp_f32 v193, v193
  v_mfma_f32_16x16x32_bf16 v[172:175], a[104:107], v[136:139], v[172:175]
  s_waitcnt lgkmcnt(2)
  ds_read_b64_tr_b16 a[156:157], v11 offset:34816
  v_cvt_pk_bf16_f32 v228, v192, v193
  v_mfma_f32_16x16x32_bf16 v[172:175], a[108:111], v[148:151], v[172:175]
  ds_read_b64_tr_b16 a[158:159], v11 offset:35840
  v_add_u32 v11, 65536, v11
  v_mfma_f32_16x16x32_bf16 v[176:179], a[96:99], v[116:119], v[236:239]
  v_exp_f32 v194, v194
  v_mfma_f32_16x16x32_bf16 v[176:179], a[100:103], v[128:131], v[176:179]
  v_exp_f32 v195, v195
  v_mfma_f32_16x16x32_bf16 v[176:179], a[104:107], v[140:143], v[176:179]
  v_exp_f32 v204, v204
  v_mfma_f32_16x16x32_bf16 v[176:179], a[108:111], v[152:155], v[176:179]
  v_exp_f32 v205, v205
  v_mfma_f32_16x16x32_bf16 v[180:183], a[96:99], v[120:123], v[240:243]
  v_exp_f32 v206, v206
  v_mfma_f32_16x16x32_bf16 v[180:183], a[100:103], v[132:135], v[180:183]
  s_add_u32 m0, s37, 114688
  v_exp_f32 v207, v207
  v_mfma_f32_16x16x32_bf16 v[180:183], a[104:107], v[144:147], v[180:183]
  v_cvt_pk_bf16_f32 v229, v194, v195
  v_cvt_pk_bf16_f32 v230, v204, v205
  v_mfma_f32_16x16x32_bf16 v[180:183], a[108:111], v[156:159], v[180:183]
  buffer_load_dwordx4 v2, s[16:19], s38 offen offset:3072 nt lds
  v_mfma_f32_16x16x32_bf16 v[16:19], a[144:147], v[220:223], v[16:19]
  ds_read_b64_tr_b16 a[112:113], v12 offset:34816
  ds_read_b64_tr_b16 a[114:115], v12 offset:35840
  v_cvt_pk_bf16_f32 v231, v206, v207
  v_mfma_f32_16x16x32_bf16 v[20:23], a[144:147], v[224:227], v[20:23]
  ds_read_b64_tr_b16 a[116:117], v13 offset:34816
  v_add_u32 v12, 65536, v12
  v_mfma_f32_16x16x32_bf16 v[24:27], a[144:147], v[228:231], v[24:27]
  ds_read_b64_tr_b16 a[118:119], v13 offset:35840
  v_add_u32 v13, 65536, v13
  v_mfma_f32_16x16x32_bf16 v[28:31], a[148:151], v[220:223], v[28:31]
  ds_read_b64_tr_b16 a[120:121], v14 offset:34816
  ds_read_b64_tr_b16 a[122:123], v14 offset:35840
  v_mfma_f32_16x16x32_bf16 v[32:35], a[148:151], v[224:227], v[32:35]
  ds_read_b64_tr_b16 a[124:125], v15 offset:34816
  v_add_u32 v14, 65536, v14
  v_mfma_f32_16x16x32_bf16 v[36:39], a[148:151], v[228:231], v[36:39]
  s_waitcnt lgkmcnt(5)
  ds_read_b64_tr_b16 a[126:127], v15 offset:35840
  v_add_u32 v15, 65536, v15
  v_mfma_f32_16x16x32_bf16 v[40:43], a[152:155], v[220:223], v[40:43]
  v_exp_f32 v160, v160
  v_mfma_f32_16x16x32_bf16 v[44:47], a[152:155], v[224:227], v[44:47]
  v_exp_f32 v161, v161
  v_mfma_f32_16x16x32_bf16 v[48:51], a[152:155], v[228:231], v[48:51]
  ds_read_b128 a[64:67], v4 offset:2048
  v_cvt_pk_bf16_f32 v208, v160, v161
  v_mfma_f32_16x16x32_bf16 v[52:55], a[156:159], v[220:223], v[52:55]
  v_exp_f32 v162, v162
  v_mfma_f32_16x16x32_bf16 v[56:59], a[156:159], v[224:227], v[56:59]
  ds_read_b128 a[68:71], v5 offset:2048
  v_mfma_f32_16x16x32_bf16 v[60:63], a[156:159], v[228:231], v[60:63]
  s_add_u32 m0, s37, 98304
  ds_read_b128 a[72:75], v6 offset:2048
  v_mfma_f32_16x16x32_bf16 v[64:67], a[112:115], v[220:223], v[64:67]
  ds_read_b128 a[76:79], v7 offset:2048
  v_mfma_f32_16x16x32_bf16 v[68:71], a[112:115], v[224:227], v[68:71]
  buffer_load_dwordx4 v3, s[20:23], s38 offen offset:0 nt lds
  v_mfma_f32_16x16x32_bf16 v[72:75], a[112:115], v[228:231], v[72:75]
  s_waitcnt lgkmcnt(3)
  v_exp_f32 v163, v163
  v_mfma_f32_16x16x32_bf16 v[76:79], a[116:119], v[220:223], v[76:79]
  ds_read_b128 a[80:83], v4 offset:3072
  v_cvt_pk_bf16_f32 v209, v162, v163
  v_mfma_f32_16x16x32_bf16 v[80:83], a[116:119], v[224:227], v[80:83]
  ds_read_b128 a[84:87], v5 offset:3072
  v_add_u32 v4, 49152, v4
  v_mfma_f32_16x16x32_bf16 v[84:87], a[116:119], v[228:231], v[84:87]
  ds_read_b128 a[88:91], v6 offset:3072
  v_add_u32 v5, 49152, v5
  v_mfma_f32_16x16x32_bf16 v[88:91], a[120:123], v[220:223], v[88:91]
  ds_read_b128 a[92:95], v7 offset:3072
  v_add_u32 v6, 49152, v6
  v_mfma_f32_16x16x32_bf16 v[92:95], a[120:123], v[224:227], v[92:95]
  v_exp_f32 v172, v172
  v_mfma_f32_16x16x32_bf16 v[96:99], a[120:123], v[228:231], v[96:99]
  v_exp_f32 v173, v173
  v_mfma_f32_16x16x32_bf16 v[100:103], a[124:127], v[220:223], v[100:103]
  v_exp_f32 v174, v174
  v_mfma_f32_16x16x32_bf16 v[104:107], a[124:127], v[224:227], v[104:107]
  v_exp_f32 v175, v175
  v_mfma_f32_16x16x32_bf16 v[108:111], a[124:127], v[228:231], v[108:111]
  v_exp_f32 v164, v164
  v_mfma_f32_16x16x32_bf16 a[48:51], a[60:63], v[220:223], a[48:51]
  s_add_u32 m0, s37, 98304
  v_exp_f32 v165, v165
  v_mfma_f32_16x16x32_bf16 a[52:55], a[60:63], v[224:227], a[52:55]
  v_exp_f32 v166, v166
  v_mfma_f32_16x16x32_bf16 a[56:59], a[60:63], v[228:231], a[56:59]
  buffer_load_dwordx4 v3, s[20:23], s38 offen offset:1024 nt lds
  v_mfma_f32_16x16x32_bf16 v[184:187], a[64:67], v[112:115], v[232:235]
  s_waitcnt lgkmcnt(0)
  v_exp_f32 v167, v167
  v_mfma_f32_16x16x32_bf16 v[184:187], a[68:71], v[124:127], v[184:187]
  v_exp_f32 v176, v176
  v_mfma_f32_16x16x32_bf16 v[184:187], a[72:75], v[136:139], v[184:187]
  v_exp_f32 v177, v177
  v_mfma_f32_16x16x32_bf16 v[184:187], a[76:79], v[148:151], v[184:187]
  v_exp_f32 v178, v178
  v_mfma_f32_16x16x32_bf16 v[188:191], a[64:67], v[116:119], v[236:239]
  v_exp_f32 v179, v179
  v_mfma_f32_16x16x32_bf16 v[188:191], a[68:71], v[128:131], v[188:191]
  v_exp_f32 v168, v168
  v_mfma_f32_16x16x32_bf16 v[188:191], a[72:75], v[140:143], v[188:191]
  v_exp_f32 v169, v169
  v_mfma_f32_16x16x32_bf16 v[188:191], a[76:79], v[152:155], v[188:191]
  v_exp_f32 v170, v170
  v_mfma_f32_16x16x32_bf16 v[192:195], a[64:67], v[120:123], v[240:243]
  v_exp_f32 v171, v171
  v_mfma_f32_16x16x32_bf16 v[192:195], a[68:71], v[132:135], v[192:195]
  v_exp_f32 v180, v180
  v_mfma_f32_16x16x32_bf16 v[192:195], a[72:75], v[144:147], v[192:195]
  s_add_u32 m0, s37, 98304
  s_waitcnt vmcnt(10)
  s_barrier
  ds_read_b64_tr_b16 a[128:129], v8 offset:0
  v_mfma_f32_16x16x32_bf16 v[192:195], a[76:79], v[156:159], v[192:195]
  ds_read_b64_tr_b16 a[130:131], v8 offset:1024
  v_cvt_pk_bf16_f32 v210, v172, v173
  v_mfma_f32_16x16x32_bf16 v[196:199], a[80:83], v[112:115], v[232:235]
  buffer_load_dwordx4 v3, s[20:23], s38 offen offset:2048 nt lds
  v_mfma_f32_16x16x32_bf16 v[196:199], a[84:87], v[124:127], v[196:199]
  ds_read_b64_tr_b16 a[132:133], v9 offset:0
  v_cvt_pk_bf16_f32 v211, v174, v175
  v_mfma_f32_16x16x32_bf16 v[196:199], a[88:91], v[136:139], v[196:199]
  ds_read_b64_tr_b16 a[134:135], v9 offset:1024
  v_cvt_pk_bf16_f32 v212, v164, v165
  v_mfma_f32_16x16x32_bf16 v[196:199], a[92:95], v[148:151], v[196:199]
  ds_read_b64_tr_b16 a[136:137], v10 offset:0
  v_cvt_pk_bf16_f32 v213, v166, v167
  v_mfma_f32_16x16x32_bf16 v[200:203], a[80:83], v[116:119], v[236:239]
  ds_read_b64_tr_b16 a[138:139], v10 offset:1024
  v_cvt_pk_bf16_f32 v214, v176, v177
  v_mfma_f32_16x16x32_bf16 v[200:203], a[84:87], v[128:131], v[200:203]
  ds_read_b64_tr_b16 a[140:141], v11 offset:0
  v_cvt_pk_bf16_f32 v215, v178, v179
  v_mfma_f32_16x16x32_bf16 v[200:203], a[88:91], v[140:143], v[200:203]
  ds_read_b64_tr_b16 a[142:143], v11 offset:1024
  v_cvt_pk_bf16_f32 v216, v168, v169
  v_mfma_f32_16x16x32_bf16 v[200:203], a[92:95], v[152:155], v[200:203]
  v_exp_f32 v181, v181
  v_mfma_f32_16x16x32_bf16 v[204:207], a[80:83], v[120:123], v[240:243]
  v_exp_f32 v182, v182
  v_mfma_f32_16x16x32_bf16 v[204:207], a[84:87], v[132:135], v[204:207]
  v_exp_f32 v183, v183
  v_mfma_f32_16x16x32_bf16 v[204:207], a[88:91], v[144:147], v[204:207]
  v_cvt_pk_bf16_f32 v217, v170, v171
  v_cvt_pk_bf16_f32 v218, v180, v181
  v_mfma_f32_16x16x32_bf16 v[204:207], a[92:95], v[156:159], v[204:207]
  s_waitcnt lgkmcnt(1)
  s_add_u32 m0, s37, 98304
  v_cvt_pk_bf16_f32 v219, v182, v183
  v_add_u32 v7, 49152, v7
  v_mfma_f32_16x16x32_bf16 v[16:19], a[128:131], v[208:211], v[16:19]
  ds_read_b64_tr_b16 a[144:145], v12 offset:0
  ds_read_b64_tr_b16 a[146:147], v12 offset:1024
  v_mfma_f32_16x16x32_bf16 v[20:23], a[128:131], v[212:215], v[20:23]
  buffer_load_dwordx4 v3, s[20:23], s38 offen offset:3072 nt lds
  v_mfma_f32_16x16x32_bf16 v[24:27], a[128:131], v[216:219], v[24:27]
  ds_read_b64_tr_b16 a[148:149], v13 offset:0
  ds_read_b64_tr_b16 a[150:151], v13 offset:1024
  v_mfma_f32_16x16x32_bf16 v[28:31], a[132:135], v[208:211], v[28:31]
  ds_read_b64_tr_b16 a[152:153], v14 offset:0
  ds_read_b64_tr_b16 a[154:155], v14 offset:1024
  v_mfma_f32_16x16x32_bf16 v[32:35], a[132:135], v[212:215], v[32:35]
  ds_read_b64_tr_b16 a[156:157], v15 offset:0
  v_mfma_f32_16x16x32_bf16 v[36:39], a[132:135], v[216:219], v[36:39]
  ds_read_b64_tr_b16 a[158:159], v15 offset:1024
  v_mfma_f32_16x16x32_bf16 v[40:43], a[136:139], v[208:211], v[40:43]
  v_exp_f32 v184, v184
  v_mfma_f32_16x16x32_bf16 v[44:47], a[136:139], v[212:215], v[44:47]
  v_exp_f32 v185, v185
  v_mfma_f32_16x16x32_bf16 v[48:51], a[136:139], v[216:219], v[48:51]
  s_waitcnt lgkmcnt(4)
  ds_read_b128 a[96:99], v4 offset:16384
  v_cvt_pk_bf16_f32 v220, v184, v185
  v_mfma_f32_16x16x32_bf16 v[52:55], a[140:143], v[208:211], v[52:55]
  v_exp_f32 v186, v186
  v_mfma_f32_16x16x32_bf16 v[56:59], a[140:143], v[212:215], v[56:59]
  ds_read_b128 a[100:103], v5 offset:16384
  v_mfma_f32_16x16x32_bf16 v[60:63], a[140:143], v[216:219], v[60:63]
  ds_read_b128 a[104:107], v6 offset:16384
  v_mfma_f32_16x16x32_bf16 v[64:67], a[144:147], v[208:211], v[64:67]
  s_add_u32 m0, s37, 0
  ds_read_b128 a[108:111], v7 offset:16384
  v_mfma_f32_16x16x32_bf16 v[68:71], a[144:147], v[212:215], v[68:71]
  s_add_u32 s38, s6, 114688
  v_exp_f32 v187, v187
  v_mfma_f32_16x16x32_bf16 v[72:75], a[144:147], v[216:219], v[72:75]
  s_and_b32 s38, s38, 0x1c000
  ds_read_b128 a[64:67], v4 offset:17408
  v_cvt_pk_bf16_f32 v221, v186, v187
  v_mfma_f32_16x16x32_bf16 v[76:79], a[148:151], v[208:211], v[76:79]
  buffer_load_dwordx4 v2, s[16:19], s38 offen offset:0 nt lds
  v_mfma_f32_16x16x32_bf16 v[80:83], a[148:151], v[212:215], v[80:83]
  v_exp_f32 v196, v196
  v_mfma_f32_16x16x32_bf16 v[84:87], a[148:151], v[216:219], v[84:87]
  s_waitcnt lgkmcnt(1)
  v_exp_f32 v197, v197
  v_mfma_f32_16x16x32_bf16 v[88:91], a[152:155], v[208:211], v[88:91]
  ds_read_b128 a[68:71], v5 offset:17408
  v_cvt_pk_bf16_f32 v222, v196, v197
  v_mfma_f32_16x16x32_bf16 v[92:95], a[152:155], v[212:215], v[92:95]
  v_exp_f32 v198, v198
  v_mfma_f32_16x16x32_bf16 v[96:99], a[152:155], v[216:219], v[96:99]
  v_exp_f32 v199, v199
  v_mfma_f32_16x16x32_bf16 v[100:103], a[156:159], v[208:211], v[100:103]
  ds_read_b128 a[72:75], v6 offset:17408
  v_cvt_pk_bf16_f32 v223, v198, v199
  v_mfma_f32_16x16x32_bf16 v[104:107], a[156:159], v[212:215], v[104:107]
  v_exp_f32 v188, v188
  v_mfma_f32_16x16x32_bf16 v[108:111], a[156:159], v[216:219], v[108:111]
  v_exp_f32 v189, v189
  v_mfma_f32_16x16x32_bf16 a[48:51], a[60:63], v[208:211], a[48:51]
  ds_read_b128 a[76:79], v7 offset:17408
  v_cvt_pk_bf16_f32 v224, v188, v189
  v_mfma_f32_16x16x32_bf16 a[52:55], a[60:63], v[212:215], a[52:55]
  s_add_u32 m0, s37, 0
  v_exp_f32 v190, v190
  v_mfma_f32_16x16x32_bf16 a[56:59], a[60:63], v[216:219], a[56:59]
  v_exp_f32 v191, v191
  v_mfma_f32_16x16x32_bf16 v[160:163], a[96:99], v[112:115], v[232:235]
  buffer_load_dwordx4 v2, s[16:19], s38 offen offset:1024 nt lds
  v_mfma_f32_16x16x32_bf16 v[160:163], a[100:103], v[124:127], v[160:163]
  ds_read_b64_tr_b16 a[112:113], v8 offset:2048
  v_cvt_pk_bf16_f32 v225, v190, v191
  v_mfma_f32_16x16x32_bf16 v[160:163], a[104:107], v[136:139], v[160:163]
  v_exp_f32 v200, v200
  v_mfma_f32_16x16x32_bf16 v[160:163], a[108:111], v[148:151], v[160:163]
  v_exp_f32 v201, v201
  v_mfma_f32_16x16x32_bf16 v[164:167], a[96:99], v[116:119], v[236:239]
  ds_read_b64_tr_b16 a[114:115], v8 offset:3072
  v_cvt_pk_bf16_f32 v226, v200, v201
  v_mfma_f32_16x16x32_bf16 v[164:167], a[100:103], v[128:131], v[164:167]
  ds_read_b64_tr_b16 a[116:117], v9 offset:2048
  v_add_u32 v8, 16384, v8
  v_mfma_f32_16x16x32_bf16 v[164:167], a[104:107], v[140:143], v[164:167]
  v_exp_f32 v202, v202
  v_mfma_f32_16x16x32_bf16 v[164:167], a[108:111], v[152:155], v[164:167]
  v_exp_f32 v203, v203
  v_mfma_f32_16x16x32_bf16 v[168:171], a[96:99], v[120:123], v[240:243]
  ds_read_b64_tr_b16 a[118:119], v9 offset:3072
  v_cvt_pk_bf16_f32 v227, v202, v203
  v_mfma_f32_16x16x32_bf16 v[168:171], a[100:103], v[132:135], v[168:171]
  ds_read_b64_tr_b16 a[120:121], v10 offset:2048
  v_add_u32 v9, 16384, v9
  v_mfma_f32_16x16x32_bf16 v[168:171], a[104:107], v[144:147], v[168:171]
  v_exp_f32 v192, v192
  v_mfma_f32_16x16x32_bf16 v[168:171], a[108:111], v[156:159], v[168:171]
  s_waitcnt lgkmcnt(2)
  v_exp_f32 v193, v193
  v_mfma_f32_16x16x32_bf16 v[172:175], a[64:67], v[112:115], v[232:235]
  s_add_u32 m0, s37, 0
  ds_read_b64_tr_b16 a[122:123], v10 offset:3072
  v_cvt_pk_bf16_f32 v228, v192, v193
  v_mfma_f32_16x16x32_bf16 v[172:175], a[68:71], v[124:127], v[172:175]
  ds_read_b64_tr_b16 a[124:125], v11 offset:2048
  v_add_u32 v10, 16384, v10
  v_mfma_f32_16x16x32_bf16 v[172:175], a[72:75], v[136:139], v[172:175]
  buffer_load_dwordx4 v2, s[16:19], s38 offen offset:2048 nt lds
  v_mfma_f32_16x16x32_bf16 v[172:175], a[76:79], v[148:151], v[172:175]
  ds_read_b64_tr_b16 a[126:127], v11 offset:3072
  v_add_u32 v11, 16384, v11
  v_mfma_f32_16x16x32_bf16 v[176:179], a[64:67], v[116:119], v[236:239]
  v_exp_f32 v194, v194
  v_mfma_f32_16x16x32_bf16 v[176:179], a[68:71], v[128:131], v[176:179]
  v_exp_f32 v195, v195
  v_mfma_f32_16x16x32_bf16 v[176:179], a[72:75], v[140:143], v[176:179]
  v_exp_f32 v204, v204
  v_mfma_f32_16x16x32_bf16 v[176:179], a[76:79], v[152:155], v[176:179]
  v_exp_f32 v205, v205
  v_mfma_f32_16x16x32_bf16 v[180:183], a[64:67], v[120:123], v[240:243]
  v_exp_f32 v206, v206
  v_mfma_f32_16x16x32_bf16 v[180:183], a[68:71], v[132:135], v[180:183]
  v_exp_f32 v207, v207
  v_mfma_f32_16x16x32_bf16 v[180:183], a[72:75], v[144:147], v[180:183]
  v_cvt_pk_bf16_f32 v229, v194, v195
  v_cvt_pk_bf16_f32 v230, v204, v205
  v_mfma_f32_16x16x32_bf16 v[180:183], a[76:79], v[156:159], v[180:183]
  v_cvt_pk_bf16_f32 v231, v206, v207
  v_mfma_f32_16x16x32_bf16 v[16:19], a[112:115], v[220:223], v[16:19]
  ds_read_b64_tr_b16 a[128:129], v12 offset:2048
  ds_read_b64_tr_b16 a[130:131], v12 offset:3072
  v_mfma_f32_16x16x32_bf16 v[20:23], a[112:115], v[224:227], v[20:23]
  s_add_u32 m0, s37, 0
  ds_read_b64_tr_b16 a[132:133], v13 offset:2048
  v_add_u32 v12, 16384, v12
  v_mfma_f32_16x16x32_bf16 v[24:27], a[112:115], v[228:231], v[24:27]
  s_waitcnt lgkmcnt(3)
  ds_read_b64_tr_b16 a[134:135], v13 offset:3072
  v_add_u32 v13, 16384, v13
  v_mfma_f32_16x16x32_bf16 v[28:31], a[116:119], v[220:223], v[28:31]
  buffer_load_dwordx4 v2, s[16:19], s38 offen offset:3072 nt lds
  v_mfma_f32_16x16x32_bf16 v[32:35], a[116:119], v[224:227], v[32:35]
  ds_read_b64_tr_b16 a[136:137], v14 offset:2048
  ds_read_b64_tr_b16 a[138:139], v14 offset:3072
  v_mfma_f32_16x16x32_bf16 v[36:39], a[116:119], v[228:231], v[36:39]
  ds_read_b64_tr_b16 a[140:141], v15 offset:2048
  v_add_u32 v14, 16384, v14
  v_mfma_f32_16x16x32_bf16 v[40:43], a[120:123], v[220:223], v[40:43]
  ds_read_b64_tr_b16 a[142:143], v15 offset:3072
  v_add_u32 v15, 16384, v15
  v_mfma_f32_16x16x32_bf16 v[44:47], a[120:123], v[224:227], v[44:47]
  v_exp_f32 v160, v160
  v_mfma_f32_16x16x32_bf16 v[48:51], a[120:123], v[228:231], v[48:51]
  v_exp_f32 v161, v161
  v_mfma_f32_16x16x32_bf16 v[52:55], a[124:127], v[220:223], v[52:55]
  ds_read_b128 a[80:83], v4 offset:18432
  v_cvt_pk_bf16_f32 v208, v160, v161
  v_mfma_f32_16x16x32_bf16 v[56:59], a[124:127], v[224:227], v[56:59]
  ds_read_b128 a[84:87], v5 offset:18432
  v_mfma_f32_16x16x32_bf16 v[60:63], a[124:127], v[228:231], v[60:63]
  s_waitcnt lgkmcnt(3)
  ds_read_b128 a[88:91], v6 offset:18432
  v_mfma_f32_16x16x32_bf16 v[64:67], a[128:131], v[220:223], v[64:67]
  ds_read_b128 a[92:95], v7 offset:18432
  v_mfma_f32_16x16x32_bf16 v[68:71], a[128:131], v[224:227], v[68:71]
  v_exp_f32 v162, v162
  v_mfma_f32_16x16x32_bf16 v[72:75], a[128:131], v[228:231], v[72:75]
  s_add_u32 m0, s37, 16384
  v_exp_f32 v163, v163
  v_mfma_f32_16x16x32_bf16 v[76:79], a[132:135], v[220:223], v[76:79]
  ds_read_b128 a[96:99], v4 offset:19456
  v_cvt_pk_bf16_f32 v209, v162, v163
  v_mfma_f32_16x16x32_bf16 v[80:83], a[132:135], v[224:227], v[80:83]
  buffer_load_dwordx4 v3, s[20:23], s38 offen offset:0 nt lds
  v_mfma_f32_16x16x32_bf16 v[84:87], a[132:135], v[228:231], v[84:87]
  v_exp_f32 v172, v172
  v_mfma_f32_16x16x32_bf16 v[88:91], a[136:139], v[220:223], v[88:91]
  v_exp_f32 v173, v173
  v_mfma_f32_16x16x32_bf16 v[92:95], a[136:139], v[224:227], v[92:95]
  ds_read_b128 a[100:103], v5 offset:19456
  v_cvt_pk_bf16_f32 v210, v172, v173
  v_mfma_f32_16x16x32_bf16 v[96:99], a[136:139], v[228:231], v[96:99]
  s_waitcnt lgkmcnt(2)
  v_exp_f32 v174, v174
  v_mfma_f32_16x16x32_bf16 v[100:103], a[140:143], v[220:223], v[100:103]
  v_exp_f32 v175, v175
  v_mfma_f32_16x16x32_bf16 v[104:107], a[140:143], v[224:227], v[104:107]
  ds_read_b128 a[104:107], v6 offset:19456
  v_cvt_pk_bf16_f32 v211, v174, v175
  v_mfma_f32_16x16x32_bf16 v[108:111], a[140:143], v[228:231], v[108:111]
  v_exp_f32 v164, v164
  v_mfma_f32_16x16x32_bf16 a[48:51], a[60:63], v[220:223], a[48:51]
  ds_read_b128 a[108:111], v7 offset:19456
  v_mfma_f32_16x16x32_bf16 a[52:55], a[60:63], v[224:227], a[52:55]
  v_exp_f32 v165, v165
  v_mfma_f32_16x16x32_bf16 a[56:59], a[60:63], v[228:231], a[56:59]
  v_exp_f32 v166, v166
  v_mfma_f32_16x16x32_bf16 v[184:187], a[80:83], v[112:115], v[232:235]
  s_add_u32 m0, s37, 16384
  v_exp_f32 v167, v167
  v_mfma_f32_16x16x32_bf16 v[184:187], a[84:87], v[124:127], v[184:187]
  v_exp_f32 v176, v176
  v_mfma_f32_16x16x32_bf16 v[184:187], a[88:91], v[136:139], v[184:187]
  buffer_load_dwordx4 v3, s[20:23], s38 offen offset:1024 nt lds
  v_mfma_f32_16x16x32_bf16 v[184:187], a[92:95], v[148:151], v[184:187]
  v_exp_f32 v177, v177
  v_mfma_f32_16x16x32_bf16 v[188:191], a[80:83], v[116:119], v[236:239]
  v_exp_f32 v178, v178
  v_mfma_f32_16x16x32_bf16 v[188:191], a[84:87], v[128:131], v[188:191]
  v_exp_f32 v179, v179
  v_mfma_f32_16x16x32_bf16 v[188:191], a[88:91], v[140:143], v[188:191]
  v_exp_f32 v168, v168
  v_mfma_f32_16x16x32_bf16 v[188:191], a[92:95], v[152:155], v[188:191]
  v_exp_f32 v169, v169
  v_mfma_f32_16x16x32_bf16 v[192:195], a[80:83], v[120:123], v[240:243]
  v_exp_f32 v170, v170
  v_mfma_f32_16x16x32_bf16 v[192:195], a[84:87], v[132:135], v[192:195]
  v_exp_f32 v171, v171
  v_mfma_f32_16x16x32_bf16 v[192:195], a[88:91], v[144:147], v[192:195]
  s_waitcnt vmcnt(10)
  s_barrier
  ds_read_b64_tr_b16 a[144:145], v8 offset:49152
  v_mfma_f32_16x16x32_bf16 v[192:195], a[92:95], v[156:159], v[192:195]
  s_waitcnt lgkmcnt(1)
  ds_read_b64_tr_b16 a[146:147], v8 offset:50176
  v_cvt_pk_bf16_f32 v212, v164, v165
  v_mfma_f32_16x16x32_bf16 v[196:199], a[96:99], v[112:115], v[232:235]
  ds_read_b64_tr_b16 a[148:149], v9 offset:49152
  v_cvt_pk_bf16_f32 v213, v166, v167
  v_mfma_f32_16x16x32_bf16 v[196:199], a[100:103], v[124:127], v[196:199]
  s_add_u32 m0, s37, 16384
  ds_read_b64_tr_b16 a[150:151], v9 offset:50176
  v_cvt_pk_bf16_f32 v214, v176, v177
  v_mfma_f32_16x16x32_bf16 v[196:199], a[104:107], v[136:139], v[196:199]
  ds_read_b64_tr_b16 a[152:153], v10 offset:49152
  v_cvt_pk_bf16_f32 v215, v178, v179
  v_mfma_f32_16x16x32_bf16 v[196:199], a[108:111], v[148:151], v[196:199]
  buffer_load_dwordx4 v3, s[20:23], s38 offen offset:2048 nt lds
  v_mfma_f32_16x16x32_bf16 v[200:203], a[96:99], v[116:119], v[236:239]
  ds_read_b64_tr_b16 a[154:155], v10 offset:50176
  v_cvt_pk_bf16_f32 v216, v168, v169
  v_mfma_f32_16x16x32_bf16 v[200:203], a[100:103], v[128:131], v[200:203]
  ds_read_b64_tr_b16 a[156:157], v11 offset:49152
  v_cvt_pk_bf16_f32 v217, v170, v171
  v_mfma_f32_16x16x32_bf16 v[200:203], a[104:107], v[140:143], v[200:203]
  ds_read_b64_tr_b16 a[158:159], v11 offset:50176
  v_mfma_f32_16x16x32_bf16 v[200:203], a[108:111], v[152:155], v[200:203]
  v_exp_f32 v180, v180
  v_mfma_f32_16x16x32_bf16 v[204:207], a[96:99], v[120:123], v[240:243]
  v_exp_f32 v181, v181
  v_mfma_f32_16x16x32_bf16 v[204:207], a[100:103], v[132:135], v[204:207]
  v_exp_f32 v182, v182
  v_mfma_f32_16x16x32_bf16 v[204:207], a[104:107], v[144:147], v[204:207]
  v_exp_f32 v183, v183
  v_mfma_f32_16x16x32_bf16 v[204:207], a[108:111], v[156:159], v[204:207]
  s_waitcnt lgkmcnt(1)
  v_cvt_pk_bf16_f32 v218, v180, v181
  v_cvt_pk_bf16_f32 v219, v182, v183
  v_mfma_f32_16x16x32_bf16 v[16:19], a[144:147], v[208:211], v[16:19]
  ds_read_b64_tr_b16 a[112:113], v12 offset:49152
  ds_read_b64_tr_b16 a[114:115], v12 offset:50176
  v_mfma_f32_16x16x32_bf16 v[20:23], a[144:147], v[212:215], v[20:23]
  ds_read_b64_tr_b16 a[116:117], v13 offset:49152
  ds_read_b64_tr_b16 a[118:119], v13 offset:50176
  v_mfma_f32_16x16x32_bf16 v[24:27], a[144:147], v[216:219], v[24:27]
  s_add_u32 m0, s37, 16384
  ds_read_b64_tr_b16 a[120:121], v14 offset:49152
  v_mfma_f32_16x16x32_bf16 v[28:31], a[148:151], v[208:211], v[28:31]
  ds_read_b64_tr_b16 a[122:123], v14 offset:50176
  v_mfma_f32_16x16x32_bf16 v[32:35], a[148:151], v[212:215], v[32:35]
  buffer_load_dwordx4 v3, s[20:23], s38 offen offset:3072 nt lds
  v_mfma_f32_16x16x32_bf16 v[36:39], a[148:151], v[216:219], v[36:39]
  ds_read_b64_tr_b16 a[124:125], v15 offset:49152
  v_mfma_f32_16x16x32_bf16 v[40:43], a[152:155], v[208:211], v[40:43]
  ds_read_b64_tr_b16 a[126:127], v15 offset:50176
  v_mfma_f32_16x16x32_bf16 v[44:47], a[152:155], v[212:215], v[44:47]
  s_lshr_b32 s7, s2, 3
  v_exp_f32 v184, v184
  v_mfma_f32_16x16x32_bf16 v[48:51], a[152:155], v[216:219], v[48:51]
  s_waitcnt lgkmcnt(3)
  buffer_load_dword v245, v244, s[68:71], 0 offen sc1
  v_mfma_f32_16x16x32_bf16 v[52:55], a[156:159], v[208:211], v[52:55]
  ds_read_b128 a[64:67], v4 offset:0
  v_mfma_f32_16x16x32_bf16 v[56:59], a[156:159], v[212:215], v[56:59]
  ds_read_b128 a[68:71], v5 offset:0
  v_mfma_f32_16x16x32_bf16 v[60:63], a[156:159], v[216:219], v[60:63]
  ds_read_b128 a[72:75], v6 offset:0
  v_mfma_f32_16x16x32_bf16 v[64:67], a[112:115], v[208:211], v[64:67]
  ds_read_b128 a[76:79], v7 offset:0
  v_mfma_f32_16x16x32_bf16 v[68:71], a[112:115], v[212:215], v[68:71]
  s_lshl_b32 s7, s7, 2
  v_exp_f32 v185, v185
  v_mfma_f32_16x16x32_bf16 v[72:75], a[112:115], v[216:219], v[72:75]
  s_add_u32 s7, s7, s3
  ds_read_b128 a[80:83], v4 offset:1024
  v_cvt_pk_bf16_f32 v220, v184, v185
  v_mfma_f32_16x16x32_bf16 v[76:79], a[116:119], v[208:211], v[76:79]
  s_lshl_b32 s7, s7, 12
  v_exp_f32 v186, v186
  v_mfma_f32_16x16x32_bf16 v[80:83], a[116:119], v[212:215], v[80:83]
  s_lshl_b32 s58, s40, 8
  v_exp_f32 v187, v187
  v_mfma_f32_16x16x32_bf16 v[84:87], a[116:119], v[216:219], v[84:87]
  s_waitcnt lgkmcnt(1)
  s_sub_u32 s7, s7, s58
  ds_read_b128 a[84:87], v5 offset:1024
  v_cvt_pk_bf16_f32 v221, v186, v187
  v_mfma_f32_16x16x32_bf16 v[88:91], a[120:123], v[208:211], v[88:91]
  v_exp_f32 v196, v196
  v_mfma_f32_16x16x32_bf16 v[92:95], a[120:123], v[212:215], v[92:95]
  v_exp_f32 v197, v197
  v_mfma_f32_16x16x32_bf16 v[96:99], a[120:123], v[216:219], v[96:99]
  ds_read_b128 a[88:91], v6 offset:1024
  v_cvt_pk_bf16_f32 v222, v196, v197
  v_mfma_f32_16x16x32_bf16 v[100:103], a[124:127], v[208:211], v[100:103]
  v_exp_f32 v198, v198
  v_mfma_f32_16x16x32_bf16 v[104:107], a[124:127], v[212:215], v[104:107]
  buffer_load_dword v247, v246, s[24:27], s7 offen
  v_mfma_f32_16x16x32_bf16 v[108:111], a[124:127], v[216:219], v[108:111]
  v_exp_f32 v199, v199
  v_mfma_f32_16x16x32_bf16 a[48:51], a[60:63], v[208:211], a[48:51]
  ds_read_b128 a[92:95], v7 offset:1024
  v_cvt_pk_bf16_f32 v223, v198, v199
  v_mfma_f32_16x16x32_bf16 a[52:55], a[60:63], v[212:215], a[52:55]
  v_exp_f32 v188, v188
  v_mfma_f32_16x16x32_bf16 a[56:59], a[60:63], v[216:219], a[56:59]
  v_exp_f32 v189, v189
  v_mfma_f32_16x16x32_bf16 v[160:163], a[64:67], v[112:115], v[232:235]
  ds_read_b64_tr_b16 a[128:129], v8 offset:51200
  v_cvt_pk_bf16_f32 v224, v188, v189
  v_mfma_f32_16x16x32_bf16 v[160:163], a[68:71], v[124:127], v[160:163]
  v_exp_f32 v190, v190
  v_mfma_f32_16x16x32_bf16 v[160:163], a[72:75], v[136:139], v[160:163]
  v_exp_f32 v191, v191
  v_mfma_f32_16x16x32_bf16 v[160:163], a[76:79], v[148:151], v[160:163]
  ds_read_b64_tr_b16 a[130:131], v8 offset:52224
  v_cvt_pk_bf16_f32 v225, v190, v191
  v_mfma_f32_16x16x32_bf16 v[164:167], a[64:67], v[116:119], v[236:239]
  v_exp_f32 v200, v200
  v_mfma_f32_16x16x32_bf16 v[164:167], a[68:71], v[128:131], v[164:167]
  v_exp_f32 v201, v201
  v_mfma_f32_16x16x32_bf16 v[164:167], a[72:75], v[140:143], v[164:167]
  ds_read_b64_tr_b16 a[132:133], v9 offset:51200
  v_cvt_pk_bf16_f32 v226, v200, v201
  v_mfma_f32_16x16x32_bf16 v[164:167], a[76:79], v[152:155], v[164:167]
  v_exp_f32 v202, v202
  v_mfma_f32_16x16x32_bf16 v[168:171], a[64:67], v[120:123], v[240:243]
  v_exp_f32 v203, v203
  v_mfma_f32_16x16x32_bf16 v[168:171], a[68:71], v[132:135], v[168:171]
  ds_read_b64_tr_b16 a[134:135], v9 offset:52224
  v_cvt_pk_bf16_f32 v227, v202, v203
  v_mfma_f32_16x16x32_bf16 v[168:171], a[72:75], v[144:147], v[168:171]
  v_exp_f32 v192, v192
  v_mfma_f32_16x16x32_bf16 v[168:171], a[76:79], v[156:159], v[168:171]
  s_waitcnt lgkmcnt(2)
  v_exp_f32 v193, v193
  v_mfma_f32_16x16x32_bf16 v[172:175], a[80:83], v[112:115], v[232:235]
  ds_read_b64_tr_b16 a[136:137], v10 offset:51200
  v_cvt_pk_bf16_f32 v228, v192, v193
  v_mfma_f32_16x16x32_bf16 v[172:175], a[84:87], v[124:127], v[172:175]
  ds_read_b64_tr_b16 a[138:139], v10 offset:52224
  v_mfma_f32_16x16x32_bf16 v[172:175], a[88:91], v[136:139], v[172:175]
  v_exp_f32 v194, v194
  v_mfma_f32_16x16x32_bf16 v[172:175], a[92:95], v[148:151], v[172:175]
  ds_read_b64_tr_b16 a[140:141], v11 offset:51200
  v_mfma_f32_16x16x32_bf16 v[176:179], a[80:83], v[116:119], v[236:239]
  ds_read_b64_tr_b16 a[142:143], v11 offset:52224
  v_mfma_f32_16x16x32_bf16 v[176:179], a[84:87], v[128:131], v[176:179]
  v_exp_f32 v195, v195
  v_mfma_f32_16x16x32_bf16 v[176:179], a[88:91], v[140:143], v[176:179]
  v_exp_f32 v204, v204
  v_mfma_f32_16x16x32_bf16 v[176:179], a[92:95], v[152:155], v[176:179]
  v_exp_f32 v205, v205
  v_mfma_f32_16x16x32_bf16 v[180:183], a[80:83], v[120:123], v[240:243]
  v_exp_f32 v206, v206
  v_mfma_f32_16x16x32_bf16 v[180:183], a[84:87], v[132:135], v[180:183]
  v_exp_f32 v207, v207
  v_mfma_f32_16x16x32_bf16 v[180:183], a[88:91], v[144:147], v[180:183]
  v_cvt_pk_bf16_f32 v229, v194, v195
  v_cvt_pk_bf16_f32 v230, v204, v205
  v_mfma_f32_16x16x32_bf16 v[180:183], a[92:95], v[156:159], v[180:183]
  v_cvt_pk_bf16_f32 v231, v206, v207
  v_mfma_f32_16x16x32_bf16 v[16:19], a[128:131], v[220:223], v[16:19]
  ds_read_b64_tr_b16 a[144:145], v12 offset:51200
  ds_read_b64_tr_b16 a[146:147], v12 offset:52224
  v_mfma_f32_16x16x32_bf16 v[20:23], a[128:131], v[224:227], v[20:23]
  ds_read_b64_tr_b16 a[148:149], v13 offset:51200
  ds_read_b64_tr_b16 a[150:151], v13 offset:52224
  v_mfma_f32_16x16x32_bf16 v[24:27], a[128:131], v[228:231], v[24:27]
  s_waitcnt lgkmcnt(4)
  ds_read_b64_tr_b16 a[152:153], v14 offset:51200
  v_mfma_f32_16x16x32_bf16 v[28:31], a[132:135], v[220:223], v[28:31]
  ds_read_b64_tr_b16 a[154:155], v14 offset:52224
  v_mfma_f32_16x16x32_bf16 v[32:35], a[132:135], v[224:227], v[32:35]
  ds_read_b64_tr_b16 a[156:157], v15 offset:51200
  v_mfma_f32_16x16x32_bf16 v[36:39], a[132:135], v[228:231], v[36:39]
  ds_read_b64_tr_b16 a[158:159], v15 offset:52224
  v_mfma_f32_16x16x32_bf16 v[40:43], a[136:139], v[220:223], v[40:43]
  v_exp_f32 v160, v160
  v_mfma_f32_16x16x32_bf16 v[44:47], a[136:139], v[224:227], v[44:47]
  v_exp_f32 v161, v161
  v_mfma_f32_16x16x32_bf16 v[48:51], a[136:139], v[228:231], v[48:51]
  ds_read_b128 a[96:99], v4 offset:2048
  v_cvt_pk_bf16_f32 v208, v160, v161
  v_mfma_f32_16x16x32_bf16 v[52:55], a[140:143], v[220:223], v[52:55]
  v_exp_f32 v162, v162
  v_mfma_f32_16x16x32_bf16 v[56:59], a[140:143], v[224:227], v[56:59]
  ds_read_b128 a[100:103], v5 offset:2048
  v_mfma_f32_16x16x32_bf16 v[60:63], a[140:143], v[228:231], v[60:63]
  s_waitcnt lgkmcnt(2)
  ds_read_b128 a[104:107], v6 offset:2048
  v_mfma_f32_16x16x32_bf16 v[64:67], a[144:147], v[220:223], v[64:67]
  ds_read_b128 a[108:111], v7 offset:2048
  v_mfma_f32_16x16x32_bf16 v[68:71], a[144:147], v[224:227], v[68:71]
  v_exp_f32 v163, v163
  v_mfma_f32_16x16x32_bf16 v[72:75], a[144:147], v[228:231], v[72:75]
  ds_read_b128 a[64:67], v4 offset:3072
  v_cvt_pk_bf16_f32 v209, v162, v163
  v_mfma_f32_16x16x32_bf16 v[76:79], a[148:151], v[220:223], v[76:79]
  ds_read_b128 a[68:71], v5 offset:3072
  v_add_u32 v4, -114688, v4
  v_mfma_f32_16x16x32_bf16 v[80:83], a[148:151], v[224:227], v[80:83]
  ds_read_b128 a[72:75], v6 offset:3072
  v_add_u32 v5, -114688, v5
  v_mfma_f32_16x16x32_bf16 v[84:87], a[148:151], v[228:231], v[84:87]
  ds_read_b128 a[76:79], v7 offset:3072
  v_add_u32 v6, -114688, v6
  v_mfma_f32_16x16x32_bf16 v[88:91], a[152:155], v[220:223], v[88:91]
  v_exp_f32 v172, v172
  v_mfma_f32_16x16x32_bf16 v[92:95], a[152:155], v[224:227], v[92:95]
  v_exp_f32 v173, v173
  v_mfma_f32_16x16x32_bf16 v[96:99], a[152:155], v[228:231], v[96:99]
  v_exp_f32 v174, v174
  v_mfma_f32_16x16x32_bf16 v[100:103], a[156:159], v[220:223], v[100:103]
  v_exp_f32 v175, v175
  v_mfma_f32_16x16x32_bf16 v[104:107], a[156:159], v[224:227], v[104:107]
  v_exp_f32 v164, v164
  v_mfma_f32_16x16x32_bf16 v[108:111], a[156:159], v[228:231], v[108:111]
  v_exp_f32 v165, v165
  v_mfma_f32_16x16x32_bf16 a[48:51], a[60:63], v[220:223], a[48:51]
  v_exp_f32 v166, v166
  v_mfma_f32_16x16x32_bf16 a[52:55], a[60:63], v[224:227], a[52:55]
  v_exp_f32 v167, v167
  v_mfma_f32_16x16x32_bf16 a[56:59], a[60:63], v[228:231], a[56:59]
  s_waitcnt lgkmcnt(0)
  v_exp_f32 v176, v176
  v_mfma_f32_16x16x32_bf16 v[184:187], a[96:99], v[112:115], v[232:235]
  v_exp_f32 v177, v177
  v_mfma_f32_16x16x32_bf16 v[184:187], a[100:103], v[124:127], v[184:187]
  v_exp_f32 v178, v178
  v_mfma_f32_16x16x32_bf16 v[184:187], a[104:107], v[136:139], v[184:187]
  v_exp_f32 v179, v179
  v_mfma_f32_16x16x32_bf16 v[184:187], a[108:111], v[148:151], v[184:187]
  v_exp_f32 v168, v168
  v_mfma_f32_16x16x32_bf16 v[188:191], a[96:99], v[116:119], v[236:239]
  v_exp_f32 v169, v169
  v_mfma_f32_16x16x32_bf16 v[188:191], a[100:103], v[128:131], v[188:191]
  v_exp_f32 v170, v170
  v_mfma_f32_16x16x32_bf16 v[188:191], a[104:107], v[140:143], v[188:191]
  v_exp_f32 v171, v171
  v_mfma_f32_16x16x32_bf16 v[188:191], a[108:111], v[152:155], v[188:191]
  v_exp_f32 v180, v180
  v_mfma_f32_16x16x32_bf16 v[192:195], a[96:99], v[120:123], v[240:243]
  v_exp_f32 v181, v181
  v_mfma_f32_16x16x32_bf16 v[192:195], a[100:103], v[132:135], v[192:195]
  v_exp_f32 v182, v182
  v_mfma_f32_16x16x32_bf16 v[192:195], a[104:107], v[144:147], v[192:195]
  s_waitcnt vmcnt(6)
  s_barrier
  ds_read_b64_tr_b16 a[112:113], v8 offset:0
  v_mfma_f32_16x16x32_bf16 v[192:195], a[108:111], v[156:159], v[192:195]
  ds_read_b64_tr_b16 a[114:115], v8 offset:1024
  v_cvt_pk_bf16_f32 v210, v172, v173
  v_mfma_f32_16x16x32_bf16 v[196:199], a[64:67], v[112:115], v[232:235]
  ds_read_b64_tr_b16 a[116:117], v9 offset:0
  v_cvt_pk_bf16_f32 v211, v174, v175
  v_mfma_f32_16x16x32_bf16 v[196:199], a[68:71], v[124:127], v[196:199]
  ds_read_b64_tr_b16 a[118:119], v9 offset:1024
  v_cvt_pk_bf16_f32 v212, v164, v165
  v_mfma_f32_16x16x32_bf16 v[196:199], a[72:75], v[136:139], v[196:199]
  ds_read_b64_tr_b16 a[120:121], v10 offset:0
  v_cvt_pk_bf16_f32 v213, v166, v167
  v_mfma_f32_16x16x32_bf16 v[196:199], a[76:79], v[148:151], v[196:199]
  ds_read_b64_tr_b16 a[122:123], v10 offset:1024
  v_cvt_pk_bf16_f32 v214, v176, v177
  v_mfma_f32_16x16x32_bf16 v[200:203], a[64:67], v[116:119], v[236:239]
  ds_read_b64_tr_b16 a[124:125], v11 offset:0
  v_cvt_pk_bf16_f32 v215, v178, v179
  v_mfma_f32_16x16x32_bf16 v[200:203], a[68:71], v[128:131], v[200:203]
  ds_read_b64_tr_b16 a[126:127], v11 offset:1024
  v_cvt_pk_bf16_f32 v216, v168, v169
  v_mfma_f32_16x16x32_bf16 v[200:203], a[72:75], v[140:143], v[200:203]
  s_lshl_b32 s44, s40, 17
  v_exp_f32 v183, v183
  v_mfma_f32_16x16x32_bf16 v[200:203], a[76:79], v[152:155], v[200:203]
  s_add_u32 m0, s37, 32768
  ds_read_b64_tr_b16 a[128:129], v12 offset:0
  v_cvt_pk_bf16_f32 v217, v170, v171
  v_mfma_f32_16x16x32_bf16 v[204:207], a[64:67], v[120:123], v[240:243]
  buffer_load_dwordx4 v250, s[24:27], s44 offen offset:0 lds
  v_mfma_f32_16x16x32_bf16 v[204:207], a[68:71], v[132:135], v[204:207]
  v_cvt_pk_bf16_f32 v218, v180, v181
  v_cvt_pk_bf16_f32 v219, v182, v183
  v_mfma_f32_16x16x32_bf16 v[204:207], a[72:75], v[144:147], v[204:207]
  ds_read_b64_tr_b16 a[130:131], v12 offset:1024
  v_add_u32 v7, -114688, v7
  v_mfma_f32_16x16x32_bf16 v[204:207], a[76:79], v[156:159], v[204:207]
  s_waitcnt lgkmcnt(2)
  s_add_u32 m0, s37, 32768
  ds_read_b64_tr_b16 a[132:133], v13 offset:0
  v_mfma_f32_16x16x32_bf16 v[16:19], a[112:115], v[208:211], v[16:19]
  ds_read_b64_tr_b16 a[134:135], v13 offset:1024
  v_mfma_f32_16x16x32_bf16 v[20:23], a[112:115], v[212:215], v[20:23]
  buffer_load_dwordx4 v251, s[24:27], s44 offen offset:1024 lds
  v_mfma_f32_16x16x32_bf16 v[24:27], a[112:115], v[216:219], v[24:27]
  ds_read_b64_tr_b16 a[136:137], v14 offset:0
  v_mfma_f32_16x16x32_bf16 v[28:31], a[116:119], v[208:211], v[28:31]
  ds_read_b64_tr_b16 a[138:139], v14 offset:1024
  v_mfma_f32_16x16x32_bf16 v[32:35], a[116:119], v[212:215], v[32:35]
  s_add_u32 m0, s37, 32768
  ds_read_b64_tr_b16 a[140:141], v15 offset:0
  v_mfma_f32_16x16x32_bf16 v[36:39], a[116:119], v[216:219], v[36:39]
  ds_read_b64_tr_b16 a[142:143], v15 offset:1024
  v_mfma_f32_16x16x32_bf16 v[40:43], a[120:123], v[208:211], v[40:43]
  buffer_load_dwordx4 v252, s[24:27], s44 offen offset:2048 lds
  v_mfma_f32_16x16x32_bf16 v[44:47], a[120:123], v[212:215], v[44:47]
  v_exp_f32 v184, v184
  v_mfma_f32_16x16x32_bf16 v[48:51], a[120:123], v[216:219], v[48:51]
  v_exp_f32 v185, v185
  v_mfma_f32_16x16x32_bf16 v[52:55], a[124:127], v[208:211], v[52:55]
  s_add_u32 m0, s37, 32768
  ds_read_b128 a[80:83], v4 offset:0
  v_cvt_pk_bf16_f32 v220, v184, v185
  v_mfma_f32_16x16x32_bf16 v[56:59], a[124:127], v[212:215], v[56:59]
  ds_read_b128 a[84:87], v5 offset:0
  v_mfma_f32_16x16x32_bf16 v[60:63], a[124:127], v[216:219], v[60:63]
  s_waitcnt lgkmcnt(2)
  buffer_load_dwordx4 v253, s[24:27], s44 offen offset:3072 lds
  v_mfma_f32_16x16x32_bf16 v[64:67], a[128:131], v[208:211], v[64:67]
  ds_read_b128 a[88:91], v6 offset:0
  v_mfma_f32_16x16x32_bf16 v[68:71], a[128:131], v[212:215], v[68:71]
  ds_read_b128 a[92:95], v7 offset:0
  v_mfma_f32_16x16x32_bf16 v[72:75], a[128:131], v[216:219], v[72:75]
  v_exp_f32 v186, v186
  v_mfma_f32_16x16x32_bf16 v[76:79], a[132:135], v[208:211], v[76:79]
  v_exp_f32 v187, v187
  v_mfma_f32_16x16x32_bf16 v[80:83], a[132:135], v[212:215], v[80:83]
  s_waitcnt vmcnt(5)
  v_cmp_le_u32 vcc, 0x80, v245
  v_cvt_pk_bf16_f32 v221, v186, v187
  v_mfma_f32_16x16x32_bf16 v[84:87], a[132:135], v[216:219], v[84:87]
  s_nop 1
  s_cmp_eq_u32 vcc_lo, 3
  s_cbranch_scc0 L_chk_slow
L_chk_ret:
  v_exp_f32 v188, v188
  v_mfma_f32_16x16x32_bf16 v[88:91], a[136:139], v[208:211], v[88:91]
  s_lshl_b32 s44, s40, 17
  v_exp_f32 v189, v189
  v_mfma_f32_16x16x32_bf16 v[92:95], a[136:139], v[212:215], v[92:95]
  s_add_u32 s44, s44, 65536
  ds_read_b128 a[96:99], v4 offset:1024
  v_cvt_pk_bf16_f32 v224, v188, v189
  v_mfma_f32_16x16x32_bf16 v[96:99], a[136:139], v[216:219], v[96:99]
  s_add_u32 m0, s37, 49152
  v_exp_f32 v190, v190
  v_mfma_f32_16x16x32_bf16 v[100:103], a[140:143], v[208:211], v[100:103]
  buffer_load_dwordx4 v250, s[24:27], s44 offen offset:0 lds
  v_mfma_f32_16x16x32_bf16 v[104:107], a[140:143], v[212:215], v[104:107]
  s_add_u32 m0, s37, 49152
  ds_read_b128 a[100:103], v5 offset:1024
  v_mfma_f32_16x16x32_bf16 v[108:111], a[140:143], v[216:219], v[108:111]
  buffer_load_dwordx4 v251, s[24:27], s44 offen offset:1024 lds
  v_mfma_f32_16x16x32_bf16 a[48:51], a[60:63], v[208:211], a[48:51]
  s_add_u32 m0, s37, 49152
  ds_read_b128 a[104:107], v6 offset:1024
  v_mfma_f32_16x16x32_bf16 a[52:55], a[60:63], v[212:215], a[52:55]
  ds_read_b128 a[108:111], v7 offset:1024
  v_mfma_f32_16x16x32_bf16 a[56:59], a[60:63], v[216:219], a[56:59]
  s_waitcnt lgkmcnt(3)
  buffer_load_dwordx4 v252, s[24:27], s44 offen offset:2048 lds
  v_mfma_f32_16x16x32_bf16 v[160:163], a[80:83], v[112:115], v[232:235]
  v_exp_f32 v191, v191
  v_mfma_f32_16x16x32_bf16 v[160:163], a[84:87], v[124:127], v[160:163]
  ds_read_b128 a[64:67], v4 offset:2048
  v_cvt_pk_bf16_f32 v225, v190, v191
  v_mfma_f32_16x16x32_bf16 v[160:163], a[88:91], v[136:139], v[160:163]
  s_add_u32 m0, s37, 49152
  v_exp_f32 v192, v192
  v_mfma_f32_16x16x32_bf16 v[160:163], a[92:95], v[148:151], v[160:163]
  v_exp_f32 v193, v193
  v_mfma_f32_16x16x32_bf16 v[164:167], a[80:83], v[116:119], v[236:239]
  buffer_load_dwordx4 v253, s[24:27], s44 offen offset:3072 lds
  v_mfma_f32_16x16x32_bf16 v[164:167], a[84:87], v[128:131], v[164:167]
  ds_read_b128 a[68:71], v5 offset:2048
  v_cvt_pk_bf16_f32 v228, v192, v193
  v_mfma_f32_16x16x32_bf16 v[164:167], a[88:91], v[140:143], v[164:167]
  v_exp_f32 v194, v194
  v_mfma_f32_16x16x32_bf16 v[164:167], a[92:95], v[152:155], v[164:167]
  s_lshl_b32 s44, s41, 17
  v_exp_f32 v195, v195
  v_mfma_f32_16x16x32_bf16 v[168:171], a[80:83], v[120:123], v[240:243]
  s_add_u32 m0, s37, 65536
  ds_read_b128 a[72:75], v6 offset:2048
  v_cvt_pk_bf16_f32 v229, v194, v195
  v_mfma_f32_16x16x32_bf16 v[168:171], a[84:87], v[132:135], v[168:171]
  buffer_load_dwordx4 v250, s[24:27], s44 offen offset:0 lds
  v_mfma_f32_16x16x32_bf16 v[168:171], a[88:91], v[144:147], v[168:171]
  ds_read_b128 a[76:79], v7 offset:2048
  v_mfma_f32_16x16x32_bf16 v[168:171], a[92:95], v[156:159], v[168:171]
  v_exp_f32 v196, v196
  v_mfma_f32_16x16x32_bf16 v[172:175], a[96:99], v[112:115], v[232:235]
  s_waitcnt lgkmcnt(2)
  s_add_u32 m0, s37, 65536
  v_exp_f32 v197, v197
  v_mfma_f32_16x16x32_bf16 v[172:175], a[100:103], v[124:127], v[172:175]
  ds_read_b128 a[80:83], v4 offset:3072
  v_cvt_pk_bf16_f32 v222, v196, v197
  v_mfma_f32_16x16x32_bf16 v[172:175], a[104:107], v[136:139], v[172:175]
  buffer_load_dwordx4 v251, s[24:27], s44 offen offset:1024 lds
  v_mfma_f32_16x16x32_bf16 v[172:175], a[108:111], v[148:151], v[172:175]
  v_exp_f32 v198, v198
  v_mfma_f32_16x16x32_bf16 v[176:179], a[96:99], v[116:119], v[236:239]
  v_exp_f32 v199, v199
  v_mfma_f32_16x16x32_bf16 v[176:179], a[100:103], v[128:131], v[176:179]
  s_add_u32 m0, s37, 65536
  ds_read_b128 a[84:87], v5 offset:3072
  v_cvt_pk_bf16_f32 v223, v198, v199
  v_mfma_f32_16x16x32_bf16 v[176:179], a[104:107], v[140:143], v[176:179]
  v_exp_f32 v200, v200
  v_mfma_f32_16x16x32_bf16 v[176:179], a[108:111], v[152:155], v[176:179]
  buffer_load_dwordx4 v252, s[24:27], s44 offen offset:2048 lds
  v_mfma_f32_16x16x32_bf16 v[180:183], a[96:99], v[120:123], v[240:243]
  ds_read_b128 a[88:91], v6 offset:3072
  v_mfma_f32_16x16x32_bf16 v[180:183], a[100:103], v[132:135], v[180:183]
  ds_read_b128 a[92:95], v7 offset:3072
  v_mfma_f32_16x16x32_bf16 v[180:183], a[104:107], v[144:147], v[180:183]
  s_add_u32 m0, s37, 65536
  v_exp_f32 v201, v201
  v_mfma_f32_16x16x32_bf16 v[180:183], a[108:111], v[156:159], v[180:183]
  ds_read_b64_tr_b16 a[144:145], v8 offset:2048
  v_cvt_pk_bf16_f32 v226, v200, v201
  v_mfma_f32_16x16x32_bf16 v[184:187], a[64:67], v[112:115], v[232:235]
  buffer_load_dwordx4 v253, s[24:27], s44 offen offset:3072 lds
  v_mfma_f32_16x16x32_bf16 v[184:187], a[68:71], v[124:127], v[184:187]
  s_waitcnt lgkmcnt(3)
  v_exp_f32 v202, v202
  v_mfma_f32_16x16x32_bf16 v[184:187], a[72:75], v[136:139], v[184:187]
  v_exp_f32 v203, v203
  v_mfma_f32_16x16x32_bf16 v[184:187], a[76:79], v[148:151], v[184:187]
  s_lshl_b32 s44, s42, 17
  ds_read_b64_tr_b16 a[146:147], v8 offset:3072
  v_cvt_pk_bf16_f32 v227, v202, v203
  v_mfma_f32_16x16x32_bf16 v[188:191], a[64:67], v[116:119], v[236:239]
  s_add_u32 m0, s37, 81920
  ds_read_b64_tr_b16 a[148:149], v9 offset:2048
  v_add_u32 v8, -81920, v8
  v_mfma_f32_16x16x32_bf16 v[188:191], a[68:71], v[128:131], v[188:191]
  buffer_load_dwordx4 v250, s[24:27], s44 offen offset:0 lds
  v_mfma_f32_16x16x32_bf16 v[188:191], a[72:75], v[140:143], v[188:191]
  v_exp_f32 v204, v204
  v_mfma_f32_16x16x32_bf16 v[188:191], a[76:79], v[152:155], v[188:191]
  ds_read_b64_tr_b16 a[150:151], v9 offset:3072
  v_add_u32 v9, -81920, v9
  v_mfma_f32_16x16x32_bf16 v[192:195], a[64:67], v[120:123], v[240:243]
  s_add_u32 m0, s37, 81920
  ds_read_b64_tr_b16 a[152:153], v10 offset:2048
  v_mfma_f32_16x16x32_bf16 v[192:195], a[68:71], v[132:135], v[192:195]
  ds_read_b64_tr_b16 a[154:155], v10 offset:3072
  v_add_u32 v10, -81920, v10
  v_mfma_f32_16x16x32_bf16 v[192:195], a[72:75], v[144:147], v[192:195]
  buffer_load_dwordx4 v251, s[24:27], s44 offen offset:1024 lds
  v_mfma_f32_16x16x32_bf16 v[192:195], a[76:79], v[156:159], v[192:195]
  ds_read_b64_tr_b16 a[156:157], v11 offset:2048
  v_mfma_f32_16x16x32_bf16 v[196:199], a[80:83], v[112:115], v[232:235]
  ds_read_b64_tr_b16 a[158:159], v11 offset:3072
  v_add_u32 v11, -81920, v11
  v_mfma_f32_16x16x32_bf16 v[196:199], a[84:87], v[124:127], v[196:199]
  s_waitcnt lgkmcnt(4)
  s_add_u32 m0, s37, 81920
  ds_read_b64_tr_b16 a[112:113], v12 offset:2048
  ds_read_b64_tr_b16 a[114:115], v12 offset:3072
  v_mfma_f32_16x16x32_bf16 v[196:199], a[88:91], v[136:139], v[196:199]
  ds_read_b64_tr_b16 a[116:117], v13 offset:2048
  v_add_u32 v12, -81920, v12
  v_mfma_f32_16x16x32_bf16 v[196:199], a[92:95], v[148:151], v[196:199]
  buffer_load_dwordx4 v252, s[24:27], s44 offen offset:2048 lds
  v_mfma_f32_16x16x32_bf16 v[200:203], a[80:83], v[116:119], v[236:239]
  ds_read_b64_tr_b16 a[118:119], v13 offset:3072
  v_add_u32 v13, -81920, v13
  v_mfma_f32_16x16x32_bf16 v[200:203], a[84:87], v[128:131], v[200:203]
  v_exp_f32 v205, v205
  v_mfma_f32_16x16x32_bf16 v[200:203], a[88:91], v[140:143], v[200:203]
  s_add_u32 m0, s37, 81920
  ds_read_b64_tr_b16 a[120:121], v14 offset:2048
  ds_read_b64_tr_b16 a[122:123], v14 offset:3072
  v_exp_f32 v206, v206
  v_exp_f32 v207, v207
  v_mfma_f32_16x16x32_bf16 v[200:203], a[92:95], v[152:155], v[200:203]
  ds_read_b64_tr_b16 a[124:125], v15 offset:2048
  ds_read_b64_tr_b16 a[126:127], v15 offset:3072
  v_cvt_pk_bf16_f32 v230, v204, v205
  v_cvt_pk_bf16_f32 v231, v206, v207
  v_mfma_f32_16x16x32_bf16 v[204:207], a[80:83], v[120:123], v[240:243]
  buffer_load_dwordx4 v253, s[24:27], s44 offen offset:3072 lds
  v_mfma_f32_16x16x32_bf16 v[204:207], a[84:87], v[132:135], v[204:207]
  v_exp_f32 v160, v160
  v_mfma_f32_16x16x32_bf16 v[204:207], a[88:91], v[144:147], v[204:207]
  v_exp_f32 v161, v161
  v_mfma_f32_16x16x32_bf16 v[204:207], a[92:95], v[156:159], v[204:207]
  s_lshl_b32 s44, s43, 17
  v_exp_f32 v162, v162
  v_mfma_f32_16x16x32_bf16 v[16:19], a[144:147], v[220:223], v[16:19]
  s_add_u32 m0, s37, 131072
  v_exp_f32 v163, v163
  v_mfma_f32_16x16x32_bf16 v[28:31], a[148:151], v[220:223], v[28:31]
  s_waitcnt lgkmcnt(0)
  buffer_load_dwordx4 v250, s[24:27], s44 offen offset:0 lds
  v_mfma_f32_16x16x32_bf16 v[40:43], a[152:155], v[220:223], v[40:43]
  v_exp_f32 v172, v172
  v_mfma_f32_16x16x32_bf16 v[52:55], a[156:159], v[220:223], v[52:55]
  v_exp_f32 v173, v173
  v_mfma_f32_16x16x32_bf16 v[64:67], a[112:115], v[220:223], v[64:67]
  s_add_u32 m0, s37, 131072
  v_exp_f32 v174, v174
  v_mfma_f32_16x16x32_bf16 v[76:79], a[116:119], v[220:223], v[76:79]
  v_exp_f32 v175, v175
  v_mfma_f32_16x16x32_bf16 v[88:91], a[120:123], v[220:223], v[88:91]
  buffer_load_dwordx4 v251, s[24:27], s44 offen offset:1024 lds
  v_mfma_f32_16x16x32_bf16 v[100:103], a[124:127], v[220:223], v[100:103]
  v_exp_f32 v184, v184
  v_mfma_f32_16x16x32_bf16 a[48:51], a[60:63], v[220:223], a[48:51]
  v_exp_f32 v185, v185
  v_mfma_f32_16x16x32_bf16 v[20:23], a[144:147], v[224:227], v[20:23]
  s_add_u32 m0, s37, 131072
  v_exp_f32 v186, v186
  v_mfma_f32_16x16x32_bf16 v[32:35], a[148:151], v[224:227], v[32:35]
  v_exp_f32 v187, v187
  v_mfma_f32_16x16x32_bf16 v[44:47], a[152:155], v[224:227], v[44:47]
  buffer_load_dwordx4 v252, s[24:27], s44 offen offset:2048 lds
  v_mfma_f32_16x16x32_bf16 v[56:59], a[156:159], v[224:227], v[56:59]
  v_exp_f32 v196, v196
  v_mfma_f32_16x16x32_bf16 v[68:71], a[112:115], v[224:227], v[68:71]
  v_exp_f32 v197, v197
  v_mfma_f32_16x16x32_bf16 v[80:83], a[116:119], v[224:227], v[80:83]
  s_add_u32 m0, s37, 131072
  v_exp_f32 v198, v198
  v_mfma_f32_16x16x32_bf16 v[92:95], a[120:123], v[224:227], v[92:95]
  s_barrier
  ds_read_b64_tr_b16 a[160:161], v8 offset:0
  v_mfma_f32_16x16x32_bf16 v[104:107], a[124:127], v[224:227], v[104:107]
  buffer_load_dwordx4 v253, s[24:27], s44 offen offset:3072 lds
  v_mfma_f32_16x16x32_bf16 a[52:55], a[60:63], v[224:227], a[52:55]
  ds_read_b64_tr_b16 a[162:163], v8 offset:1024
  ds_read_b64_tr_b16 a[192:193], v8 offset:2048
  v_mfma_f32_16x16x32_bf16 v[24:27], a[144:147], v[228:231], v[24:27]
  ds_read_b64_tr_b16 a[194:195], v8 offset:3072
  ds_read_b64_tr_b16 a[164:165], v9 offset:0
  v_mfma_f32_16x16x32_bf16 v[36:39], a[148:151], v[228:231], v[36:39]
  ds_read_b64_tr_b16 a[166:167], v9 offset:1024
  ds_read_b64_tr_b16 a[196:197], v9 offset:2048
  v_mfma_f32_16x16x32_bf16 v[48:51], a[152:155], v[228:231], v[48:51]
  ds_read_b64_tr_b16 a[198:199], v9 offset:3072
  ds_read_b64_tr_b16 a[168:169], v10 offset:0
  v_mfma_f32_16x16x32_bf16 v[60:63], a[156:159], v[228:231], v[60:63]
  ds_read_b64_tr_b16 a[170:171], v10 offset:1024
  ds_read_b64_tr_b16 a[200:201], v10 offset:2048
  v_mfma_f32_16x16x32_bf16 v[72:75], a[112:115], v[228:231], v[72:75]
  ds_read_b64_tr_b16 a[202:203], v10 offset:3072
  ds_read_b64_tr_b16 a[172:173], v11 offset:0
  v_mfma_f32_16x16x32_bf16 v[84:87], a[116:119], v[228:231], v[84:87]
  ds_read_b64_tr_b16 a[174:175], v11 offset:1024
  ds_read_b64_tr_b16 a[204:205], v11 offset:2048
  v_mfma_f32_16x16x32_bf16 v[96:99], a[120:123], v[228:231], v[96:99]
  ds_read_b64_tr_b16 a[206:207], v11 offset:3072
  v_cvt_pk_bf16_f32 v208, v160, v161
  v_mfma_f32_16x16x32_bf16 v[108:111], a[124:127], v[228:231], v[108:111]
  ds_read_b64_tr_b16 a[176:177], v12 offset:0
  ds_read_b64_tr_b16 a[178:179], v12 offset:1024
  v_cvt_pk_bf16_f32 v209, v162, v163
  v_cvt_pk_bf16_f32 v210, v172, v173
  v_cvt_pk_bf16_f32 v211, v174, v175
  v_exp_f32 v199, v199
  v_mfma_f32_16x16x32_bf16 a[56:59], a[60:63], v[228:231], a[56:59]
  ds_read_b64_tr_b16 a[208:209], v12 offset:2048
  ds_read_b64_tr_b16 a[210:211], v12 offset:3072
  v_cvt_pk_bf16_f32 v220, v184, v185
  v_cvt_pk_bf16_f32 v221, v186, v187
  v_cvt_pk_bf16_f32 v222, v196, v197
  v_cvt_pk_bf16_f32 v223, v198, v199
  v_mfma_f32_16x16x32_bf16 a[48:51], a[60:63], v[208:211], a[48:51]
  ds_read_b64_tr_b16 a[180:181], v13 offset:0
  ds_read_b64_tr_b16 a[182:183], v13 offset:1024
  v_mfma_f32_16x16x32_bf16 a[48:51], a[60:63], v[220:223], a[48:51]
  s_waitcnt lgkmcnt(4)
  ds_read_b64_tr_b16 a[212:213], v13 offset:2048
  ds_read_b64_tr_b16 a[214:215], v13 offset:3072
  v_add_u32 v14, -81920, v14
  v_mfma_f32_16x16x32_bf16 v[16:19], a[160:163], v[208:211], v[16:19]
  ds_read_b64_tr_b16 a[184:185], v14 offset:0
  ds_read_b64_tr_b16 a[186:187], v14 offset:1024
  v_mfma_f32_16x16x32_bf16 v[16:19], a[192:195], v[220:223], v[16:19]
  ds_read_b64_tr_b16 a[216:217], v14 offset:2048
  ds_read_b64_tr_b16 a[218:219], v14 offset:3072
  v_add_u32 v15, -81920, v15
  v_mfma_f32_16x16x32_bf16 v[28:31], a[164:167], v[208:211], v[28:31]
  ds_read_b64_tr_b16 a[188:189], v15 offset:0
  ds_read_b64_tr_b16 a[190:191], v15 offset:1024
  v_mfma_f32_16x16x32_bf16 v[28:31], a[196:199], v[220:223], v[28:31]
  ds_read_b64_tr_b16 a[220:221], v15 offset:2048
  ds_read_b64_tr_b16 a[222:223], v15 offset:3072
  v_accvgpr_read_b32 v245, a48
  v_mfma_f32_16x16x32_bf16 v[40:43], a[168:171], v[208:211], v[40:43]
  v_rcp_f32 v244, v245
  v_mfma_f32_16x16x32_bf16 v[40:43], a[200:203], v[220:223], v[40:43]
  v_mul_f32 v16, v244, v16
  v_mul_f32 v17, v244, v17
  v_mfma_f32_16x16x32_bf16 v[52:55], a[172:175], v[208:211], v[52:55]
  v_mul_f32 v18, v244, v18
  v_mul_f32 v19, v244, v19
  v_mfma_f32_16x16x32_bf16 v[52:55], a[204:207], v[220:223], v[52:55]
  v_cvt_pk_bf16_f32 v160, v16, v17
  v_cvt_pk_bf16_f32 v161, v18, v19
  v_mfma_f32_16x16x32_bf16 v[64:67], a[176:179], v[208:211], v[64:67]
  s_waitcnt lgkmcnt(0)
  v_mul_f32 v28, v244, v28
  v_mul_f32 v29, v244, v29
  v_mfma_f32_16x16x32_bf16 v[64:67], a[208:211], v[220:223], v[64:67]
  v_mul_f32 v30, v244, v30
  v_mul_f32 v31, v244, v31
  v_mfma_f32_16x16x32_bf16 v[76:79], a[180:183], v[208:211], v[76:79]
  v_cvt_pk_bf16_f32 v162, v28, v29
  v_cvt_pk_bf16_f32 v163, v30, v31
  v_mfma_f32_16x16x32_bf16 v[76:79], a[212:215], v[220:223], v[76:79]
  buffer_store_dwordx4 v[160:163], v1, s[28:31], 0 offen offset:0 sc1
  v_mfma_f32_16x16x32_bf16 v[88:91], a[184:187], v[208:211], v[88:91]
  v_mul_f32 v40, v244, v40
  v_mul_f32 v41, v244, v41
  v_mfma_f32_16x16x32_bf16 v[88:91], a[216:219], v[220:223], v[88:91]
  v_mul_f32 v42, v244, v42
  v_mul_f32 v43, v244, v43
  v_exp_f32 v164, v164
  v_exp_f32 v165, v165
  v_exp_f32 v166, v166
  v_exp_f32 v167, v167
  v_exp_f32 v176, v176
  v_exp_f32 v177, v177
  v_exp_f32 v178, v178
  v_exp_f32 v179, v179
  v_mfma_f32_16x16x32_bf16 v[100:103], a[188:191], v[208:211], v[100:103]
  v_cvt_pk_bf16_f32 v172, v40, v41
  v_cvt_pk_bf16_f32 v173, v42, v43
  v_cvt_pk_bf16_f32 v212, v164, v165
  v_cvt_pk_bf16_f32 v213, v166, v167
  v_cvt_pk_bf16_f32 v214, v176, v177
  v_cvt_pk_bf16_f32 v215, v178, v179
  v_exp_f32 v188, v188
  v_exp_f32 v189, v189
  v_exp_f32 v190, v190
  v_exp_f32 v191, v191
  v_exp_f32 v200, v200
  v_exp_f32 v201, v201
  v_exp_f32 v202, v202
  v_exp_f32 v203, v203
  v_mfma_f32_16x16x32_bf16 v[100:103], a[220:223], v[220:223], v[100:103]
  v_mul_f32 v52, v244, v52
  v_mul_f32 v53, v244, v53
  v_cvt_pk_bf16_f32 v224, v188, v189
  v_cvt_pk_bf16_f32 v225, v190, v191
  v_cvt_pk_bf16_f32 v226, v200, v201
  v_cvt_pk_bf16_f32 v227, v202, v203
  v_mfma_f32_16x16x32_bf16 a[52:55], a[60:63], v[212:215], a[52:55]
  v_mul_f32 v54, v244, v54
  v_mul_f32 v55, v244, v55
  v_mfma_f32_16x16x32_bf16 a[52:55], a[60:63], v[224:227], a[52:55]
  v_cvt_pk_bf16_f32 v174, v52, v53
  v_cvt_pk_bf16_f32 v175, v54, v55
  v_mfma_f32_16x16x32_bf16 v[20:23], a[160:163], v[212:215], v[20:23]
  buffer_store_dwordx4 v[172:175], v1, s[28:31], 0 offen offset:3072 sc1
  v_mfma_f32_16x16x32_bf16 v[20:23], a[192:195], v[224:227], v[20:23]
  v_mul_f32 v64, v244, v64
  v_mul_f32 v65, v244, v65
  v_mfma_f32_16x16x32_bf16 v[32:35], a[164:167], v[212:215], v[32:35]
  v_mul_f32 v66, v244, v66
  v_mul_f32 v67, v244, v67
  v_mfma_f32_16x16x32_bf16 v[32:35], a[196:199], v[224:227], v[32:35]
  s_waitcnt vmcnt(22)
  v_accvgpr_read_b32 v247, a52
  v_cvt_pk_bf16_f32 v184, v64, v65
  v_mfma_f32_16x16x32_bf16 v[44:47], a[168:171], v[212:215], v[44:47]
  v_rcp_f32 v246, v247
  v_mfma_f32_16x16x32_bf16 v[44:47], a[200:203], v[224:227], v[44:47]
  v_cvt_pk_bf16_f32 v185, v66, v67
  v_mul_f32 v76, v244, v76
  v_mfma_f32_16x16x32_bf16 v[56:59], a[172:175], v[212:215], v[56:59]
  v_mul_f32 v77, v244, v77
  v_mul_f32 v78, v244, v78
  v_mfma_f32_16x16x32_bf16 v[56:59], a[204:207], v[224:227], v[56:59]
  v_mul_f32 v79, v244, v79
  v_cvt_pk_bf16_f32 v186, v76, v77
  v_mfma_f32_16x16x32_bf16 v[68:71], a[176:179], v[212:215], v[68:71]
  v_cvt_pk_bf16_f32 v187, v78, v79
  v_mul_f32 v88, v244, v88
  v_mfma_f32_16x16x32_bf16 v[68:71], a[208:211], v[224:227], v[68:71]
  buffer_store_dwordx4 v[184:187], v1, s[28:31], s56 offen offset:2048 sc1
  v_mfma_f32_16x16x32_bf16 v[80:83], a[180:183], v[212:215], v[80:83]
  v_mul_f32 v89, v244, v89
  v_mul_f32 v90, v244, v90
  v_mfma_f32_16x16x32_bf16 v[80:83], a[212:215], v[224:227], v[80:83]
  v_mul_f32 v91, v244, v91
  v_cvt_pk_bf16_f32 v196, v88, v89
  v_mfma_f32_16x16x32_bf16 v[92:95], a[184:187], v[212:215], v[92:95]
  v_cvt_pk_bf16_f32 v197, v90, v91
  v_mul_f32 v100, v244, v100
  v_mfma_f32_16x16x32_bf16 v[92:95], a[216:219], v[224:227], v[92:95]
  v_mul_f32 v101, v244, v101
  v_mul_f32 v102, v244, v102
  v_exp_f32 v168, v168
  v_exp_f32 v169, v169
  v_exp_f32 v170, v170
  v_exp_f32 v171, v171
  v_exp_f32 v180, v180
  v_exp_f32 v181, v181
  v_exp_f32 v182, v182
  v_exp_f32 v183, v183
  v_mfma_f32_16x16x32_bf16 v[104:107], a[188:191], v[212:215], v[104:107]
  v_mul_f32 v103, v244, v103
  v_cvt_pk_bf16_f32 v198, v100, v101
  v_cvt_pk_bf16_f32 v216, v168, v169
  v_cvt_pk_bf16_f32 v217, v170, v171
  v_cvt_pk_bf16_f32 v218, v180, v181
  v_cvt_pk_bf16_f32 v219, v182, v183
  v_exp_f32 v192, v192
  v_exp_f32 v193, v193
  v_exp_f32 v194, v194
  v_exp_f32 v195, v195
  v_exp_f32 v204, v204
  v_exp_f32 v205, v205
  v_exp_f32 v206, v206
  v_exp_f32 v207, v207
  v_mfma_f32_16x16x32_bf16 v[104:107], a[220:223], v[224:227], v[104:107]
  v_cvt_pk_bf16_f32 v199, v102, v103
  v_mul_f32 v20, v246, v20
  v_cvt_pk_bf16_f32 v228, v192, v193
  v_cvt_pk_bf16_f32 v229, v194, v195
  v_cvt_pk_bf16_f32 v230, v204, v205
  v_cvt_pk_bf16_f32 v231, v206, v207
  v_mfma_f32_16x16x32_bf16 a[56:59], a[60:63], v[216:219], a[56:59]
  buffer_store_dwordx4 v[196:199], v1, s[28:31], s57 offen offset:1024 sc1
  v_mfma_f32_16x16x32_bf16 a[56:59], a[60:63], v[228:231], a[56:59]
  v_mul_f32 v21, v246, v21
  v_mul_f32 v22, v246, v22
  v_mfma_f32_16x16x32_bf16 v[24:27], a[160:163], v[216:219], v[24:27]
  v_mul_f32 v23, v246, v23
  v_cvt_pk_bf16_f32 v164, v20, v21
  v_mfma_f32_16x16x32_bf16 v[24:27], a[192:195], v[228:231], v[24:27]
  v_cvt_pk_bf16_f32 v165, v22, v23
  v_mul_f32 v32, v246, v32
  v_mfma_f32_16x16x32_bf16 v[36:39], a[164:167], v[216:219], v[36:39]
  v_mul_f32 v33, v246, v33
  v_mul_f32 v34, v246, v34
  v_mfma_f32_16x16x32_bf16 v[36:39], a[196:199], v[228:231], v[36:39]
  v_accvgpr_read_b32 v249, a56
  v_mul_f32 v35, v246, v35
  v_mfma_f32_16x16x32_bf16 v[48:51], a[168:171], v[216:219], v[48:51]
  v_rcp_f32 v248, v249
  v_mfma_f32_16x16x32_bf16 v[48:51], a[200:203], v[228:231], v[48:51]
  v_cvt_pk_bf16_f32 v166, v32, v33
  v_cvt_pk_bf16_f32 v167, v34, v35
  v_mfma_f32_16x16x32_bf16 v[60:63], a[172:175], v[216:219], v[60:63]
  buffer_store_dwordx4 v[164:167], v1, s[28:31], 0 offen offset:1024 sc1
  v_mfma_f32_16x16x32_bf16 v[60:63], a[204:207], v[228:231], v[60:63]
  v_mul_f32 v44, v246, v44
  v_mul_f32 v45, v246, v45
  v_mfma_f32_16x16x32_bf16 v[72:75], a[176:179], v[216:219], v[72:75]
  v_mul_f32 v46, v246, v46
  v_mul_f32 v47, v246, v47
  v_mfma_f32_16x16x32_bf16 v[72:75], a[208:211], v[228:231], v[72:75]
  v_cvt_pk_bf16_f32 v176, v44, v45
  v_cvt_pk_bf16_f32 v177, v46, v47
  v_mfma_f32_16x16x32_bf16 v[84:87], a[180:183], v[216:219], v[84:87]
  v_mul_f32 v56, v246, v56
  v_mul_f32 v57, v246, v57
  v_mfma_f32_16x16x32_bf16 v[84:87], a[212:215], v[228:231], v[84:87]
  v_mul_f32 v58, v246, v58
  v_mul_f32 v59, v246, v59
  v_mfma_f32_16x16x32_bf16 v[96:99], a[184:187], v[216:219], v[96:99]
  v_cvt_pk_bf16_f32 v178, v56, v57
  v_cvt_pk_bf16_f32 v179, v58, v59
  v_mfma_f32_16x16x32_bf16 v[96:99], a[216:219], v[228:231], v[96:99]
  buffer_store_dwordx4 v[176:179], v1, s[28:31], s56 offen offset:0 sc1
  v_mfma_f32_16x16x32_bf16 v[108:111], a[188:191], v[216:219], v[108:111]
  v_mul_f32 v68, v246, v68
  v_mul_f32 v69, v246, v69
  v_mfma_f32_16x16x32_bf16 v[108:111], a[220:223], v[228:231], v[108:111]
  v_pk_mul_f32 v[70:71], v[70:71], v[246:247] op_sel_hi:[1,0]
  v_cvt_pk_bf16_f32 v188, v68, v69
  v_cvt_pk_bf16_f32 v189, v70, v71
  v_pk_mul_f32 v[80:81], v[80:81], v[246:247] op_sel_hi:[1,0]
  v_pk_mul_f32 v[82:83], v[82:83], v[246:247] op_sel_hi:[1,0]
  v_cvt_pk_bf16_f32 v190, v80, v81
  v_cvt_pk_bf16_f32 v191, v82, v83
  buffer_store_dwordx4 v[188:191], v1, s[28:31], s56 offen offset:3072 sc1
  v_pk_mul_f32 v[92:93], v[92:93], v[246:247] op_sel_hi:[1,0]
  v_pk_mul_f32 v[94:95], v[94:95], v[246:247] op_sel_hi:[1,0]
  v_cvt_pk_bf16_f32 v200, v92, v93
  v_cvt_pk_bf16_f32 v201, v94, v95
  v_pk_mul_f32 v[104:105], v[104:105], v[246:247] op_sel_hi:[1,0]
  v_pk_mul_f32 v[106:107], v[106:107], v[246:247] op_sel_hi:[1,0]
  v_cvt_pk_bf16_f32 v202, v104, v105
  v_cvt_pk_bf16_f32 v203, v106, v107
  buffer_store_dwordx4 v[200:203], v1, s[28:31], s57 offen offset:2048 sc1
  v_pk_mul_f32 v[24:25], v[24:25], v[248:249] op_sel_hi:[1,0]
  v_pk_mul_f32 v[26:27], v[26:27], v[248:249] op_sel_hi:[1,0]
  v_cvt_pk_bf16_f32 v168, v24, v25
  v_cvt_pk_bf16_f32 v169, v26, v27
  v_pk_mul_f32 v[36:37], v[36:37], v[248:249] op_sel_hi:[1,0]
  v_pk_mul_f32 v[38:39], v[38:39], v[248:249] op_sel_hi:[1,0]
  v_cvt_pk_bf16_f32 v170, v36, v37
  v_cvt_pk_bf16_f32 v171, v38, v39
  buffer_store_dwordx4 v[168:171], v1, s[28:31], 0 offen offset:2048 sc1
  v_pk_mul_f32 v[48:49], v[48:49], v[248:249] op_sel_hi:[1,0]
  v_pk_mul_f32 v[50:51], v[50:51], v[248:249] op_sel_hi:[1,0]
  v_cvt_pk_bf16_f32 v180, v48, v49
  v_cvt_pk_bf16_f32 v181, v50, v51
  v_pk_mul_f32 v[60:61], v[60:61], v[248:249] op_sel_hi:[1,0]
  v_pk_mul_f32 v[62:63], v[62:63], v[248:249] op_sel_hi:[1,0]
  v_cvt_pk_bf16_f32 v182, v60, v61
  v_cvt_pk_bf16_f32 v183, v62, v63
  buffer_store_dwordx4 v[180:183], v1, s[28:31], s56 offen offset:1024 sc1
  v_pk_mul_f32 v[72:73], v[72:73], v[248:249] op_sel_hi:[1,0]
  v_pk_mul_f32 v[74:75], v[74:75], v[248:249] op_sel_hi:[1,0]
  v_cvt_pk_bf16_f32 v192, v72, v73
  v_cvt_pk_bf16_f32 v193, v74, v75
  v_pk_mul_f32 v[84:85], v[84:85], v[248:249] op_sel_hi:[1,0]
  v_pk_mul_f32 v[86:87], v[86:87], v[248:249] op_sel_hi:[1,0]
  v_cvt_pk_bf16_f32 v194, v84, v85
  v_cvt_pk_bf16_f32 v195, v86, v87
  buffer_store_dwordx4 v[192:195], v1, s[28:31], s57 offen offset:0 sc1
  v_pk_mul_f32 v[96:97], v[96:97], v[248:249] op_sel_hi:[1,0]
  v_pk_mul_f32 v[98:99], v[98:99], v[248:249] op_sel_hi:[1,0]
  v_cvt_pk_bf16_f32 v204, v96, v97
  v_cvt_pk_bf16_f32 v205, v98, v99
  v_pk_mul_f32 v[108:109], v[108:109], v[248:249] op_sel_hi:[1,0]
  v_pk_mul_f32 v[110:111], v[110:111], v[248:249] op_sel_hi:[1,0]
  v_cvt_pk_bf16_f32 v206, v108, v109
  v_cvt_pk_bf16_f32 v207, v110, v111
  buffer_store_dwordx4 v[204:207], v1, s[28:31], s57 offen offset:3072 sc1
  v_subrev_u32 v232, 0x30800000, v245
  v_subrev_u32 v233, 0x30800000, v247
  v_subrev_u32 v234, 0x30800000, v249
  v_max3_u32 v232, v232, v233, v234
  v_cmp_lt_u32 vcc, 0x1e000000, v232
  s_nop 3
  s_or_b32 s7, vcc_lo, vcc_hi
  v_mov_b32 v233, s7
  s_lshl_b32 s58, s3, 2
  s_add_u32 s58, s58, 98304
  v_mov_b32 v234, s58
  v_mov_b32 v235, 98304
  ds_write_b32 v234, v233
  s_waitcnt lgkmcnt(0)
  s_barrier
  ds_read_b128 v[236:239], v235
  s_waitcnt lgkmcnt(0)
  v_or3_b32 v236, v236, v237, v238
  v_or_b32 v236, v236, v239
  s_nop 0
  v_readfirstlane_b32 s62, v236
  s_nop 3
  s_cmp_lg_u32 s62, 0
  s_cbranch_scc1 L_redo
  L_stored:
  s_and_b32 s54, s2, 7
  s_lshl_b32 s55, s54, 5
  v_lshrrev_b32 v244, 8, v1
  v_mul_u32_u24 v244, 3072, v244
  v_subrev_u32 v244, 16384, v244
  v_sub_u32 v8, v8, v244
  v_xor_b32 v8, s55, v8
  s_waitcnt vmcnt(12)
  s_barrier
  ds_read_b64_tr_b16 a[0:1], v8 offset:0
  ds_read_b64_tr_b16 a[2:3], v8 offset:4096
  v_sub_u32 v9, v9, v244
  v_xor_b32 v9, s55, v9
  s_waitcnt lgkmcnt(0)
  v_mfma_f32_16x16x32_bf16 v[16:19], a[0:3], v[160:163], 0
  s_add_u32 s16, s74, s63
  ds_read_b64_tr_b16 a[4:5], v8 offset:8192
  ds_read_b64_tr_b16 a[6:7], v8 offset:12288
  ds_read_b64_tr_b16 a[8:9], v8 offset:16384
  ds_read_b64_tr_b16 a[10:11], v8 offset:20480
  ds_read_b64_tr_b16 a[12:13], v8 offset:24576
  ds_read_b64_tr_b16 a[14:15], v8 offset:28672
  ds_read_b64_tr_b16 a[16:17], v9 offset:0
  ds_read_b64_tr_b16 a[18:19], v9 offset:4096
  s_waitcnt lgkmcnt(6)
  v_mfma_f32_16x16x32_bf16 v[16:19], a[4:7], v[172:175], v[16:19]
  s_addc_u32 s17, s75, 0
  ds_read_b64_tr_b16 a[20:21], v9 offset:8192
  ds_read_b64_tr_b16 a[22:23], v9 offset:12288
  v_mov_b32 v249, 1
  s_waitcnt lgkmcnt(6)
  v_mfma_f32_16x16x32_bf16 v[16:19], a[8:11], v[184:187], v[16:19]
  s_waitcnt lgkmcnt(4)
  s_sub_u32 s18, 1572864, s63
  ds_read_b64_tr_b16 a[24:25], v9 offset:16384
  ds_read_b64_tr_b16 a[26:27], v9 offset:20480
  v_mfma_f32_16x16x32_bf16 v[16:19], a[12:15], v[196:199], v[16:19]
  s_mov_b32 s19, 0x20000
  ds_read_b64_tr_b16 a[28:29], v9 offset:24576
  ds_read_b64_tr_b16 a[30:31], v9 offset:28672
  v_mfma_f32_16x16x32_bf16 v[20:23], a[0:3], v[164:167], 0
  s_mov_b32 s52, 16384
  v_sub_u32 v10, v10, v244
  v_xor_b32 v10, s55, v10
  v_mfma_f32_16x16x32_bf16 v[20:23], a[4:7], v[176:179], v[20:23]
  s_mov_b32 s53, 32768
  ds_read_b64_tr_b16 a[32:33], v10 offset:0
  v_sub_u32 v11, v11, v244
  v_mfma_f32_16x16x32_bf16 v[20:23], a[8:11], v[188:191], v[20:23]
  s_bfe_u32 s7, s2, 0x50003
  ds_read_b64_tr_b16 a[34:35], v10 offset:4096
  v_xor_b32 v11, s55, v11
  v_mfma_f32_16x16x32_bf16 v[20:23], a[12:15], v[200:203], v[20:23]
  s_lshl_b32 s7, s7, 2
  ds_read_b64_tr_b16 a[36:37], v10 offset:8192
  v_sub_u32 v12, v12, v244
  v_mfma_f32_16x16x32_bf16 v[24:27], a[0:3], v[168:171], 0
  s_add_u32 s7, s7, s3
  ds_read_b64_tr_b16 a[38:39], v10 offset:12288
  v_xor_b32 v12, s55, v12
  v_mfma_f32_16x16x32_bf16 v[24:27], a[4:7], v[180:183], v[24:27]
  s_lshl_b32 s7, s7, 3
  ds_read_b64_tr_b16 a[40:41], v10 offset:16384
  v_sub_u32 v13, v13, v244
  v_mfma_f32_16x16x32_bf16 v[24:27], a[8:11], v[192:195], v[24:27]
  s_add_u32 s7, s7, s54
  ds_read_b64_tr_b16 a[42:43], v10 offset:20480
  v_xor_b32 v13, s55, v13
  v_mfma_f32_16x16x32_bf16 v[24:27], a[12:15], v[204:207], v[24:27]
  s_waitcnt lgkmcnt(3)
  s_add_u32 s7, s7, 1024
  ds_read_b64_tr_b16 a[44:45], v10 offset:24576
  v_sub_u32 v14, v14, v244
  v_mfma_f32_16x16x32_bf16 v[28:31], a[16:19], v[160:163], 0
  s_lshl_b32 s7, s7, 7
  ds_read_b64_tr_b16 a[46:47], v10 offset:28672
  v_xor_b32 v14, s55, v14
  v_mfma_f32_16x16x32_bf16 v[28:31], a[20:23], v[172:175], v[28:31]
  ds_read_b64_tr_b16 a[48:49], v11 offset:0
  v_sub_u32 v15, v15, v244
  v_mfma_f32_16x16x32_bf16 v[28:31], a[24:27], v[184:187], v[28:31]
  ds_read_b64_tr_b16 a[50:51], v11 offset:4096
  v_xor_b32 v15, s55, v15
  v_mfma_f32_16x16x32_bf16 v[28:31], a[28:31], v[196:199], v[28:31]
  ds_read_b64_tr_b16 a[52:53], v11 offset:8192
  v_bfe_u32 v7, v0, 4, 2
  v_mfma_f32_16x16x32_bf16 v[32:35], a[16:19], v[164:167], 0
  ds_read_b64_tr_b16 a[54:55], v11 offset:12288
  v_bfe_u32 v246, v0, 2, 2
  v_mfma_f32_16x16x32_bf16 v[32:35], a[20:23], v[176:179], v[32:35]
  ds_read_b64_tr_b16 a[56:57], v11 offset:16384
  v_sub_u32 v246, v7, v246
  v_mfma_f32_16x16x32_bf16 v[32:35], a[24:27], v[188:191], v[32:35]
  ds_read_b64_tr_b16 a[58:59], v11 offset:20480
  v_bfe_u32 v247, v0, 1, 1
  v_mfma_f32_16x16x32_bf16 v[32:35], a[28:31], v[200:203], v[32:35]
  ds_read_b64_tr_b16 a[60:61], v11 offset:24576
  v_lshl_add_u32 v246, v246, 1, v247
  v_mfma_f32_16x16x32_bf16 v[36:39], a[16:19], v[168:171], 0
  ds_read_b64_tr_b16 a[62:63], v11 offset:28672
  v_and_b32 v247, 1, v0
  v_mfma_f32_16x16x32_bf16 v[36:39], a[20:23], v[180:183], v[36:39]
  v_lshlrev_b32 v247, 4, v247
  v_mov_b32 v248, 0x3f80
  v_mfma_f32_16x16x32_bf16 v[36:39], a[24:27], v[192:195], v[36:39]
  ds_read_b64_tr_b16 a[0:1], v12 offset:0
  v_lshlrev_b32 v247, v247, v248
  v_mfma_f32_16x16x32_bf16 v[36:39], a[28:31], v[204:207], v[36:39]
  ds_read_b64_tr_b16 a[2:3], v12 offset:4096
  v_cmp_eq_u32 vcc, 0, v246
  v_mfma_f32_16x16x32_bf16 v[40:43], a[32:35], v[160:163], 0
  s_waitcnt lgkmcnt(3)
  ds_read_b64_tr_b16 a[4:5], v12 offset:8192
  v_cndmask_b32 v248, 0, v247, vcc
  v_mfma_f32_16x16x32_bf16 v[40:43], a[36:39], v[172:175], v[40:43]
  ds_read_b64_tr_b16 a[6:7], v12 offset:12288
  v_accvgpr_write_b32 a208, v248
  v_mfma_f32_16x16x32_bf16 v[40:43], a[40:43], v[184:187], v[40:43]
  ds_read_b64_tr_b16 a[8:9], v12 offset:16384
  v_cmp_eq_u32 vcc, 1, v246
  v_mfma_f32_16x16x32_bf16 v[40:43], a[44:47], v[196:199], v[40:43]
  v_mov_b32 v246, 1
  v_cndmask_b32 v248, 0, v247, vcc
  v_mfma_f32_16x16x32_bf16 v[44:47], a[32:35], v[164:167], 0
  v_mov_b32 v247, 1
  v_accvgpr_write_b32 a209, v248
  v_mfma_f32_16x16x32_bf16 v[44:47], a[36:39], v[176:179], v[44:47]
  v_mov_b32 v248, 1
  v_lshrrev_b32 v5, 7, v1
  v_mfma_f32_16x16x32_bf16 v[44:47], a[40:43], v[188:191], v[44:47]
  ds_read_b64_tr_b16 a[10:11], v12 offset:20480
  v_lshl_add_u32 v5, v5, 20, s7
  s_bfe_u32 s7, s2, 0x50003
  v_mfma_f32_16x16x32_bf16 v[44:47], a[44:47], v[200:203], v[44:47]
  s_lshl_b32 s7, s7, 2
  ds_read_b64_tr_b16 a[12:13], v12 offset:24576
  v_and_b32 v4, 15, v0
  v_mfma_f32_16x16x32_bf16 v[48:51], a[32:35], v[168:171], 0
  s_add_u32 s7, s7, s3
  ds_read_b64_tr_b16 a[14:15], v12 offset:28672
  v_lshlrev_b32 v4, 10, v4
  v_mfma_f32_16x16x32_bf16 v[48:51], a[36:39], v[180:183], v[48:51]
  s_lshl_b32 s7, s7, 3
  v_lshl_add_u32 v4, v7, 3, v4
  v_lshrrev_b32 v7, 1, v1
  v_mfma_f32_16x16x32_bf16 v[48:51], a[40:43], v[192:195], v[48:51]
  s_add_u32 s7, s7, 1024
  ds_read_b64_tr_b16 a[16:17], v13 offset:0
  v_add_u32 v5, v5, v1
  v_mfma_f32_16x16x32_bf16 v[48:51], a[44:47], v[204:207], v[48:51]
  s_lshl_b32 s7, s7, 7
  ds_read_b64_tr_b16 a[18:19], v13 offset:4096
  v_lshrrev_b32 v6, 7, v1
  v_mfma_f32_16x16x32_bf16 v[52:55], a[48:51], v[160:163], 0
  ds_read_b64_tr_b16 a[20:21], v13 offset:8192
  v_lshl_add_u32 v6, v6, 20, s7
  v_mfma_f32_16x16x32_bf16 v[52:55], a[52:55], v[172:175], v[52:55]
  ds_read_b64_tr_b16 a[22:23], v13 offset:12288
  v_lshl_add_u32 v6, v1, 3, v6
  v_mfma_f32_16x16x32_bf16 v[52:55], a[56:59], v[184:187], v[52:55]
  s_waitcnt lgkmcnt(3)
  ds_read_b64_tr_b16 a[24:25], v13 offset:16384
  v_mfma_f32_16x16x32_bf16 v[52:55], a[60:63], v[196:199], v[52:55]
  ds_read_b64_tr_b16 a[26:27], v13 offset:20480
  v_mfma_f32_16x16x32_bf16 v[56:59], a[48:51], v[164:167], 0
  ds_read_b64_tr_b16 a[28:29], v13 offset:24576
  v_mfma_f32_16x16x32_bf16 v[56:59], a[52:55], v[176:179], v[56:59]
  ds_read_b64_tr_b16 a[30:31], v13 offset:28672
  v_mfma_f32_16x16x32_bf16 v[56:59], a[56:59], v[188:191], v[56:59]
  v_mfma_f32_16x16x32_bf16 v[56:59], a[60:63], v[200:203], v[56:59]
  v_mfma_f32_16x16x32_bf16 v[60:63], a[48:51], v[168:171], 0
  v_mfma_f32_16x16x32_bf16 v[60:63], a[52:55], v[180:183], v[60:63]
  v_mfma_f32_16x16x32_bf16 v[60:63], a[56:59], v[192:195], v[60:63]
  ds_read_b64_tr_b16 a[32:33], v14 offset:0
  v_mfma_f32_16x16x32_bf16 v[60:63], a[60:63], v[204:207], v[60:63]
  ds_read_b64_tr_b16 a[34:35], v14 offset:4096
  v_mfma_f32_16x16x32_bf16 v[64:67], a[0:3], v[160:163], 0
  ds_read_b64_tr_b16 a[36:37], v14 offset:8192
  v_mfma_f32_16x16x32_bf16 v[64:67], a[4:7], v[172:175], v[64:67]
  ds_read_b64_tr_b16 a[38:39], v14 offset:12288
  v_mfma_f32_16x16x32_bf16 v[64:67], a[8:11], v[184:187], v[64:67]
  ds_read_b64_tr_b16 a[40:41], v14 offset:16384
  v_mfma_f32_16x16x32_bf16 v[64:67], a[12:15], v[196:199], v[64:67]
  ds_read_b64_tr_b16 a[42:43], v14 offset:20480
  v_mfma_f32_16x16x32_bf16 v[68:71], a[0:3], v[164:167], 0
  ds_read_b64_tr_b16 a[44:45], v14 offset:24576
  v_mfma_f32_16x16x32_bf16 v[68:71], a[4:7], v[176:179], v[68:71]
  ds_read_b64_tr_b16 a[46:47], v14 offset:28672
  v_mfma_f32_16x16x32_bf16 v[68:71], a[8:11], v[188:191], v[68:71]
  v_mfma_f32_16x16x32_bf16 v[68:71], a[12:15], v[200:203], v[68:71]
  v_mfma_f32_16x16x32_bf16 v[72:75], a[0:3], v[168:171], 0
  v_mfma_f32_16x16x32_bf16 v[72:75], a[4:7], v[180:183], v[72:75]
  v_mfma_f32_16x16x32_bf16 v[72:75], a[8:11], v[192:195], v[72:75]
  ds_read_b64_tr_b16 a[48:49], v15 offset:0
  v_mfma_f32_16x16x32_bf16 v[72:75], a[12:15], v[204:207], v[72:75]
  s_waitcnt lgkmcnt(4)
  ds_read_b64_tr_b16 a[50:51], v15 offset:4096
  v_mfma_f32_16x16x32_bf16 v[76:79], a[16:19], v[160:163], 0
  ds_read_b64_tr_b16 a[52:53], v15 offset:8192
  v_mfma_f32_16x16x32_bf16 v[76:79], a[20:23], v[172:175], v[76:79]
  ds_read_b64_tr_b16 a[54:55], v15 offset:12288
  v_mfma_f32_16x16x32_bf16 v[76:79], a[24:27], v[184:187], v[76:79]
  ds_read_b64_tr_b16 a[56:57], v15 offset:16384
  v_mfma_f32_16x16x32_bf16 v[76:79], a[28:31], v[196:199], v[76:79]
  ds_read_b64_tr_b16 a[58:59], v15 offset:20480
  v_mfma_f32_16x16x32_bf16 v[80:83], a[16:19], v[164:167], 0
  s_waitcnt vmcnt(0)
  buffer_store_dwordx4 v[246:249], v254, s[64:67], s101 offen
  v_mfma_f32_16x16x32_bf16 v[80:83], a[20:23], v[176:179], v[80:83]
  s_lshl_b32 s44, s41, 17
  ds_read_b64_tr_b16 a[60:61], v15 offset:24576
  v_mfma_f32_16x16x32_bf16 v[80:83], a[24:27], v[188:191], v[80:83]
  s_add_u32 s44, s44, 65536
  ds_read_b64_tr_b16 a[62:63], v15 offset:28672
  v_mfma_f32_16x16x32_bf16 v[80:83], a[28:31], v[200:203], v[80:83]
  s_add_u32 m0, s37, 147456
  v_mfma_f32_16x16x32_bf16 v[84:87], a[16:19], v[168:171], 0
  buffer_store_dwordx4 v[246:249], v254, s[64:67], 0 offen sc1
  v_mfma_f32_16x16x32_bf16 v[84:87], a[20:23], v[180:183], v[84:87]
  buffer_load_dwordx4 v250, s[24:27], s44 offen offset:0 lds
  v_mfma_f32_16x16x32_bf16 v[84:87], a[24:27], v[192:195], v[84:87]
  s_add_u32 m0, s37, 147456
  v_mfma_f32_16x16x32_bf16 v[84:87], a[28:31], v[204:207], v[84:87]
  buffer_load_dwordx4 v251, s[24:27], s44 offen offset:1024 lds
  v_mfma_f32_16x16x32_bf16 v[88:91], a[32:35], v[160:163], 0
  s_add_u32 m0, s37, 147456
  v_mfma_f32_16x16x32_bf16 v[88:91], a[36:39], v[172:175], v[88:91]
  s_waitcnt lgkmcnt(0)
  buffer_load_dwordx4 v252, s[24:27], s44 offen offset:2048 lds
  v_mfma_f32_16x16x32_bf16 v[88:91], a[40:43], v[184:187], v[88:91]
  s_add_u32 m0, s37, 147456
  v_mfma_f32_16x16x32_bf16 v[88:91], a[44:47], v[196:199], v[88:91]
  v_mfma_f32_16x16x32_bf16 v[92:95], a[32:35], v[164:167], 0
  buffer_load_dwordx4 v253, s[24:27], s44 offen offset:3072 lds
  v_mfma_f32_16x16x32_bf16 v[92:95], a[36:39], v[176:179], v[92:95]
  s_lshl_b32 s44, s42, 17
  v_mfma_f32_16x16x32_bf16 v[92:95], a[40:43], v[188:191], v[92:95]
  s_add_u32 s44, s44, 65536
  v_mfma_f32_16x16x32_bf16 v[92:95], a[44:47], v[200:203], v[92:95]
  s_add_u32 m0, s37, 114688
  v_mfma_f32_16x16x32_bf16 v[96:99], a[32:35], v[168:171], 0
  buffer_load_dwordx4 v250, s[24:27], s44 offen offset:0 lds
  v_mfma_f32_16x16x32_bf16 v[96:99], a[36:39], v[180:183], v[96:99]
  s_add_u32 m0, s37, 114688
  v_mfma_f32_16x16x32_bf16 v[96:99], a[40:43], v[192:195], v[96:99]
  buffer_load_dwordx4 v251, s[24:27], s44 offen offset:1024 lds
  v_mfma_f32_16x16x32_bf16 v[96:99], a[44:47], v[204:207], v[96:99]
  s_add_u32 m0, s37, 114688
  v_mfma_f32_16x16x32_bf16 v[100:103], a[48:51], v[160:163], 0
  v_mfma_f32_16x16x32_bf16 v[100:103], a[52:55], v[172:175], v[100:103]
  buffer_load_dwordx4 v252, s[24:27], s44 offen offset:2048 lds
  v_mfma_f32_16x16x32_bf16 v[100:103], a[56:59], v[184:187], v[100:103]
  s_add_u32 m0, s37, 114688
  v_mfma_f32_16x16x32_bf16 v[100:103], a[60:63], v[196:199], v[100:103]
  v_mfma_f32_16x16x32_bf16 v[104:107], a[48:51], v[164:167], 0
  buffer_load_dwordx4 v253, s[24:27], s44 offen offset:3072 lds
  v_mfma_f32_16x16x32_bf16 v[104:107], a[52:55], v[176:179], v[104:107]
  s_lshl_b32 s44, s43, 17
  v_mfma_f32_16x16x32_bf16 v[104:107], a[56:59], v[188:191], v[104:107]
  s_add_u32 s44, s44, 65536
  v_mfma_f32_16x16x32_bf16 v[104:107], a[60:63], v[200:203], v[104:107]
  s_add_u32 m0, s37, 98304
  v_mfma_f32_16x16x32_bf16 v[108:111], a[48:51], v[168:171], 0
  buffer_load_dwordx4 v250, s[24:27], s44 offen offset:0 lds
  v_mfma_f32_16x16x32_bf16 v[108:111], a[52:55], v[180:183], v[108:111]
  s_add_u32 m0, s37, 98304
  v_mfma_f32_16x16x32_bf16 v[108:111], a[56:59], v[192:195], v[108:111]
  buffer_load_dwordx4 v251, s[24:27], s44 offen offset:1024 lds
  v_mfma_f32_16x16x32_bf16 v[108:111], a[60:63], v[204:207], v[108:111]
  s_add_u32 m0, s37, 98304
  s_nop 0
  buffer_load_dwordx4 v252, s[24:27], s44 offen offset:2048 lds
  s_add_u32 m0, s37, 98304
  s_nop 0
  buffer_load_dwordx4 v253, s[24:27], s44 offen offset:3072 lds
  s_mov_b32 s58, 0
  L_poll1:
  buffer_load_dword v245, v255, s[64:67], s101 offen sc1
  s_waitcnt vmcnt(0)
  v_cmp_eq_u32 vcc, 1, v245
  s_nop 3
  s_cmp_eq_u32 vcc_lo, 0xf
  s_cbranch_scc1 L_go1
  buffer_load_dword v245, v255, s[64:67], s101 offen sc1
  s_waitcnt vmcnt(0)
  v_cmp_eq_u32 vcc, 1, v245
  s_nop 3
  s_cmp_eq_u32 vcc_lo, 0xf
  s_cbranch_scc1 L_go1
  buffer_load_dword v245, v255, s[64:67], 0 offen sc1
  s_waitcnt vmcnt(0)
  v_cmp_eq_u32 vcc, 1, v245
  s_nop 3
  s_cmp_eq_u32 vcc_lo, 0xf
  s_cbranch_scc1 L_go1
  s_add_u32 s58, s58, 1
  s_cmp_lt_u32 s58, 200000
  s_cbranch_scc1 L_poll1
L_go1:
  s_mul_i32 s41, s41, 49152
  s_mul_i32 s42, s42, 49152
  s_mul_i32 s43, s43, 49152
  buffer_load_dwordx4 a[64:67], v1, s[8:11], s41 offen offset:0 sc1
  buffer_load_dwordx4 a[68:71], v1, s[8:11], s41 offen offset:1024 sc1
  buffer_load_dwordx4 a[72:75], v1, s[8:11], s41 offen offset:2048 sc1
  buffer_load_dwordx4 a[112:115], v1, s[8:11], s42 offen offset:0 sc1
  buffer_load_dwordx4 a[116:119], v1, s[8:11], s42 offen offset:1024 sc1
  buffer_load_dwordx4 a[120:123], v1, s[8:11], s42 offen offset:2048 sc1
  buffer_load_dwordx4 a[160:163], v1, s[8:11], s43 offen offset:0 sc1
  buffer_load_dwordx4 a[164:167], v1, s[8:11], s43 offen offset:1024 sc1
  buffer_load_dwordx4 a[168:171], v1, s[8:11], s43 offen offset:2048 sc1
  s_add_u32 s45, s41, 3072
  buffer_load_dwordx4 a[76:79], v1, s[8:11], s45 offen offset:0 sc1
  buffer_load_dwordx4 a[80:83], v1, s[8:11], s45 offen offset:1024 sc1
  buffer_load_dwordx4 a[84:87], v1, s[8:11], s45 offen offset:2048 sc1
  s_barrier
  ds_read_b64_tr_b16 a[0:1], v9 offset:32768
  ds_read_b64_tr_b16 a[2:3], v9 offset:36864
  ds_read_b64_tr_b16 a[4:5], v10 offset:32768
  ds_read_b64_tr_b16 a[6:7], v10 offset:36864
  ds_read_b64_tr_b16 a[8:9], v11 offset:32768
  ds_read_b64_tr_b16 a[10:11], v11 offset:36864
  ds_read_b64_tr_b16 a[12:13], v12 offset:32768
  ds_read_b64_tr_b16 a[14:15], v12 offset:36864
  s_waitcnt vmcnt(11) lgkmcnt(6)
  v_mfma_f32_16x16x32_bf16 v[28:31], a[0:3], a[64:67], v[28:31]
  s_add_u32 s45, s42, 3072
  ds_read_b64_tr_b16 a[16:17], v13 offset:32768
  ds_read_b64_tr_b16 a[18:19], v13 offset:36864
  s_waitcnt vmcnt(10)
  v_mfma_f32_16x16x32_bf16 v[32:35], a[0:3], a[68:71], v[32:35]
  ds_read_b64_tr_b16 a[20:21], v14 offset:32768
  ds_read_b64_tr_b16 a[22:23], v14 offset:36864
  s_waitcnt vmcnt(9)
  v_mfma_f32_16x16x32_bf16 v[36:39], a[0:3], a[72:75], v[36:39]
  s_waitcnt lgkmcnt(5)
  buffer_load_dwordx4 a[124:127], v1, s[8:11], s45 offen offset:0 sc1
  v_mfma_f32_16x16x32_bf16 v[40:43], a[4:7], a[64:67], v[40:43]
  ds_read_b64_tr_b16 a[24:25], v15 offset:32768
  ds_read_b64_tr_b16 a[26:27], v15 offset:36864
  v_mfma_f32_16x16x32_bf16 v[44:47], a[4:7], a[68:71], v[44:47]
  ds_read_b64_tr_b16 a[28:29], v9 offset:49152
  v_mfma_f32_16x16x32_bf16 v[48:51], a[4:7], a[72:75], v[48:51]
  ds_read_b64_tr_b16 a[30:31], v9 offset:53248
  v_add_u32 v9, 65536, v9
  v_mfma_f32_16x16x32_bf16 v[52:55], a[8:11], a[64:67], v[52:55]
  ds_read_b64_tr_b16 a[32:33], v10 offset:49152
  v_mfma_f32_16x16x32_bf16 v[56:59], a[8:11], a[68:71], v[56:59]
  buffer_load_dwordx4 a[128:131], v1, s[8:11], s45 offen offset:1024 sc1
  v_mfma_f32_16x16x32_bf16 v[60:63], a[8:11], a[72:75], v[60:63]
  s_waitcnt lgkmcnt(5)
  ds_read_b64_tr_b16 a[34:35], v10 offset:53248
  v_add_u32 v10, 65536, v10
  v_mfma_f32_16x16x32_bf16 v[64:67], a[12:15], a[64:67], v[64:67]
  ds_read_b64_tr_b16 a[36:37], v11 offset:49152
  v_mfma_f32_16x16x32_bf16 v[68:71], a[12:15], a[68:71], v[68:71]
  ds_read_b64_tr_b16 a[38:39], v11 offset:53248
  v_add_u32 v11, 65536, v11
  v_mfma_f32_16x16x32_bf16 v[72:75], a[12:15], a[72:75], v[72:75]
  ds_read_b64_tr_b16 a[40:41], v12 offset:49152
  v_mfma_f32_16x16x32_bf16 v[76:79], a[16:19], a[64:67], v[76:79]
  buffer_load_dwordx4 a[132:135], v1, s[8:11], s45 offen offset:2048 sc1
  v_mfma_f32_16x16x32_bf16 v[80:83], a[16:19], a[68:71], v[80:83]
  s_add_u32 s45, s43, 3072
  ds_read_b64_tr_b16 a[42:43], v12 offset:53248
  v_add_u32 v12, 65536, v12
  v_mfma_f32_16x16x32_bf16 v[84:87], a[16:19], a[72:75], v[84:87]
  ds_read_b64_tr_b16 a[44:45], v13 offset:49152
  v_mfma_f32_16x16x32_bf16 v[88:91], a[20:23], a[64:67], v[88:91]
  ds_read_b64_tr_b16 a[46:47], v13 offset:53248
  v_add_u32 v13, 65536, v13
  v_mfma_f32_16x16x32_bf16 v[92:95], a[20:23], a[68:71], v[92:95]
  ds_read_b64_tr_b16 a[48:49], v14 offset:49152
  v_mfma_f32_16x16x32_bf16 v[96:99], a[20:23], a[72:75], v[96:99]
  s_waitcnt lgkmcnt(4)
  buffer_load_dwordx4 a[172:175], v1, s[8:11], s45 offen offset:0 sc1
  v_mfma_f32_16x16x32_bf16 v[100:103], a[24:27], a[64:67], v[100:103]
  ds_read_b64_tr_b16 a[50:51], v14 offset:53248
  v_add_u32 v14, 65536, v14
  v_mfma_f32_16x16x32_bf16 v[104:107], a[24:27], a[68:71], v[104:107]
  ds_read_b64_tr_b16 a[52:53], v15 offset:49152
  v_mfma_f32_16x16x32_bf16 v[108:111], a[24:27], a[72:75], v[108:111]
  ds_read_b64_tr_b16 a[54:55], v15 offset:53248
  v_add_u32 v15, 65536, v15
  s_waitcnt vmcnt(12)
  v_mfma_f32_16x16x32_bf16 v[28:31], a[28:31], a[112:115], v[28:31]
  ds_read_b64_tr_b16 a[56:57], v9 offset:32768
  s_waitcnt vmcnt(11)
  v_mfma_f32_16x16x32_bf16 v[32:35], a[28:31], a[116:119], v[32:35]
  buffer_load_dwordx4 a[176:179], v1, s[8:11], s45 offen offset:1024 sc1
  s_waitcnt vmcnt(11)
  v_mfma_f32_16x16x32_bf16 v[36:39], a[28:31], a[120:123], v[36:39]
  ds_read_b64_tr_b16 a[58:59], v9 offset:36864
  v_add_u32 v9, -65536, v9
  v_mfma_f32_16x16x32_bf16 v[40:43], a[32:35], a[112:115], v[40:43]
  ds_read_b64_tr_b16 a[60:61], v10 offset:32768
  v_mfma_f32_16x16x32_bf16 v[44:47], a[32:35], a[116:119], v[44:47]
  ds_read_b64_tr_b16 a[62:63], v10 offset:36864
  v_add_u32 v10, -65536, v10
  v_mfma_f32_16x16x32_bf16 v[48:51], a[32:35], a[120:123], v[48:51]
  ds_read_b64_tr_b16 a[0:1], v11 offset:32768
  v_mfma_f32_16x16x32_bf16 v[52:55], a[36:39], a[112:115], v[52:55]
  buffer_load_dwordx4 a[180:183], v1, s[8:11], s45 offen offset:2048 sc1
  v_mfma_f32_16x16x32_bf16 v[56:59], a[36:39], a[116:119], v[56:59]
  s_add_u32 s45, s41, 6144
  ds_read_b64_tr_b16 a[2:3], v11 offset:36864
  v_add_u32 v11, -65536, v11
  v_mfma_f32_16x16x32_bf16 v[60:63], a[36:39], a[120:123], v[60:63]
  s_waitcnt lgkmcnt(3)
  ds_read_b64_tr_b16 a[4:5], v12 offset:32768
  v_mfma_f32_16x16x32_bf16 v[64:67], a[40:43], a[112:115], v[64:67]
  ds_read_b64_tr_b16 a[6:7], v12 offset:36864
  v_add_u32 v12, -65536, v12
  v_mfma_f32_16x16x32_bf16 v[68:71], a[40:43], a[116:119], v[68:71]
  ds_read_b64_tr_b16 a[8:9], v13 offset:32768
  v_mfma_f32_16x16x32_bf16 v[72:75], a[40:43], a[120:123], v[72:75]
  buffer_load_dwordx4 a[88:91], v1, s[8:11], s45 offen offset:0 sc1
  v_mfma_f32_16x16x32_bf16 v[76:79], a[44:47], a[112:115], v[76:79]
  ds_read_b64_tr_b16 a[10:11], v13 offset:36864
  v_add_u32 v13, -65536, v13
  v_mfma_f32_16x16x32_bf16 v[80:83], a[44:47], a[116:119], v[80:83]
  ds_read_b64_tr_b16 a[12:13], v14 offset:32768
  v_mfma_f32_16x16x32_bf16 v[84:87], a[44:47], a[120:123], v[84:87]
  ds_read_b64_tr_b16 a[14:15], v14 offset:36864
  v_add_u32 v14, -65536, v14
  v_mfma_f32_16x16x32_bf16 v[88:91], a[48:51], a[112:115], v[88:91]
  ds_read_b64_tr_b16 a[16:17], v15 offset:32768
  v_mfma_f32_16x16x32_bf16 v[92:95], a[48:51], a[116:119], v[92:95]
  buffer_load_dwordx4 a[92:95], v1, s[8:11], s45 offen offset:1024 sc1
  v_mfma_f32_16x16x32_bf16 v[96:99], a[48:51], a[120:123], v[96:99]
  ds_read_b64_tr_b16 a[18:19], v15 offset:36864
  v_add_u32 v15, -65536, v15
  v_mfma_f32_16x16x32_bf16 v[100:103], a[52:55], a[112:115], v[100:103]
  ds_read_b64_tr_b16 a[20:21], v9 offset:40960
  v_mfma_f32_16x16x32_bf16 v[104:107], a[52:55], a[116:119], v[104:107]
  ds_read_b64_tr_b16 a[22:23], v9 offset:45056
  v_mfma_f32_16x16x32_bf16 v[108:111], a[52:55], a[120:123], v[108:111]
  ds_read_b64_tr_b16 a[24:25], v9 offset:57344
  s_waitcnt vmcnt(13)
  v_mfma_f32_16x16x32_bf16 v[28:31], a[56:59], a[160:163], v[28:31]
  buffer_load_dwordx4 a[96:99], v1, s[8:11], s45 offen offset:2048 sc1
  s_waitcnt vmcnt(13)
  v_mfma_f32_16x16x32_bf16 v[32:35], a[56:59], a[164:167], v[32:35]
  s_add_u32 s45, s42, 6144
  ds_read_b64_tr_b16 a[26:27], v9 offset:61440
  v_add_u32 v9, 65536, v9
  s_waitcnt vmcnt(12)
  v_mfma_f32_16x16x32_bf16 v[36:39], a[56:59], a[168:171], v[36:39]
  s_waitcnt lgkmcnt(2)
  ds_read_b64_tr_b16 a[28:29], v9 offset:40960
  v_mfma_f32_16x16x32_bf16 v[40:43], a[60:63], a[160:163], v[40:43]
  ds_read_b64_tr_b16 a[30:31], v9 offset:45056
  v_mfma_f32_16x16x32_bf16 v[44:47], a[60:63], a[164:167], v[44:47]
  ds_read_b64_tr_b16 a[32:33], v10 offset:40960
  v_mfma_f32_16x16x32_bf16 v[48:51], a[60:63], a[168:171], v[48:51]
  buffer_load_dwordx4 a[136:139], v1, s[8:11], s45 offen offset:0 sc1
  v_mfma_f32_16x16x32_bf16 v[52:55], a[0:3], a[160:163], v[52:55]
  ds_read_b64_tr_b16 a[34:35], v10 offset:45056
  v_mfma_f32_16x16x32_bf16 v[56:59], a[0:3], a[164:167], v[56:59]
  ds_read_b64_tr_b16 a[36:37], v10 offset:57344
  v_mfma_f32_16x16x32_bf16 v[60:63], a[0:3], a[168:171], v[60:63]
  ds_read_b64_tr_b16 a[38:39], v10 offset:61440
  v_add_u32 v10, 65536, v10
  v_mfma_f32_16x16x32_bf16 v[64:67], a[4:7], a[160:163], v[64:67]
  ds_read_b64_tr_b16 a[40:41], v10 offset:40960
  v_mfma_f32_16x16x32_bf16 v[68:71], a[4:7], a[164:167], v[68:71]
  buffer_load_dwordx4 a[140:143], v1, s[8:11], s45 offen offset:1024 sc1
  v_mfma_f32_16x16x32_bf16 v[72:75], a[4:7], a[168:171], v[72:75]
  ds_read_b64_tr_b16 a[42:43], v10 offset:45056
  v_mfma_f32_16x16x32_bf16 v[76:79], a[8:11], a[160:163], v[76:79]
  v_mfma_f32_16x16x32_bf16 v[80:83], a[8:11], a[164:167], v[80:83]
  ds_read_b64_tr_b16 a[44:45], v11 offset:40960
  v_mfma_f32_16x16x32_bf16 v[84:87], a[8:11], a[168:171], v[84:87]
  ds_read_b64_tr_b16 a[46:47], v11 offset:45056
  v_mfma_f32_16x16x32_bf16 v[88:91], a[12:15], a[160:163], v[88:91]
  buffer_load_dwordx4 a[144:147], v1, s[8:11], s45 offen offset:2048 sc1
  v_mfma_f32_16x16x32_bf16 v[92:95], a[12:15], a[164:167], v[92:95]
  s_add_u32 s45, s43, 6144
  ds_read_b64_tr_b16 a[48:49], v11 offset:57344
  v_mfma_f32_16x16x32_bf16 v[96:99], a[12:15], a[168:171], v[96:99]
  ds_read_b64_tr_b16 a[50:51], v11 offset:61440
  v_add_u32 v11, 65536, v11
  v_mfma_f32_16x16x32_bf16 v[100:103], a[16:19], a[160:163], v[100:103]
  ds_read_b64_tr_b16 a[52:53], v11 offset:40960
  v_mfma_f32_16x16x32_bf16 v[104:107], a[16:19], a[164:167], v[104:107]
  ds_read_b64_tr_b16 a[54:55], v11 offset:45056
  v_mfma_f32_16x16x32_bf16 v[108:111], a[16:19], a[168:171], v[108:111]
  buffer_load_dwordx4 a[184:187], v1, s[8:11], s45 offen offset:0 sc1
  s_waitcnt vmcnt(15)
  v_mfma_f32_16x16x32_bf16 v[28:31], a[20:23], a[76:79], v[28:31]
  s_waitcnt lgkmcnt(4)
  s_waitcnt vmcnt(12)
  v_mfma_f32_16x16x32_bf16 v[28:31], a[24:27], a[124:127], v[28:31]
  ds_read_b64_tr_b16 a[56:57], v12 offset:40960
  s_waitcnt vmcnt(9)
  v_mfma_f32_16x16x32_bf16 v[28:31], a[28:31], a[172:175], v[28:31]
  ds_read_b64_tr_b16 a[58:59], v12 offset:45056
  v_mfma_f32_16x16x32_bf16 v[32:35], a[20:23], a[80:83], v[32:35]
  ds_read_b64_tr_b16 a[60:61], v12 offset:57344
  v_mfma_f32_16x16x32_bf16 v[32:35], a[24:27], a[128:131], v[32:35]
  buffer_load_dwordx4 a[188:191], v1, s[8:11], s45 offen offset:1024 sc1
  s_waitcnt vmcnt(9)
  v_mfma_f32_16x16x32_bf16 v[32:35], a[28:31], a[176:179], v[32:35]
  ds_read_b64_tr_b16 a[62:63], v12 offset:61440
  v_add_u32 v12, 65536, v12
  v_mfma_f32_16x16x32_bf16 v[36:39], a[20:23], a[84:87], v[36:39]
  ds_read_b64_tr_b16 a[0:1], v12 offset:40960
  v_mfma_f32_16x16x32_bf16 v[36:39], a[24:27], a[132:135], v[36:39]
  ds_read_b64_tr_b16 a[2:3], v12 offset:45056
  s_waitcnt vmcnt(8)
  v_mfma_f32_16x16x32_bf16 v[36:39], a[28:31], a[180:183], v[36:39]
  v_mfma_f32_16x16x32_bf16 v[40:43], a[32:35], a[76:79], v[40:43]
  buffer_load_dwordx4 a[192:195], v1, s[8:11], s45 offen offset:2048 sc1
  v_mfma_f32_16x16x32_bf16 v[40:43], a[36:39], a[124:127], v[40:43]
  s_add_u32 s45, s41, 9216
  ds_read_b64_tr_b16 a[4:5], v13 offset:40960
  v_mfma_f32_16x16x32_bf16 v[40:43], a[40:43], a[172:175], v[40:43]
  ds_read_b64_tr_b16 a[6:7], v13 offset:45056
  v_mfma_f32_16x16x32_bf16 v[44:47], a[32:35], a[80:83], v[44:47]
  ds_read_b64_tr_b16 a[8:9], v13 offset:57344
  v_mfma_f32_16x16x32_bf16 v[44:47], a[36:39], a[128:131], v[44:47]
  ds_read_b64_tr_b16 a[10:11], v13 offset:61440
  v_add_u32 v13, 65536, v13
  v_mfma_f32_16x16x32_bf16 v[44:47], a[40:43], a[176:179], v[44:47]
  buffer_load_dwordx4 a[100:103], v1, s[8:11], s45 offen offset:0 sc1
  v_mfma_f32_16x16x32_bf16 v[48:51], a[32:35], a[84:87], v[48:51]
  ds_read_b64_tr_b16 a[12:13], v13 offset:40960
  v_mfma_f32_16x16x32_bf16 v[48:51], a[36:39], a[132:135], v[48:51]
  ds_read_b64_tr_b16 a[14:15], v13 offset:45056
  v_mfma_f32_16x16x32_bf16 v[48:51], a[40:43], a[180:183], v[48:51]
  v_mfma_f32_16x16x32_bf16 v[52:55], a[44:47], a[76:79], v[52:55]
  s_waitcnt lgkmcnt(4)
  v_mfma_f32_16x16x32_bf16 v[52:55], a[48:51], a[124:127], v[52:55]
  buffer_load_dwordx4 a[104:107], v1, s[8:11], s45 offen offset:1024 sc1
  v_mfma_f32_16x16x32_bf16 v[52:55], a[52:55], a[172:175], v[52:55]
  ds_read_b64_tr_b16 a[16:17], v14 offset:40960
  v_mfma_f32_16x16x32_bf16 v[56:59], a[44:47], a[80:83], v[56:59]
  ds_read_b64_tr_b16 a[18:19], v14 offset:45056
  v_mfma_f32_16x16x32_bf16 v[56:59], a[48:51], a[128:131], v[56:59]
  ds_read_b64_tr_b16 a[20:21], v14 offset:57344
  v_mfma_f32_16x16x32_bf16 v[56:59], a[52:55], a[176:179], v[56:59]
  ds_read_b64_tr_b16 a[22:23], v14 offset:61440
  v_add_u32 v14, 65536, v14
  v_mfma_f32_16x16x32_bf16 v[60:63], a[44:47], a[84:87], v[60:63]
  buffer_load_dwordx4 a[108:111], v1, s[8:11], s45 offen offset:2048 sc1
  v_mfma_f32_16x16x32_bf16 v[60:63], a[48:51], a[132:135], v[60:63]
  s_add_u32 s45, s42, 9216
  ds_read_b64_tr_b16 a[24:25], v14 offset:40960
  v_mfma_f32_16x16x32_bf16 v[60:63], a[52:55], a[180:183], v[60:63]
  ds_read_b64_tr_b16 a[26:27], v14 offset:45056
  v_mfma_f32_16x16x32_bf16 v[64:67], a[56:59], a[76:79], v[64:67]
  v_mfma_f32_16x16x32_bf16 v[64:67], a[60:63], a[124:127], v[64:67]
  ds_read_b64_tr_b16 a[28:29], v15 offset:40960
  v_mfma_f32_16x16x32_bf16 v[64:67], a[0:3], a[172:175], v[64:67]
  buffer_load_dwordx4 a[148:151], v1, s[8:11], s45 offen offset:0 sc1
  v_mfma_f32_16x16x32_bf16 v[68:71], a[56:59], a[80:83], v[68:71]
  ds_read_b64_tr_b16 a[30:31], v15 offset:45056
  v_mfma_f32_16x16x32_bf16 v[68:71], a[60:63], a[128:131], v[68:71]
  ds_read_b64_tr_b16 a[32:33], v15 offset:57344
  v_mfma_f32_16x16x32_bf16 v[68:71], a[0:3], a[176:179], v[68:71]
  ds_read_b64_tr_b16 a[34:35], v15 offset:61440
  v_add_u32 v15, 65536, v15
  v_mfma_f32_16x16x32_bf16 v[72:75], a[56:59], a[84:87], v[72:75]
  ds_read_b64_tr_b16 a[36:37], v15 offset:40960
  v_mfma_f32_16x16x32_bf16 v[72:75], a[60:63], a[132:135], v[72:75]
  buffer_load_dwordx4 a[152:155], v1, s[8:11], s45 offen offset:1024 sc1
  v_mfma_f32_16x16x32_bf16 v[72:75], a[0:3], a[180:183], v[72:75]
  ds_read_b64_tr_b16 a[38:39], v15 offset:45056
  v_mfma_f32_16x16x32_bf16 v[76:79], a[4:7], a[76:79], v[76:79]
  s_waitcnt lgkmcnt(4)
  v_mfma_f32_16x16x32_bf16 v[76:79], a[8:11], a[124:127], v[76:79]
  ds_read_b64_tr_b16 a[40:41], v9 offset:49152
  v_mfma_f32_16x16x32_bf16 v[76:79], a[12:15], a[172:175], v[76:79]
  ds_read_b64_tr_b16 a[42:43], v9 offset:53248
  v_mfma_f32_16x16x32_bf16 v[80:83], a[4:7], a[80:83], v[80:83]
  buffer_load_dwordx4 a[156:159], v1, s[8:11], s45 offen offset:2048 sc1
  v_mfma_f32_16x16x32_bf16 v[80:83], a[8:11], a[128:131], v[80:83]
  s_add_u32 s45, s43, 9216
  ds_read_b64_tr_b16 a[44:45], v9 offset:16384
  v_mfma_f32_16x16x32_bf16 v[80:83], a[12:15], a[176:179], v[80:83]
  s_xor_b32 s46, s54, 1
  ds_read_b64_tr_b16 a[46:47], v9 offset:20480
  v_mfma_f32_16x16x32_bf16 v[84:87], a[4:7], a[84:87], v[84:87]
  s_mul_i32 s46, s46, 49152
  ds_read_b64_tr_b16 a[48:49], v9 offset:0
  v_mfma_f32_16x16x32_bf16 v[84:87], a[8:11], a[132:135], v[84:87]
  ds_read_b64_tr_b16 a[50:51], v9 offset:4096
  v_mfma_f32_16x16x32_bf16 v[84:87], a[12:15], a[180:183], v[84:87]
  buffer_load_dwordx4 a[196:199], v1, s[8:11], s45 offen offset:0 sc1
  v_mfma_f32_16x16x32_bf16 v[88:91], a[16:19], a[76:79], v[88:91]
  ds_read_b64_tr_b16 a[52:53], v9 offset:57344
  v_mfma_f32_16x16x32_bf16 v[88:91], a[20:23], a[124:127], v[88:91]
  ds_read_b64_tr_b16 a[54:55], v9 offset:61440
  v_mfma_f32_16x16x32_bf16 v[88:91], a[24:27], a[172:175], v[88:91]
  ds_read_b64_tr_b16 a[56:57], v9 offset:24576
  v_mfma_f32_16x16x32_bf16 v[92:95], a[16:19], a[80:83], v[92:95]
  ds_read_b64_tr_b16 a[58:59], v9 offset:28672
  v_mfma_f32_16x16x32_bf16 v[92:95], a[20:23], a[128:131], v[92:95]
  buffer_load_dwordx4 a[200:203], v1, s[8:11], s45 offen offset:1024 sc1
  v_mfma_f32_16x16x32_bf16 v[92:95], a[24:27], a[176:179], v[92:95]
  ds_read_b64_tr_b16 a[60:61], v9 offset:8192
  v_mfma_f32_16x16x32_bf16 v[96:99], a[16:19], a[84:87], v[96:99]
  ds_read_b64_tr_b16 a[62:63], v9 offset:12288
  v_mfma_f32_16x16x32_bf16 v[96:99], a[20:23], a[132:135], v[96:99]
  v_mfma_f32_16x16x32_bf16 v[96:99], a[24:27], a[180:183], v[96:99]
  v_mfma_f32_16x16x32_bf16 v[100:103], a[28:31], a[76:79], v[100:103]
  s_waitcnt lgkmcnt(4)
  buffer_load_dwordx4 a[204:207], v1, s[8:11], s45 offen offset:2048 sc1
  v_mfma_f32_16x16x32_bf16 v[100:103], a[32:35], a[124:127], v[100:103]
  ds_read_b64_tr_b16 a[0:1], v10 offset:49152
  v_mfma_f32_16x16x32_bf16 v[100:103], a[36:39], a[172:175], v[100:103]
  ds_read_b64_tr_b16 a[2:3], v10 offset:53248
  v_mfma_f32_16x16x32_bf16 v[104:107], a[28:31], a[80:83], v[104:107]
  ds_read_b64_tr_b16 a[4:5], v10 offset:16384
  v_mfma_f32_16x16x32_bf16 v[104:107], a[32:35], a[128:131], v[104:107]
  ds_read_b64_tr_b16 a[6:7], v10 offset:20480
  v_mfma_f32_16x16x32_bf16 v[104:107], a[36:39], a[176:179], v[104:107]
  ds_read_b64_tr_b16 a[8:9], v10 offset:0
  v_mfma_f32_16x16x32_bf16 v[108:111], a[28:31], a[84:87], v[108:111]
  ds_read_b64_tr_b16 a[10:11], v10 offset:4096
  v_mfma_f32_16x16x32_bf16 v[108:111], a[32:35], a[132:135], v[108:111]
  ds_read_b64_tr_b16 a[12:13], v10 offset:57344
  v_mfma_f32_16x16x32_bf16 v[108:111], a[36:39], a[180:183], v[108:111]
  ds_read_b64_tr_b16 a[14:15], v10 offset:61440
  s_waitcnt vmcnt(17)
  v_mfma_f32_16x16x32_bf16 v[28:31], a[40:43], a[88:91], v[28:31]
  ds_read_b64_tr_b16 a[16:17], v10 offset:24576
  s_waitcnt vmcnt(14)
  v_mfma_f32_16x16x32_bf16 v[28:31], a[44:47], a[136:139], v[28:31]
  ds_read_b64_tr_b16 a[18:19], v10 offset:28672
  s_waitcnt vmcnt(11)
  v_mfma_f32_16x16x32_bf16 v[28:31], a[48:51], a[184:187], v[28:31]
  ds_read_b64_tr_b16 a[20:21], v10 offset:8192
  s_waitcnt vmcnt(8)
  v_mfma_f32_16x16x32_bf16 v[28:31], a[52:55], a[100:103], v[28:31]
  s_waitcnt lgkmcnt(4)
  ds_read_b64_tr_b16 a[22:23], v10 offset:12288
  s_waitcnt vmcnt(5)
  v_mfma_f32_16x16x32_bf16 v[28:31], a[56:59], a[148:151], v[28:31]
  s_waitcnt vmcnt(2)
  v_mfma_f32_16x16x32_bf16 v[28:31], a[60:63], a[196:199], v[28:31]
  v_mfma_f32_16x16x32_bf16 v[32:35], a[40:43], a[92:95], v[32:35]
  v_mfma_f32_16x16x32_bf16 v[32:35], a[44:47], a[140:143], v[32:35]
  v_mfma_f32_16x16x32_bf16 v[32:35], a[48:51], a[188:191], v[32:35]
  v_mfma_f32_16x16x32_bf16 v[32:35], a[52:55], a[104:107], v[32:35]
  s_nop 3
  v_cvt_pk_bf16_f32 v112, v28, v29
  v_cvt_pk_bf16_f32 v113, v30, v31
  v_mfma_f32_16x16x32_bf16 v[32:35], a[56:59], a[152:155], v[32:35]
  ds_read_b64_tr_b16 a[24:25], v11 offset:49152
  s_waitcnt vmcnt(1)
  v_mfma_f32_16x16x32_bf16 v[32:35], a[60:63], a[200:203], v[32:35]
  ds_read_b64_tr_b16 a[26:27], v11 offset:53248
  v_mfma_f32_16x16x32_bf16 v[36:39], a[40:43], a[96:99], v[36:39]
  ds_read_b64_tr_b16 a[28:29], v11 offset:16384
  v_mfma_f32_16x16x32_bf16 v[36:39], a[44:47], a[144:147], v[36:39]
  ds_read_b64_tr_b16 a[30:31], v11 offset:20480
  v_mfma_f32_16x16x32_bf16 v[36:39], a[48:51], a[192:195], v[36:39]
  ds_read_b64_tr_b16 a[32:33], v11 offset:0
  v_mfma_f32_16x16x32_bf16 v[36:39], a[52:55], a[108:111], v[36:39]
  v_cvt_pk_bf16_f32 v114, v32, v33
  v_cvt_pk_bf16_f32 v115, v34, v35
  v_mfma_f32_16x16x32_bf16 v[36:39], a[56:59], a[156:159], v[36:39]
  buffer_store_dwordx4 v[112:115], v1, s[32:35], s46 offen sc1
  s_waitcnt vmcnt(1)
  v_mfma_f32_16x16x32_bf16 v[36:39], a[60:63], a[204:207], v[36:39]
  ds_read_b64_tr_b16 a[34:35], v11 offset:4096
  v_mfma_f32_16x16x32_bf16 v[40:43], a[0:3], a[88:91], v[40:43]
  ds_read_b64_tr_b16 a[36:37], v11 offset:57344
  v_mfma_f32_16x16x32_bf16 v[40:43], a[4:7], a[136:139], v[40:43]
  ds_read_b64_tr_b16 a[38:39], v11 offset:61440
  v_mfma_f32_16x16x32_bf16 v[40:43], a[8:11], a[184:187], v[40:43]
  s_waitcnt lgkmcnt(3)
  ds_read_b64_tr_b16 a[40:41], v11 offset:24576
  v_mfma_f32_16x16x32_bf16 v[40:43], a[12:15], a[100:103], v[40:43]
  v_cvt_pk_bf16_f32 v116, v36, v37
  v_cvt_pk_bf16_f32 v117, v38, v39
  v_mfma_f32_16x16x32_bf16 v[40:43], a[16:19], a[148:151], v[40:43]
  buffer_store_dwordx2 v[116:117], v7, s[32:35], s46 offen offset:1024 sc1
  v_mfma_f32_16x16x32_bf16 v[40:43], a[20:23], a[196:199], v[40:43]
  s_xor_b32 s46, s54, 2
  ds_read_b64_tr_b16 a[42:43], v11 offset:28672
  v_mfma_f32_16x16x32_bf16 v[44:47], a[0:3], a[92:95], v[44:47]
  s_mul_i32 s46, s46, 49152
  ds_read_b64_tr_b16 a[44:45], v11 offset:8192
  v_mfma_f32_16x16x32_bf16 v[44:47], a[4:7], a[140:143], v[44:47]
  ds_read_b64_tr_b16 a[46:47], v11 offset:12288
  v_mfma_f32_16x16x32_bf16 v[44:47], a[8:11], a[188:191], v[44:47]
  v_mfma_f32_16x16x32_bf16 v[44:47], a[12:15], a[104:107], v[44:47]
  v_cvt_pk_bf16_f32 v118, v40, v41
  v_cvt_pk_bf16_f32 v119, v42, v43
  v_mfma_f32_16x16x32_bf16 v[44:47], a[16:19], a[152:155], v[44:47]
  ds_read_b64_tr_b16 a[48:49], v12 offset:49152
  v_mfma_f32_16x16x32_bf16 v[44:47], a[20:23], a[200:203], v[44:47]
  ds_read_b64_tr_b16 a[50:51], v12 offset:53248
  v_mfma_f32_16x16x32_bf16 v[48:51], a[0:3], a[96:99], v[48:51]
  ds_read_b64_tr_b16 a[52:53], v12 offset:16384
  v_mfma_f32_16x16x32_bf16 v[48:51], a[4:7], a[144:147], v[48:51]
  ds_read_b64_tr_b16 a[54:55], v12 offset:20480
  v_mfma_f32_16x16x32_bf16 v[48:51], a[8:11], a[192:195], v[48:51]
  ds_read_b64_tr_b16 a[56:57], v12 offset:0
  v_mfma_f32_16x16x32_bf16 v[48:51], a[12:15], a[108:111], v[48:51]
  v_cvt_pk_bf16_f32 v120, v44, v45
  v_cvt_pk_bf16_f32 v121, v46, v47
  v_mfma_f32_16x16x32_bf16 v[48:51], a[16:19], a[156:159], v[48:51]
  buffer_store_dwordx4 v[118:121], v1, s[32:35], s46 offen sc1
  v_mfma_f32_16x16x32_bf16 v[48:51], a[20:23], a[204:207], v[48:51]
  ds_read_b64_tr_b16 a[58:59], v12 offset:4096
  v_mfma_f32_16x16x32_bf16 v[52:55], a[24:27], a[88:91], v[52:55]
  ds_read_b64_tr_b16 a[60:61], v12 offset:57344
  v_mfma_f32_16x16x32_bf16 v[52:55], a[28:31], a[136:139], v[52:55]
  s_waitcnt lgkmcnt(3)
  ds_read_b64_tr_b16 a[62:63], v12 offset:61440
  v_mfma_f32_16x16x32_bf16 v[52:55], a[32:35], a[184:187], v[52:55]
  ds_read_b64_tr_b16 a[0:1], v12 offset:24576
  v_mfma_f32_16x16x32_bf16 v[52:55], a[36:39], a[100:103], v[52:55]
  v_cvt_pk_bf16_f32 v122, v48, v49
  v_cvt_pk_bf16_f32 v123, v50, v51
  v_mfma_f32_16x16x32_bf16 v[52:55], a[40:43], a[148:151], v[52:55]
  buffer_store_dwordx2 v[122:123], v7, s[32:35], s46 offen offset:1024 sc1
  v_mfma_f32_16x16x32_bf16 v[52:55], a[44:47], a[196:199], v[52:55]
  s_xor_b32 s46, s54, 3
  ds_read_b64_tr_b16 a[2:3], v12 offset:28672
  v_mfma_f32_16x16x32_bf16 v[56:59], a[24:27], a[92:95], v[56:59]
  s_mul_i32 s46, s46, 49152
  ds_read_b64_tr_b16 a[4:5], v12 offset:8192
  v_mfma_f32_16x16x32_bf16 v[56:59], a[28:31], a[140:143], v[56:59]
  ds_read_b64_tr_b16 a[6:7], v12 offset:12288
  v_mfma_f32_16x16x32_bf16 v[56:59], a[32:35], a[188:191], v[56:59]
  v_mfma_f32_16x16x32_bf16 v[56:59], a[36:39], a[104:107], v[56:59]
  v_cvt_pk_bf16_f32 v124, v52, v53
  v_cvt_pk_bf16_f32 v125, v54, v55
  v_mfma_f32_16x16x32_bf16 v[56:59], a[40:43], a[152:155], v[56:59]
  ds_read_b64_tr_b16 a[8:9], v13 offset:49152
  v_mfma_f32_16x16x32_bf16 v[56:59], a[44:47], a[200:203], v[56:59]
  ds_read_b64_tr_b16 a[10:11], v13 offset:53248
  v_mfma_f32_16x16x32_bf16 v[60:63], a[24:27], a[96:99], v[60:63]
  ds_read_b64_tr_b16 a[12:13], v13 offset:16384
  v_mfma_f32_16x16x32_bf16 v[60:63], a[28:31], a[144:147], v[60:63]
  ds_read_b64_tr_b16 a[14:15], v13 offset:20480
  v_mfma_f32_16x16x32_bf16 v[60:63], a[32:35], a[192:195], v[60:63]
  ds_read_b64_tr_b16 a[16:17], v13 offset:0
  v_mfma_f32_16x16x32_bf16 v[60:63], a[36:39], a[108:111], v[60:63]
  v_cvt_pk_bf16_f32 v126, v56, v57
  v_cvt_pk_bf16_f32 v127, v58, v59
  v_mfma_f32_16x16x32_bf16 v[60:63], a[40:43], a[156:159], v[60:63]
  buffer_store_dwordx4 v[124:127], v1, s[32:35], s46 offen sc1
  v_mfma_f32_16x16x32_bf16 v[60:63], a[44:47], a[204:207], v[60:63]
  ds_read_b64_tr_b16 a[18:19], v13 offset:4096
  v_mfma_f32_16x16x32_bf16 v[64:67], a[48:51], a[88:91], v[64:67]
  ds_read_b64_tr_b16 a[20:21], v13 offset:57344
  v_mfma_f32_16x16x32_bf16 v[64:67], a[52:55], a[136:139], v[64:67]
  s_waitcnt lgkmcnt(3)
  ds_read_b64_tr_b16 a[22:23], v13 offset:61440
  v_mfma_f32_16x16x32_bf16 v[64:67], a[56:59], a[184:187], v[64:67]
  ds_read_b64_tr_b16 a[24:25], v13 offset:24576
  v_mfma_f32_16x16x32_bf16 v[64:67], a[60:63], a[100:103], v[64:67]
  v_cvt_pk_bf16_f32 v128, v60, v61
  v_cvt_pk_bf16_f32 v129, v62, v63
  v_mfma_f32_16x16x32_bf16 v[64:67], a[0:3], a[148:151], v[64:67]
  buffer_store_dwordx2 v[128:129], v7, s[32:35], s46 offen offset:1024 sc1
  v_mfma_f32_16x16x32_bf16 v[64:67], a[4:7], a[196:199], v[64:67]
  s_xor_b32 s46, s54, 4
  ds_read_b64_tr_b16 a[26:27], v13 offset:28672
  v_mfma_f32_16x16x32_bf16 v[68:71], a[48:51], a[92:95], v[68:71]
  s_mul_i32 s46, s46, 49152
  ds_read_b64_tr_b16 a[28:29], v13 offset:8192
  v_mfma_f32_16x16x32_bf16 v[68:71], a[52:55], a[140:143], v[68:71]
  ds_read_b64_tr_b16 a[30:31], v13 offset:12288
  v_mfma_f32_16x16x32_bf16 v[68:71], a[56:59], a[188:191], v[68:71]
  v_mfma_f32_16x16x32_bf16 v[68:71], a[60:63], a[104:107], v[68:71]
  v_cvt_pk_bf16_f32 v130, v64, v65
  v_cvt_pk_bf16_f32 v131, v66, v67
  v_mfma_f32_16x16x32_bf16 v[68:71], a[0:3], a[152:155], v[68:71]
  ds_read_b64_tr_b16 a[32:33], v14 offset:49152
  v_mfma_f32_16x16x32_bf16 v[68:71], a[4:7], a[200:203], v[68:71]
  ds_read_b64_tr_b16 a[34:35], v14 offset:53248
  v_mfma_f32_16x16x32_bf16 v[72:75], a[48:51], a[96:99], v[72:75]
  ds_read_b64_tr_b16 a[36:37], v14 offset:16384
  v_mfma_f32_16x16x32_bf16 v[72:75], a[52:55], a[144:147], v[72:75]
  ds_read_b64_tr_b16 a[38:39], v14 offset:20480
  v_mfma_f32_16x16x32_bf16 v[72:75], a[56:59], a[192:195], v[72:75]
  ds_read_b64_tr_b16 a[40:41], v14 offset:0
  v_mfma_f32_16x16x32_bf16 v[72:75], a[60:63], a[108:111], v[72:75]
  v_cvt_pk_bf16_f32 v132, v68, v69
  v_cvt_pk_bf16_f32 v133, v70, v71
  v_mfma_f32_16x16x32_bf16 v[72:75], a[0:3], a[156:159], v[72:75]
  buffer_store_dwordx4 v[130:133], v1, s[32:35], s46 offen sc1
  v_mfma_f32_16x16x32_bf16 v[72:75], a[4:7], a[204:207], v[72:75]
  ds_read_b64_tr_b16 a[42:43], v14 offset:4096
  v_mfma_f32_16x16x32_bf16 v[76:79], a[8:11], a[88:91], v[76:79]
  ds_read_b64_tr_b16 a[44:45], v14 offset:57344
  v_mfma_f32_16x16x32_bf16 v[76:79], a[12:15], a[136:139], v[76:79]
  s_waitcnt lgkmcnt(3)
  ds_read_b64_tr_b16 a[46:47], v14 offset:61440
  v_mfma_f32_16x16x32_bf16 v[76:79], a[16:19], a[184:187], v[76:79]
  ds_read_b64_tr_b16 a[48:49], v14 offset:24576
  v_mfma_f32_16x16x32_bf16 v[76:79], a[20:23], a[100:103], v[76:79]
  v_cvt_pk_bf16_f32 v134, v72, v73
  v_cvt_pk_bf16_f32 v135, v74, v75
  v_mfma_f32_16x16x32_bf16 v[76:79], a[24:27], a[148:151], v[76:79]
  buffer_store_dwordx2 v[134:135], v7, s[32:35], s46 offen offset:1024 sc1
  v_mfma_f32_16x16x32_bf16 v[76:79], a[28:31], a[196:199], v[76:79]
  s_xor_b32 s46, s54, 5
  ds_read_b64_tr_b16 a[50:51], v14 offset:28672
  v_mfma_f32_16x16x32_bf16 v[80:83], a[8:11], a[92:95], v[80:83]
  s_mul_i32 s46, s46, 49152
  ds_read_b64_tr_b16 a[52:53], v14 offset:8192
  v_mfma_f32_16x16x32_bf16 v[80:83], a[12:15], a[140:143], v[80:83]
  ds_read_b64_tr_b16 a[54:55], v14 offset:12288
  v_mfma_f32_16x16x32_bf16 v[80:83], a[16:19], a[188:191], v[80:83]
  v_mfma_f32_16x16x32_bf16 v[80:83], a[20:23], a[104:107], v[80:83]
  v_cvt_pk_bf16_f32 v136, v76, v77
  v_cvt_pk_bf16_f32 v137, v78, v79
  v_mfma_f32_16x16x32_bf16 v[80:83], a[24:27], a[152:155], v[80:83]
  ds_read_b64_tr_b16 a[56:57], v15 offset:49152
  v_mfma_f32_16x16x32_bf16 v[80:83], a[28:31], a[200:203], v[80:83]
  ds_read_b64_tr_b16 a[58:59], v15 offset:53248
  v_mfma_f32_16x16x32_bf16 v[84:87], a[8:11], a[96:99], v[84:87]
  ds_read_b64_tr_b16 a[60:61], v15 offset:16384
  v_mfma_f32_16x16x32_bf16 v[84:87], a[12:15], a[144:147], v[84:87]
  ds_read_b64_tr_b16 a[62:63], v15 offset:20480
  v_mfma_f32_16x16x32_bf16 v[84:87], a[16:19], a[192:195], v[84:87]
  ds_read_b64_tr_b16 a[0:1], v15 offset:0
  v_mfma_f32_16x16x32_bf16 v[84:87], a[20:23], a[108:111], v[84:87]
  v_cvt_pk_bf16_f32 v138, v80, v81
  v_cvt_pk_bf16_f32 v139, v82, v83
  v_mfma_f32_16x16x32_bf16 v[84:87], a[24:27], a[156:159], v[84:87]
  buffer_store_dwordx4 v[136:139], v1, s[32:35], s46 offen sc1
  v_mfma_f32_16x16x32_bf16 v[84:87], a[28:31], a[204:207], v[84:87]
  ds_read_b64_tr_b16 a[2:3], v15 offset:4096
  v_mfma_f32_16x16x32_bf16 v[88:91], a[32:35], a[88:91], v[88:91]
  ds_read_b64_tr_b16 a[4:5], v15 offset:57344
  v_mfma_f32_16x16x32_bf16 v[88:91], a[36:39], a[136:139], v[88:91]
  s_waitcnt lgkmcnt(3)
  ds_read_b64_tr_b16 a[6:7], v15 offset:61440
  v_mfma_f32_16x16x32_bf16 v[88:91], a[40:43], a[184:187], v[88:91]
  ds_read_b64_tr_b16 a[8:9], v15 offset:24576
  v_mfma_f32_16x16x32_bf16 v[88:91], a[44:47], a[100:103], v[88:91]
  v_cvt_pk_bf16_f32 v140, v84, v85
  v_cvt_pk_bf16_f32 v141, v86, v87
  v_mfma_f32_16x16x32_bf16 v[88:91], a[48:51], a[148:151], v[88:91]
  buffer_store_dwordx2 v[140:141], v7, s[32:35], s46 offen offset:1024 sc1
  v_mfma_f32_16x16x32_bf16 v[88:91], a[52:55], a[196:199], v[88:91]
  s_xor_b32 s46, s54, 6
  ds_read_b64_tr_b16 a[10:11], v15 offset:28672
  v_mfma_f32_16x16x32_bf16 v[92:95], a[32:35], a[92:95], v[92:95]
  s_mul_i32 s46, s46, 49152
  ds_read_b64_tr_b16 a[12:13], v15 offset:8192
  v_mfma_f32_16x16x32_bf16 v[92:95], a[36:39], a[140:143], v[92:95]
  ds_read_b64_tr_b16 a[14:15], v15 offset:12288
  v_mfma_f32_16x16x32_bf16 v[92:95], a[40:43], a[188:191], v[92:95]
  v_mfma_f32_16x16x32_bf16 v[92:95], a[44:47], a[104:107], v[92:95]
  v_cvt_pk_bf16_f32 v142, v88, v89
  v_cvt_pk_bf16_f32 v143, v90, v91
  v_mfma_f32_16x16x32_bf16 v[92:95], a[48:51], a[152:155], v[92:95]
  ds_read_b64_tr_b16 a[16:17], v8 offset:32768
  v_mfma_f32_16x16x32_bf16 v[92:95], a[52:55], a[200:203], v[92:95]
  ds_read_b64_tr_b16 a[18:19], v8 offset:36864
  v_mfma_f32_16x16x32_bf16 v[96:99], a[32:35], a[96:99], v[96:99]
  ds_read_b64_tr_b16 a[20:21], v8 offset:49152
  v_mfma_f32_16x16x32_bf16 v[96:99], a[36:39], a[144:147], v[96:99]
  ds_read_b64_tr_b16 a[22:23], v8 offset:53248
  v_add_u32 v8, 65536, v8
  v_mfma_f32_16x16x32_bf16 v[96:99], a[40:43], a[192:195], v[96:99]
  ds_read_b64_tr_b16 a[24:25], v8 offset:32768
  v_mfma_f32_16x16x32_bf16 v[96:99], a[44:47], a[108:111], v[96:99]
  v_cvt_pk_bf16_f32 v144, v92, v93
  v_cvt_pk_bf16_f32 v145, v94, v95
  v_mfma_f32_16x16x32_bf16 v[96:99], a[48:51], a[156:159], v[96:99]
  buffer_store_dwordx4 v[142:145], v1, s[32:35], s46 offen sc1
  v_mfma_f32_16x16x32_bf16 v[96:99], a[52:55], a[204:207], v[96:99]
  ds_read_b64_tr_b16 a[26:27], v8 offset:36864
  v_add_u32 v8, -65536, v8
  v_mfma_f32_16x16x32_bf16 v[100:103], a[56:59], a[88:91], v[100:103]
  ds_read_b64_tr_b16 a[28:29], v8 offset:40960
  v_mfma_f32_16x16x32_bf16 v[100:103], a[60:63], a[136:139], v[100:103]
  s_waitcnt lgkmcnt(3)
  ds_read_b64_tr_b16 a[30:31], v8 offset:45056
  v_mfma_f32_16x16x32_bf16 v[100:103], a[0:3], a[184:187], v[100:103]
  ds_read_b64_tr_b16 a[32:33], v8 offset:57344
  v_mfma_f32_16x16x32_bf16 v[100:103], a[4:7], a[100:103], v[100:103]
  v_cvt_pk_bf16_f32 v146, v96, v97
  v_cvt_pk_bf16_f32 v147, v98, v99
  v_mfma_f32_16x16x32_bf16 v[100:103], a[8:11], a[148:151], v[100:103]
  buffer_store_dwordx2 v[146:147], v7, s[32:35], s46 offen offset:1024 sc1
  v_mfma_f32_16x16x32_bf16 v[100:103], a[12:15], a[196:199], v[100:103]
  s_xor_b32 s46, s54, 7
  ds_read_b64_tr_b16 a[34:35], v8 offset:61440
  v_add_u32 v8, 65536, v8
  v_mfma_f32_16x16x32_bf16 v[104:107], a[56:59], a[92:95], v[104:107]
  s_mul_i32 s46, s46, 49152
  ds_read_b64_tr_b16 a[36:37], v8 offset:40960
  v_mfma_f32_16x16x32_bf16 v[104:107], a[60:63], a[140:143], v[104:107]
  s_xor_b32 s40, s54, 1
  ds_read_b64_tr_b16 a[38:39], v8 offset:45056
  v_mfma_f32_16x16x32_bf16 v[104:107], a[0:3], a[188:191], v[104:107]
  s_mul_i32 s40, s40, 1536
  v_mfma_f32_16x16x32_bf16 v[104:107], a[4:7], a[104:107], v[104:107]
  s_xor_b32 s41, s54, 2
  v_cvt_pk_bf16_f32 v148, v100, v101
  v_cvt_pk_bf16_f32 v149, v102, v103
  v_mfma_f32_16x16x32_bf16 v[104:107], a[8:11], a[152:155], v[104:107]
  s_mul_i32 s41, s41, 1536
  ds_read_b64_tr_b16 a[40:41], v8 offset:49152
  v_mfma_f32_16x16x32_bf16 v[104:107], a[12:15], a[200:203], v[104:107]
  s_xor_b32 s42, s54, 3
  ds_read_b64_tr_b16 a[42:43], v8 offset:53248
  v_mfma_f32_16x16x32_bf16 v[108:111], a[56:59], a[96:99], v[108:111]
  s_mul_i32 s42, s42, 1536
  ds_read_b64_tr_b16 a[44:45], v8 offset:16384
  v_mfma_f32_16x16x32_bf16 v[108:111], a[60:63], a[144:147], v[108:111]
  s_xor_b32 s43, s54, 4
  ds_read_b64_tr_b16 a[46:47], v8 offset:20480
  v_mfma_f32_16x16x32_bf16 v[108:111], a[0:3], a[192:195], v[108:111]
  s_mul_i32 s43, s43, 1536
  ds_read_b64_tr_b16 a[48:49], v8 offset:0
  v_mfma_f32_16x16x32_bf16 v[108:111], a[4:7], a[108:111], v[108:111]
  s_xor_b32 s44, s54, 5
  v_cvt_pk_bf16_f32 v150, v104, v105
  v_cvt_pk_bf16_f32 v151, v106, v107
  v_mfma_f32_16x16x32_bf16 v[108:111], a[8:11], a[156:159], v[108:111]
  buffer_store_dwordx4 v[148:151], v1, s[32:35], s46 offen sc1
  v_mfma_f32_16x16x32_bf16 v[108:111], a[12:15], a[204:207], v[108:111]
  ds_read_b64_tr_b16 a[50:51], v8 offset:4096
  v_mfma_f32_16x16x32_bf16 v[16:19], a[16:19], a[64:67], v[16:19]
  ds_read_b64_tr_b16 a[52:53], v8 offset:57344
  v_mfma_f32_16x16x32_bf16 v[16:19], a[20:23], a[112:115], v[16:19]
  s_waitcnt lgkmcnt(3)
  ds_read_b64_tr_b16 a[54:55], v8 offset:61440
  v_mfma_f32_16x16x32_bf16 v[16:19], a[24:27], a[160:163], v[16:19]
  ds_read_b64_tr_b16 a[56:57], v8 offset:24576
  v_mfma_f32_16x16x32_bf16 v[16:19], a[28:31], a[76:79], v[16:19]
  s_mul_i32 s44, s44, 1536
  v_cvt_pk_bf16_f32 v152, v108, v109
  v_cvt_pk_bf16_f32 v153, v110, v111
  v_mfma_f32_16x16x32_bf16 v[16:19], a[32:35], a[124:127], v[16:19]
  buffer_store_dwordx2 v[152:153], v7, s[32:35], s46 offen offset:1024 sc1
  v_mfma_f32_16x16x32_bf16 v[16:19], a[36:39], a[172:175], v[16:19]
  ds_read_b64_tr_b16 a[58:59], v8 offset:28672
  v_mfma_f32_16x16x32_bf16 v[20:23], a[16:19], a[68:71], v[20:23]
  ds_read_b64_tr_b16 a[60:61], v8 offset:8192
  v_mfma_f32_16x16x32_bf16 v[20:23], a[20:23], a[116:119], v[20:23]
  s_xor_b32 s45, s54, 6
  ds_read_b64_tr_b16 a[62:63], v8 offset:12288
  v_mfma_f32_16x16x32_bf16 v[20:23], a[24:27], a[164:167], v[20:23]
  s_mul_i32 s45, s45, 1536
  v_mfma_f32_16x16x32_bf16 v[20:23], a[28:31], a[80:83], v[20:23]
  s_xor_b32 s46, s54, 7
  v_mfma_f32_16x16x32_bf16 v[20:23], a[32:35], a[128:131], v[20:23]
  s_mul_i32 s46, s46, 1536
  v_mfma_f32_16x16x32_bf16 v[20:23], a[36:39], a[176:179], v[20:23]
  v_mfma_f32_16x16x32_bf16 v[24:27], a[16:19], a[72:75], v[24:27]
  s_waitcnt vmcnt(0)
  buffer_store_dwordx4 v[246:249], v5, s[64:67], 0 offen sc1
  v_mfma_f32_16x16x32_bf16 v[24:27], a[20:23], a[120:123], v[24:27]
  v_mfma_f32_16x16x32_bf16 v[24:27], a[24:27], a[168:171], v[24:27]
  v_mfma_f32_16x16x32_bf16 v[24:27], a[28:31], a[84:87], v[24:27]
  v_mfma_f32_16x16x32_bf16 v[24:27], a[32:35], a[132:135], v[24:27]
  v_mfma_f32_16x16x32_bf16 v[24:27], a[36:39], a[180:183], v[24:27]
  v_mfma_f32_16x16x32_bf16 v[16:19], a[40:43], a[88:91], v[16:19]
  v_mfma_f32_16x16x32_bf16 v[16:19], a[44:47], a[136:139], v[16:19]
  s_waitcnt lgkmcnt(0)
  v_mfma_f32_16x16x32_bf16 v[16:19], a[48:51], a[184:187], v[16:19]
  v_mfma_f32_16x16x32_bf16 v[16:19], a[52:55], a[100:103], v[16:19]
  v_mfma_f32_16x16x32_bf16 v[16:19], a[56:59], a[148:151], v[16:19]
  v_mfma_f32_16x16x32_bf16 v[16:19], a[60:63], a[196:199], v[16:19]
  v_mfma_f32_16x16x32_bf16 v[20:23], a[40:43], a[92:95], v[20:23]
  v_mfma_f32_16x16x32_bf16 v[20:23], a[44:47], a[140:143], v[20:23]
  v_mfma_f32_16x16x32_bf16 v[20:23], a[48:51], a[188:191], v[20:23]
  v_mfma_f32_16x16x32_bf16 v[20:23], a[52:55], a[104:107], v[20:23]
  v_mfma_f32_16x16x32_bf16 v[20:23], a[56:59], a[152:155], v[20:23]
  v_mfma_f32_16x16x32_bf16 v[20:23], a[60:63], a[200:203], v[20:23]
  v_mfma_f32_16x16x32_bf16 v[24:27], a[40:43], a[96:99], v[24:27]
  v_mfma_f32_16x16x32_bf16 v[24:27], a[44:47], a[144:147], v[24:27]
  v_mfma_f32_16x16x32_bf16 v[24:27], a[48:51], a[192:195], v[24:27]
  v_mfma_f32_16x16x32_bf16 v[24:27], a[52:55], a[108:111], v[24:27]
  v_mfma_f32_16x16x32_bf16 v[24:27], a[56:59], a[156:159], v[24:27]
  v_mfma_f32_16x16x32_bf16 v[24:27], a[60:63], a[204:207], v[24:27]
  s_mov_b32 s58, 0
  L_poll2:
  buffer_load_dword v245, v6, s[64:67], 0 offen sc1
  s_waitcnt vmcnt(0)
  v_cmp_eq_u32 vcc, 1, v245
  s_nop 3
  s_cmp_eq_u32 vcc_lo, 0xff
  s_cbranch_scc1 L_go2
  s_add_u32 s58, s58, 1
  s_cmp_lt_u32 s58, 200000
  s_cbranch_scc1 L_poll2
L_go2:
  buffer_load_dwordx4 a[0:3], v1, s[12:15], s40 offen sc1
  buffer_load_dwordx2 a[4:5], v7, s[12:15], s40 offen offset:1024 sc1
  buffer_load_dwordx4 a[6:9], v1, s[12:15], s41 offen sc1
  buffer_load_dwordx2 a[10:11], v7, s[12:15], s41 offen offset:1024 sc1
  buffer_load_dwordx4 a[12:15], v1, s[12:15], s42 offen sc1
  buffer_load_dwordx2 a[16:17], v7, s[12:15], s42 offen offset:1024 sc1
  buffer_load_dwordx4 a[18:21], v1, s[12:15], s43 offen sc1
  buffer_load_dwordx2 a[22:23], v7, s[12:15], s43 offen offset:1024 sc1
  buffer_load_dwordx4 a[24:27], v1, s[12:15], s44 offen sc1
  buffer_load_dwordx2 a[28:29], v7, s[12:15], s44 offen offset:1024 sc1
  buffer_load_dwordx4 a[30:33], v1, s[12:15], s45 offen sc1
  buffer_load_dwordx2 a[34:35], v7, s[12:15], s45 offen offset:1024 sc1
  buffer_load_dwordx4 a[36:39], v1, s[12:15], s46 offen sc1
  buffer_load_dwordx2 a[40:41], v7, s[12:15], s46 offen offset:1024 sc1
  s_waitcnt vmcnt(13)
  v_mfma_f32_16x16x16_bf16 v[16:19], a[208:209], a[0:1], v[16:19]
  v_mfma_f32_16x16x16_bf16 v[20:23], a[208:209], a[2:3], v[20:23]
  s_waitcnt vmcnt(12)
  v_mfma_f32_16x16x16_bf16 v[24:27], a[208:209], a[4:5], v[24:27]
  s_waitcnt vmcnt(11)
  v_mfma_f32_16x16x16_bf16 v[16:19], a[208:209], a[6:7], v[16:19]
  v_mfma_f32_16x16x16_bf16 v[20:23], a[208:209], a[8:9], v[20:23]
  s_waitcnt vmcnt(10)
  v_mfma_f32_16x16x16_bf16 v[24:27], a[208:209], a[10:11], v[24:27]
  s_waitcnt vmcnt(9)
  v_mfma_f32_16x16x16_bf16 v[16:19], a[208:209], a[12:13], v[16:19]
  v_mfma_f32_16x16x16_bf16 v[20:23], a[208:209], a[14:15], v[20:23]
  s_waitcnt vmcnt(8)
  v_mfma_f32_16x16x16_bf16 v[24:27], a[208:209], a[16:17], v[24:27]
  s_waitcnt vmcnt(7)
  v_mfma_f32_16x16x16_bf16 v[16:19], a[208:209], a[18:19], v[16:19]
  v_mfma_f32_16x16x16_bf16 v[20:23], a[208:209], a[20:21], v[20:23]
  s_waitcnt vmcnt(6)
  v_mfma_f32_16x16x16_bf16 v[24:27], a[208:209], a[22:23], v[24:27]
  s_waitcnt vmcnt(5)
  v_mfma_f32_16x16x16_bf16 v[16:19], a[208:209], a[24:25], v[16:19]
  v_mfma_f32_16x16x16_bf16 v[20:23], a[208:209], a[26:27], v[20:23]
  s_waitcnt vmcnt(4)
  v_mfma_f32_16x16x16_bf16 v[24:27], a[208:209], a[28:29], v[24:27]
  s_waitcnt vmcnt(3)
  v_mfma_f32_16x16x16_bf16 v[16:19], a[208:209], a[30:31], v[16:19]
  v_mfma_f32_16x16x16_bf16 v[20:23], a[208:209], a[32:33], v[20:23]
  s_waitcnt vmcnt(2)
  v_mfma_f32_16x16x16_bf16 v[24:27], a[208:209], a[34:35], v[24:27]
  s_waitcnt vmcnt(1)
  v_mfma_f32_16x16x16_bf16 v[16:19], a[208:209], a[36:37], v[16:19]
  v_mfma_f32_16x16x16_bf16 v[20:23], a[208:209], a[38:39], v[20:23]
  s_waitcnt vmcnt(0)
  v_mfma_f32_16x16x16_bf16 v[24:27], a[208:209], a[40:41], v[24:27]
  s_nop 4
  v_cvt_pk_bf16_f32 v32, v16, v17
  v_cvt_pk_bf16_f32 v33, v18, v19
  v_cvt_pk_bf16_f32 v34, v20, v21
  v_cvt_pk_bf16_f32 v35, v22, v23
  v_cvt_pk_bf16_f32 v36, v24, v25
  v_cvt_pk_bf16_f32 v37, v26, v27
  buffer_store_dwordx2 v[32:33], v4, s[16:19], 0 offen
  buffer_store_dwordx2 v[34:35], v4, s[16:19], s52 offen
  buffer_store_dwordx2 v[36:37], v4, s[16:19], s53 offen
L_k1_end:
  s_endpgm
L_codeend:
L_redo:
  s_waitcnt vmcnt(0) lgkmcnt(0)
  s_nop 7
  s_nop 7
  v_mov_b32 v244, 0xff800000
  v_mov_b32 v245, 0xff800000
  v_mov_b32 v246, 0xff800000
  s_mov_b32 s38, 0
  L_redo1:
  s_barrier
  s_add_u32 m0, s37, 0
  s_nop 0
  buffer_load_dwordx4 v2, s[16:19], s38 offen offset:0 lds
  buffer_load_dwordx4 v2, s[16:19], s38 offen offset:1024 lds
  buffer_load_dwordx4 v2, s[16:19], s38 offen offset:2048 lds
  buffer_load_dwordx4 v2, s[16:19], s38 offen offset:3072 lds
  s_waitcnt vmcnt(0)
  s_barrier
  ds_read_b128 a[0:3], v4 offset:0
  ds_read_b128 a[4:7], v5 offset:0
  ds_read_b128 a[8:11], v6 offset:0
  ds_read_b128 a[12:15], v7 offset:0
  s_waitcnt lgkmcnt(3)
  v_mfma_f32_16x16x32_bf16 v[160:163], a[0:3], v[112:115], 0
  v_mfma_f32_16x16x32_bf16 v[164:167], a[0:3], v[116:119], 0
  v_mfma_f32_16x16x32_bf16 v[168:171], a[0:3], v[120:123], 0
  s_waitcnt lgkmcnt(2)
  v_mfma_f32_16x16x32_bf16 v[160:163], a[4:7], v[124:127], v[160:163]
  v_mfma_f32_16x16x32_bf16 v[164:167], a[4:7], v[128:131], v[164:167]
  v_mfma_f32_16x16x32_bf16 v[168:171], a[4:7], v[132:135], v[168:171]
  s_waitcnt lgkmcnt(1)
  v_mfma_f32_16x16x32_bf16 v[160:163], a[8:11], v[136:139], v[160:163]
  v_mfma_f32_16x16x32_bf16 v[164:167], a[8:11], v[140:143], v[164:167]
  v_mfma_f32_16x16x32_bf16 v[168:171], a[8:11], v[144:147], v[168:171]
  s_waitcnt lgkmcnt(0)
  v_mfma_f32_16x16x32_bf16 v[160:163], a[12:15], v[148:151], v[160:163]
  v_mfma_f32_16x16x32_bf16 v[164:167], a[12:15], v[152:155], v[164:167]
  v_mfma_f32_16x16x32_bf16 v[168:171], a[12:15], v[156:159], v[168:171]
  s_nop 5
  v_max3_f32 v244, v244, v160, v161
  v_max3_f32 v244, v244, v162, v163
  v_max3_f32 v245, v245, v164, v165
  v_max3_f32 v245, v245, v166, v167
  v_max3_f32 v246, v246, v168, v169
  v_max3_f32 v246, v246, v170, v171
  ds_read_b128 a[0:3], v4 offset:1024
  ds_read_b128 a[4:7], v5 offset:1024
  ds_read_b128 a[8:11], v6 offset:1024
  ds_read_b128 a[12:15], v7 offset:1024
  s_waitcnt lgkmcnt(3)
  v_mfma_f32_16x16x32_bf16 v[160:163], a[0:3], v[112:115], 0
  v_mfma_f32_16x16x32_bf16 v[164:167], a[0:3], v[116:119], 0
  v_mfma_f32_16x16x32_bf16 v[168:171], a[0:3], v[120:123], 0
  s_waitcnt lgkmcnt(2)
  v_mfma_f32_16x16x32_bf16 v[160:163], a[4:7], v[124:127], v[160:163]
  v_mfma_f32_16x16x32_bf16 v[164:167], a[4:7], v[128:131], v[164:167]
  v_mfma_f32_16x16x32_bf16 v[168:171], a[4:7], v[132:135], v[168:171]
  s_waitcnt lgkmcnt(1)
  v_mfma_f32_16x16x32_bf16 v[160:163], a[8:11], v[136:139], v[160:163]
  v_mfma_f32_16x16x32_bf16 v[164:167], a[8:11], v[140:143], v[164:167]
  v_mfma_f32_16x16x32_bf16 v[168:171], a[8:11], v[144:147], v[168:171]
  s_waitcnt lgkmcnt(0)
  v_mfma_f32_16x16x32_bf16 v[160:163], a[12:15], v[148:151], v[160:163]
  v_mfma_f32_16x16x32_bf16 v[164:167], a[12:15], v[152:155], v[164:167]
  v_mfma_f32_16x16x32_bf16 v[168:171], a[12:15], v[156:159], v[168:171]
  s_nop 5
  v_max3_f32 v244, v244, v160, v161
  v_max3_f32 v244, v244, v162, v163
  v_max3_f32 v245, v245, v164, v165
  v_max3_f32 v245, v245, v166, v167
  v_max3_f32 v246, v246, v168, v169
  v_max3_f32 v246, v246, v170, v171
  ds_read_b128 a[0:3], v4 offset:2048
  ds_read_b128 a[4:7], v5 offset:2048
  ds_read_b128 a[8:11], v6 offset:2048
  ds_read_b128 a[12:15], v7 offset:2048
  s_waitcnt lgkmcnt(3)
  v_mfma_f32_16x16x32_bf16 v[160:163], a[0:3], v[112:115], 0
  v_mfma_f32_16x16x32_bf16 v[164:167], a[0:3], v[116:119], 0
  v_mfma_f32_16x16x32_bf16 v[168:171], a[0:3], v[120:123], 0
  s_waitcnt lgkmcnt(2)
  v_mfma_f32_16x16x32_bf16 v[160:163], a[4:7], v[124:127], v[160:163]
  v_mfma_f32_16x16x32_bf16 v[164:167], a[4:7], v[128:131], v[164:167]
  v_mfma_f32_16x16x32_bf16 v[168:171], a[4:7], v[132:135], v[168:171]
  s_waitcnt lgkmcnt(1)
  v_mfma_f32_16x16x32_bf16 v[160:163], a[8:11], v[136:139], v[160:163]
  v_mfma_f32_16x16x32_bf16 v[164:167], a[8:11], v[140:143], v[164:167]
  v_mfma_f32_16x16x32_bf16 v[168:171], a[8:11], v[144:147], v[168:171]
  s_waitcnt lgkmcnt(0)
  v_mfma_f32_16x16x32_bf16 v[160:163], a[12:15], v[148:151], v[160:163]
  v_mfma_f32_16x16x32_bf16 v[164:167], a[12:15], v[152:155], v[164:167]
  v_mfma_f32_16x16x32_bf16 v[168:171], a[12:15], v[156:159], v[168:171]
  s_nop 5
  v_max3_f32 v244, v244, v160, v161
  v_max3_f32 v244, v244, v162, v163
  v_max3_f32 v245, v245, v164, v165
  v_max3_f32 v245, v245, v166, v167
  v_max3_f32 v246, v246, v168, v169
  v_max3_f32 v246, v246, v170, v171
  ds_read_b128 a[0:3], v4 offset:3072
  ds_read_b128 a[4:7], v5 offset:3072
  ds_read_b128 a[8:11], v6 offset:3072
  ds_read_b128 a[12:15], v7 offset:3072
  s_waitcnt lgkmcnt(3)
  v_mfma_f32_16x16x32_bf16 v[160:163], a[0:3], v[112:115], 0
  v_mfma_f32_16x16x32_bf16 v[164:167], a[0:3], v[116:119], 0
  v_mfma_f32_16x16x32_bf16 v[168:171], a[0:3], v[120:123], 0
  s_waitcnt lgkmcnt(2)
  v_mfma_f32_16x16x32_bf16 v[160:163], a[4:7], v[124:127], v[160:163]
  v_mfma_f32_16x16x32_bf16 v[164:167], a[4:7], v[128:131], v[164:167]
  v_mfma_f32_16x16x32_bf16 v[168:171], a[4:7], v[132:135], v[168:171]
  s_waitcnt lgkmcnt(1)
  v_mfma_f32_16x16x32_bf16 v[160:163], a[8:11], v[136:139], v[160:163]
  v_mfma_f32_16x16x32_bf16 v[164:167], a[8:11], v[140:143], v[164:167]
  v_mfma_f32_16x16x32_bf16 v[168:171], a[8:11], v[144:147], v[168:171]
  s_waitcnt lgkmcnt(0)
  v_mfma_f32_16x16x32_bf16 v[160:163], a[12:15], v[148:151], v[160:163]
  v_mfma_f32_16x16x32_bf16 v[164:167], a[12:15], v[152:155], v[164:167]
  v_mfma_f32_16x16x32_bf16 v[168:171], a[12:15], v[156:159], v[168:171]
  s_nop 5
  v_max3_f32 v244, v244, v160, v161
  v_max3_f32 v244, v244, v162, v163
  v_max3_f32 v245, v245, v164, v165
  v_max3_f32 v245, v245, v166, v167
  v_max3_f32 v246, v246, v168, v169
  v_max3_f32 v246, v246, v170, v171
  s_waitcnt vmcnt(0) lgkmcnt(0)
  s_nop 7
  s_nop 7
  s_add_u32 s38, s38, 16384
  s_cmp_lt_u32 s38, 131072
  s_cbranch_scc1 L_redo1
  v_mov_b32 v247, v244
  s_nop 1
  v_permlane32_swap_b32 v247, v244
  v_max_f32 v244, v244, v247
  v_mov_b32 v247, v244
  s_nop 1
  v_permlane16_swap_b32 v247, v244
  v_max_f32 v244, v244, v247
  v_sub_f32 v232, 0, v244
  v_sub_f32 v233, 0, v244
  v_sub_f32 v234, 0, v244
  v_sub_f32 v235, 0, v244
  v_mov_b32 v247, v245
  s_nop 1
  v_permlane32_swap_b32 v247, v245
  v_max_f32 v245, v245, v247
  v_mov_b32 v247, v245
  s_nop 1
  v_permlane16_swap_b32 v247, v245
  v_max_f32 v245, v245, v247
  v_sub_f32 v236, 0, v245
  v_sub_f32 v237, 0, v245
  v_sub_f32 v238, 0, v245
  v_sub_f32 v239, 0, v245
  v_mov_b32 v247, v246
  s_nop 1
  v_permlane32_swap_b32 v247, v246
  v_max_f32 v246, v246, v247
  v_mov_b32 v247, v246
  s_nop 1
  v_permlane16_swap_b32 v247, v246
  v_max_f32 v246, v246, v247
  v_sub_f32 v240, 0, v246
  v_sub_f32 v241, 0, v246
  v_sub_f32 v242, 0, v246
  v_sub_f32 v243, 0, v246
  v_mov_b32 v16, 0
  v_mov_b32 v17, 0
  v_mov_b32 v18, 0
  v_mov_b32 v19, 0
  v_mov_b32 v20, 0
  v_mov_b32 v21, 0
  v_mov_b32 v22, 0
  v_mov_b32 v23, 0
  v_mov_b32 v24, 0
  v_mov_b32 v25, 0
  v_mov_b32 v26, 0
  v_mov_b32 v27, 0
  v_mov_b32 v28, 0
  v_mov_b32 v29, 0
  v_mov_b32 v30, 0
  v_mov_b32 v31, 0
  v_mov_b32 v32, 0
  v_mov_b32 v33, 0
  v_mov_b32 v34, 0
  v_mov_b32 v35, 0
  v_mov_b32 v36, 0
  v_mov_b32 v37, 0
  v_mov_b32 v38, 0
  v_mov_b32 v39, 0
  v_mov_b32 v40, 0
  v_mov_b32 v41, 0
  v_mov_b32 v42, 0
  v_mov_b32 v43, 0
  v_mov_b32 v44, 0
  v_mov_b32 v45, 0
  v_mov_b32 v46, 0
  v_mov_b32 v47, 0
  v_mov_b32 v48, 0
  v_mov_b32 v49, 0
  v_mov_b32 v50, 0
  v_mov_b32 v51, 0
  v_mov_b32 v52, 0
  v_mov_b32 v53, 0
  v_mov_b32 v54, 0
  v_mov_b32 v55, 0
  v_mov_b32 v56, 0
  v_mov_b32 v57, 0
  v_mov_b32 v58, 0
  v_mov_b32 v59, 0
  v_mov_b32 v60, 0
  v_mov_b32 v61, 0
  v_mov_b32 v62, 0
  v_mov_b32 v63, 0
  v_mov_b32 v64, 0
  v_mov_b32 v65, 0
  v_mov_b32 v66, 0
  v_mov_b32 v67, 0
  v_mov_b32 v68, 0
  v_mov_b32 v69, 0
  v_mov_b32 v70, 0
  v_mov_b32 v71, 0
  v_mov_b32 v72, 0
  v_mov_b32 v73, 0
  v_mov_b32 v74, 0
  v_mov_b32 v75, 0
  v_mov_b32 v76, 0
  v_mov_b32 v77, 0
  v_mov_b32 v78, 0
  v_mov_b32 v79, 0
  v_mov_b32 v80, 0
  v_mov_b32 v81, 0
  v_mov_b32 v82, 0
  v_mov_b32 v83, 0
  v_mov_b32 v84, 0
  v_mov_b32 v85, 0
  v_mov_b32 v86, 0
  v_mov_b32 v87, 0
  v_mov_b32 v88, 0
  v_mov_b32 v89, 0
  v_mov_b32 v90, 0
  v_mov_b32 v91, 0
  v_mov_b32 v92, 0
  v_mov_b32 v93, 0
  v_mov_b32 v94, 0
  v_mov_b32 v95, 0
  v_mov_b32 v96, 0
  v_mov_b32 v97, 0
  v_mov_b32 v98, 0
  v_mov_b32 v99, 0
  v_mov_b32 v100, 0
  v_mov_b32 v101, 0
  v_mov_b32 v102, 0
  v_mov_b32 v103, 0
  v_mov_b32 v104, 0
  v_mov_b32 v105, 0
  v_mov_b32 v106, 0
  v_mov_b32 v107, 0
  v_mov_b32 v108, 0
  v_mov_b32 v109, 0
  v_mov_b32 v110, 0
  v_mov_b32 v111, 0
  v_accvgpr_write_b32 a48, 0
  v_accvgpr_write_b32 a49, 0
  v_accvgpr_write_b32 a50, 0
  v_accvgpr_write_b32 a51, 0
  v_accvgpr_write_b32 a52, 0
  v_accvgpr_write_b32 a53, 0
  v_accvgpr_write_b32 a54, 0
  v_accvgpr_write_b32 a55, 0
  v_accvgpr_write_b32 a56, 0
  v_accvgpr_write_b32 a57, 0
  v_accvgpr_write_b32 a58, 0
  v_accvgpr_write_b32 a59, 0
  s_mov_b32 s38, 0
  s_waitcnt vmcnt(0) lgkmcnt(0)
  s_nop 7
  s_nop 7
  L_redo2:
  s_barrier
  s_add_u32 m0, s37, 0
  s_nop 0
  buffer_load_dwordx4 v2, s[16:19], s38 offen offset:0 lds
  buffer_load_dwordx4 v2, s[16:19], s38 offen offset:1024 lds
  buffer_load_dwordx4 v2, s[16:19], s38 offen offset:2048 lds
  buffer_load_dwordx4 v2, s[16:19], s38 offen offset:3072 lds
  s_add_u32 m0, s37, 16384
  s_nop 0
  buffer_load_dwordx4 v3, s[20:23], s38 offen offset:0 lds
  buffer_load_dwordx4 v3, s[20:23], s38 offen offset:1024 lds
  buffer_load_dwordx4 v3, s[20:23], s38 offen offset:2048 lds
  buffer_load_dwordx4 v3, s[20:23], s38 offen offset:3072 lds
  s_waitcnt vmcnt(0)
  s_barrier
  ds_read_b128 a[0:3], v4 offset:0
  ds_read_b128 a[4:7], v5 offset:0
  ds_read_b128 a[8:11], v6 offset:0
  ds_read_b128 a[12:15], v7 offset:0
  s_waitcnt lgkmcnt(3)
  v_mfma_f32_16x16x32_bf16 v[160:163], a[0:3], v[112:115], v[232:235]
  v_mfma_f32_16x16x32_bf16 v[164:167], a[0:3], v[116:119], v[236:239]
  v_mfma_f32_16x16x32_bf16 v[168:171], a[0:3], v[120:123], v[240:243]
  s_waitcnt lgkmcnt(2)
  v_mfma_f32_16x16x32_bf16 v[160:163], a[4:7], v[124:127], v[160:163]
  v_mfma_f32_16x16x32_bf16 v[164:167], a[4:7], v[128:131], v[164:167]
  v_mfma_f32_16x16x32_bf16 v[168:171], a[4:7], v[132:135], v[168:171]
  s_waitcnt lgkmcnt(1)
  v_mfma_f32_16x16x32_bf16 v[160:163], a[8:11], v[136:139], v[160:163]
  v_mfma_f32_16x16x32_bf16 v[164:167], a[8:11], v[140:143], v[164:167]
  v_mfma_f32_16x16x32_bf16 v[168:171], a[8:11], v[144:147], v[168:171]
  s_waitcnt lgkmcnt(0)
  v_mfma_f32_16x16x32_bf16 v[160:163], a[12:15], v[148:151], v[160:163]
  v_mfma_f32_16x16x32_bf16 v[164:167], a[12:15], v[152:155], v[164:167]
  v_mfma_f32_16x16x32_bf16 v[168:171], a[12:15], v[156:159], v[168:171]
  ds_read_b128 a[0:3], v4 offset:1024
  ds_read_b128 a[4:7], v5 offset:1024
  ds_read_b128 a[8:11], v6 offset:1024
  ds_read_b128 a[12:15], v7 offset:1024
  s_waitcnt lgkmcnt(3)
  v_mfma_f32_16x16x32_bf16 v[172:175], a[0:3], v[112:115], v[232:235]
  v_mfma_f32_16x16x32_bf16 v[176:179], a[0:3], v[116:119], v[236:239]
  v_mfma_f32_16x16x32_bf16 v[180:183], a[0:3], v[120:123], v[240:243]
  s_waitcnt lgkmcnt(2)
  v_mfma_f32_16x16x32_bf16 v[172:175], a[4:7], v[124:127], v[172:175]
  v_mfma_f32_16x16x32_bf16 v[176:179], a[4:7], v[128:131], v[176:179]
  v_mfma_f32_16x16x32_bf16 v[180:183], a[4:7], v[132:135], v[180:183]
  s_waitcnt lgkmcnt(1)
  v_mfma_f32_16x16x32_bf16 v[172:175], a[8:11], v[136:139], v[172:175]
  v_mfma_f32_16x16x32_bf16 v[176:179], a[8:11], v[140:143], v[176:179]
  v_mfma_f32_16x16x32_bf16 v[180:183], a[8:11], v[144:147], v[180:183]
  s_waitcnt lgkmcnt(0)
  v_mfma_f32_16x16x32_bf16 v[172:175], a[12:15], v[148:151], v[172:175]
  v_mfma_f32_16x16x32_bf16 v[176:179], a[12:15], v[152:155], v[176:179]
  v_mfma_f32_16x16x32_bf16 v[180:183], a[12:15], v[156:159], v[180:183]
  v_exp_f32 v160, v160
  v_exp_f32 v161, v161
  v_exp_f32 v162, v162
  v_exp_f32 v163, v163
  v_cvt_pk_bf16_f32 v208, v160, v161
  v_cvt_pk_bf16_f32 v209, v162, v163
  v_exp_f32 v172, v172
  v_exp_f32 v173, v173
  v_exp_f32 v174, v174
  v_exp_f32 v175, v175
  v_cvt_pk_bf16_f32 v210, v172, v173
  v_cvt_pk_bf16_f32 v211, v174, v175
  v_exp_f32 v164, v164
  v_exp_f32 v165, v165
  v_exp_f32 v166, v166
  v_exp_f32 v167, v167
  v_cvt_pk_bf16_f32 v212, v164, v165
  v_cvt_pk_bf16_f32 v213, v166, v167
  v_exp_f32 v176, v176
  v_exp_f32 v177, v177
  v_exp_f32 v178, v178
  v_exp_f32 v179, v179
  v_cvt_pk_bf16_f32 v214, v176, v177
  v_cvt_pk_bf16_f32 v215, v178, v179
  v_exp_f32 v168, v168
  v_exp_f32 v169, v169
  v_exp_f32 v170, v170
  v_exp_f32 v171, v171
  v_cvt_pk_bf16_f32 v216, v168, v169
  v_cvt_pk_bf16_f32 v217, v170, v171
  v_exp_f32 v180, v180
  v_exp_f32 v181, v181
  v_exp_f32 v182, v182
  v_exp_f32 v183, v183
  v_cvt_pk_bf16_f32 v218, v180, v181
  v_cvt_pk_bf16_f32 v219, v182, v183
  v_mfma_f32_16x16x32_bf16 a[48:51], a[60:63], v[208:211], a[48:51]
  v_mfma_f32_16x16x32_bf16 a[52:55], a[60:63], v[212:215], a[52:55]
  v_mfma_f32_16x16x32_bf16 a[56:59], a[60:63], v[216:219], a[56:59]
  ds_read_b64_tr_b16 a[112:113], v8 offset:0
  ds_read_b64_tr_b16 a[114:115], v8 offset:1024
  ds_read_b64_tr_b16 a[116:117], v9 offset:0
  ds_read_b64_tr_b16 a[118:119], v9 offset:1024
  ds_read_b64_tr_b16 a[120:121], v10 offset:0
  ds_read_b64_tr_b16 a[122:123], v10 offset:1024
  ds_read_b64_tr_b16 a[124:125], v11 offset:0
  ds_read_b64_tr_b16 a[126:127], v11 offset:1024
  s_waitcnt lgkmcnt(6)
  v_mfma_f32_16x16x32_bf16 v[16:19], a[112:115], v[208:211], v[16:19]
  v_mfma_f32_16x16x32_bf16 v[20:23], a[112:115], v[212:215], v[20:23]
  v_mfma_f32_16x16x32_bf16 v[24:27], a[112:115], v[216:219], v[24:27]
  s_waitcnt lgkmcnt(4)
  v_mfma_f32_16x16x32_bf16 v[28:31], a[116:119], v[208:211], v[28:31]
  v_mfma_f32_16x16x32_bf16 v[32:35], a[116:119], v[212:215], v[32:35]
  v_mfma_f32_16x16x32_bf16 v[36:39], a[116:119], v[216:219], v[36:39]
  s_waitcnt lgkmcnt(2)
  v_mfma_f32_16x16x32_bf16 v[40:43], a[120:123], v[208:211], v[40:43]
  v_mfma_f32_16x16x32_bf16 v[44:47], a[120:123], v[212:215], v[44:47]
  v_mfma_f32_16x16x32_bf16 v[48:51], a[120:123], v[216:219], v[48:51]
  s_waitcnt lgkmcnt(0)
  v_mfma_f32_16x16x32_bf16 v[52:55], a[124:127], v[208:211], v[52:55]
  v_mfma_f32_16x16x32_bf16 v[56:59], a[124:127], v[212:215], v[56:59]
  v_mfma_f32_16x16x32_bf16 v[60:63], a[124:127], v[216:219], v[60:63]
  ds_read_b64_tr_b16 a[112:113], v12 offset:0
  ds_read_b64_tr_b16 a[114:115], v12 offset:1024
  ds_read_b64_tr_b16 a[116:117], v13 offset:0
  ds_read_b64_tr_b16 a[118:119], v13 offset:1024
  ds_read_b64_tr_b16 a[120:121], v14 offset:0
  ds_read_b64_tr_b16 a[122:123], v14 offset:1024
  ds_read_b64_tr_b16 a[124:125], v15 offset:0
  ds_read_b64_tr_b16 a[126:127], v15 offset:1024
  s_waitcnt lgkmcnt(6)
  v_mfma_f32_16x16x32_bf16 v[64:67], a[112:115], v[208:211], v[64:67]
  v_mfma_f32_16x16x32_bf16 v[68:71], a[112:115], v[212:215], v[68:71]
  v_mfma_f32_16x16x32_bf16 v[72:75], a[112:115], v[216:219], v[72:75]
  s_waitcnt lgkmcnt(4)
  v_mfma_f32_16x16x32_bf16 v[76:79], a[116:119], v[208:211], v[76:79]
  v_mfma_f32_16x16x32_bf16 v[80:83], a[116:119], v[212:215], v[80:83]
  v_mfma_f32_16x16x32_bf16 v[84:87], a[116:119], v[216:219], v[84:87]
  s_waitcnt lgkmcnt(2)
  v_mfma_f32_16x16x32_bf16 v[88:91], a[120:123], v[208:211], v[88:91]
  v_mfma_f32_16x16x32_bf16 v[92:95], a[120:123], v[212:215], v[92:95]
  v_mfma_f32_16x16x32_bf16 v[96:99], a[120:123], v[216:219], v[96:99]
  s_waitcnt lgkmcnt(0)
  v_mfma_f32_16x16x32_bf16 v[100:103], a[124:127], v[208:211], v[100:103]
  v_mfma_f32_16x16x32_bf16 v[104:107], a[124:127], v[212:215], v[104:107]
  v_mfma_f32_16x16x32_bf16 v[108:111], a[124:127], v[216:219], v[108:111]
  ds_read_b128 a[0:3], v4 offset:2048
  ds_read_b128 a[4:7], v5 offset:2048
  ds_read_b128 a[8:11], v6 offset:2048
  ds_read_b128 a[12:15], v7 offset:2048
  s_waitcnt lgkmcnt(3)
  v_mfma_f32_16x16x32_bf16 v[160:163], a[0:3], v[112:115], v[232:235]
  v_mfma_f32_16x16x32_bf16 v[164:167], a[0:3], v[116:119], v[236:239]
  v_mfma_f32_16x16x32_bf16 v[168:171], a[0:3], v[120:123], v[240:243]
  s_waitcnt lgkmcnt(2)
  v_mfma_f32_16x16x32_bf16 v[160:163], a[4:7], v[124:127], v[160:163]
  v_mfma_f32_16x16x32_bf16 v[164:167], a[4:7], v[128:131], v[164:167]
  v_mfma_f32_16x16x32_bf16 v[168:171], a[4:7], v[132:135], v[168:171]
  s_waitcnt lgkmcnt(1)
  v_mfma_f32_16x16x32_bf16 v[160:163], a[8:11], v[136:139], v[160:163]
  v_mfma_f32_16x16x32_bf16 v[164:167], a[8:11], v[140:143], v[164:167]
  v_mfma_f32_16x16x32_bf16 v[168:171], a[8:11], v[144:147], v[168:171]
  s_waitcnt lgkmcnt(0)
  v_mfma_f32_16x16x32_bf16 v[160:163], a[12:15], v[148:151], v[160:163]
  v_mfma_f32_16x16x32_bf16 v[164:167], a[12:15], v[152:155], v[164:167]
  v_mfma_f32_16x16x32_bf16 v[168:171], a[12:15], v[156:159], v[168:171]
  ds_read_b128 a[0:3], v4 offset:3072
  ds_read_b128 a[4:7], v5 offset:3072
  ds_read_b128 a[8:11], v6 offset:3072
  ds_read_b128 a[12:15], v7 offset:3072
  s_waitcnt lgkmcnt(3)
  v_mfma_f32_16x16x32_bf16 v[172:175], a[0:3], v[112:115], v[232:235]
  v_mfma_f32_16x16x32_bf16 v[176:179], a[0:3], v[116:119], v[236:239]
  v_mfma_f32_16x16x32_bf16 v[180:183], a[0:3], v[120:123], v[240:243]
  s_waitcnt lgkmcnt(2)
  v_mfma_f32_16x16x32_bf16 v[172:175], a[4:7], v[124:127], v[172:175]
  v_mfma_f32_16x16x32_bf16 v[176:179], a[4:7], v[128:131], v[176:179]
  v_mfma_f32_16x16x32_bf16 v[180:183], a[4:7], v[132:135], v[180:183]
  s_waitcnt lgkmcnt(1)
  v_mfma_f32_16x16x32_bf16 v[172:175], a[8:11], v[136:139], v[172:175]
  v_mfma_f32_16x16x32_bf16 v[176:179], a[8:11], v[140:143], v[176:179]
  v_mfma_f32_16x16x32_bf16 v[180:183], a[8:11], v[144:147], v[180:183]
  s_waitcnt lgkmcnt(0)
  v_mfma_f32_16x16x32_bf16 v[172:175], a[12:15], v[148:151], v[172:175]
  v_mfma_f32_16x16x32_bf16 v[176:179], a[12:15], v[152:155], v[176:179]
  v_mfma_f32_16x16x32_bf16 v[180:183], a[12:15], v[156:159], v[180:183]
  v_exp_f32 v160, v160
  v_exp_f32 v161, v161
  v_exp_f32 v162, v162
  v_exp_f32 v163, v163
  v_cvt_pk_bf16_f32 v208, v160, v161
  v_cvt_pk_bf16_f32 v209, v162, v163
  v_exp_f32 v172, v172
  v_exp_f32 v173, v173
  v_exp_f32 v174, v174
  v_exp_f32 v175, v175
  v_cvt_pk_bf16_f32 v210, v172, v173
  v_cvt_pk_bf16_f32 v211, v174, v175
  v_exp_f32 v164, v164
  v_exp_f32 v165, v165
  v_exp_f32 v166, v166
  v_exp_f32 v167, v167
  v_cvt_pk_bf16_f32 v212, v164, v165
  v_cvt_pk_bf16_f32 v213, v166, v167
  v_exp_f32 v176, v176
  v_exp_f32 v177, v177
  v_exp_f32 v178, v178
  v_exp_f32 v179, v179
  v_cvt_pk_bf16_f32 v214, v176, v177
  v_cvt_pk_bf16_f32 v215, v178, v179
  v_exp_f32 v168, v168
  v_exp_f32 v169, v169
  v_exp_f32 v170, v170
  v_exp_f32 v171, v171
  v_cvt_pk_bf16_f32 v216, v168, v169
  v_cvt_pk_bf16_f32 v217, v170, v171
  v_exp_f32 v180, v180
  v_exp_f32 v181, v181
  v_exp_f32 v182, v182
  v_exp_f32 v183, v183
  v_cvt_pk_bf16_f32 v218, v180, v181
  v_cvt_pk_bf16_f32 v219, v182, v183
  v_mfma_f32_16x16x32_bf16 a[48:51], a[60:63], v[208:211], a[48:51]
  v_mfma_f32_16x16x32_bf16 a[52:55], a[60:63], v[212:215], a[52:55]
  v_mfma_f32_16x16x32_bf16 a[56:59], a[60:63], v[216:219], a[56:59]
  ds_read_b64_tr_b16 a[112:113], v8 offset:2048
  ds_read_b64_tr_b16 a[114:115], v8 offset:3072
  ds_read_b64_tr_b16 a[116:117], v9 offset:2048
  ds_read_b64_tr_b16 a[118:119], v9 offset:3072
  ds_read_b64_tr_b16 a[120:121], v10 offset:2048
  ds_read_b64_tr_b16 a[122:123], v10 offset:3072
  ds_read_b64_tr_b16 a[124:125], v11 offset:2048
  ds_read_b64_tr_b16 a[126:127], v11 offset:3072
  s_waitcnt lgkmcnt(6)
  v_mfma_f32_16x16x32_bf16 v[16:19], a[112:115], v[208:211], v[16:19]
  v_mfma_f32_16x16x32_bf16 v[20:23], a[112:115], v[212:215], v[20:23]
  v_mfma_f32_16x16x32_bf16 v[24:27], a[112:115], v[216:219], v[24:27]
  s_waitcnt lgkmcnt(4)
  v_mfma_f32_16x16x32_bf16 v[28:31], a[116:119], v[208:211], v[28:31]
  v_mfma_f32_16x16x32_bf16 v[32:35], a[116:119], v[212:215], v[32:35]
  v_mfma_f32_16x16x32_bf16 v[36:39], a[116:119], v[216:219], v[36:39]
  s_waitcnt lgkmcnt(2)
  v_mfma_f32_16x16x32_bf16 v[40:43], a[120:123], v[208:211], v[40:43]
  v_mfma_f32_16x16x32_bf16 v[44:47], a[120:123], v[212:215], v[44:47]
  v_mfma_f32_16x16x32_bf16 v[48:51], a[120:123], v[216:219], v[48:51]
  s_waitcnt lgkmcnt(0)
  v_mfma_f32_16x16x32_bf16 v[52:55], a[124:127], v[208:211], v[52:55]
  v_mfma_f32_16x16x32_bf16 v[56:59], a[124:127], v[212:215], v[56:59]
  v_mfma_f32_16x16x32_bf16 v[60:63], a[124:127], v[216:219], v[60:63]
  ds_read_b64_tr_b16 a[112:113], v12 offset:2048
  ds_read_b64_tr_b16 a[114:115], v12 offset:3072
  ds_read_b64_tr_b16 a[116:117], v13 offset:2048
  ds_read_b64_tr_b16 a[118:119], v13 offset:3072
  ds_read_b64_tr_b16 a[120:121], v14 offset:2048
  ds_read_b64_tr_b16 a[122:123], v14 offset:3072
  ds_read_b64_tr_b16 a[124:125], v15 offset:2048
  ds_read_b64_tr_b16 a[126:127], v15 offset:3072
  s_waitcnt lgkmcnt(6)
  v_mfma_f32_16x16x32_bf16 v[64:67], a[112:115], v[208:211], v[64:67]
  v_mfma_f32_16x16x32_bf16 v[68:71], a[112:115], v[212:215], v[68:71]
  v_mfma_f32_16x16x32_bf16 v[72:75], a[112:115], v[216:219], v[72:75]
  s_waitcnt lgkmcnt(4)
  v_mfma_f32_16x16x32_bf16 v[76:79], a[116:119], v[208:211], v[76:79]
  v_mfma_f32_16x16x32_bf16 v[80:83], a[116:119], v[212:215], v[80:83]
  v_mfma_f32_16x16x32_bf16 v[84:87], a[116:119], v[216:219], v[84:87]
  s_waitcnt lgkmcnt(2)
  v_mfma_f32_16x16x32_bf16 v[88:91], a[120:123], v[208:211], v[88:91]
  v_mfma_f32_16x16x32_bf16 v[92:95], a[120:123], v[212:215], v[92:95]
  v_mfma_f32_16x16x32_bf16 v[96:99], a[120:123], v[216:219], v[96:99]
  s_waitcnt lgkmcnt(0)
  v_mfma_f32_16x16x32_bf16 v[100:103], a[124:127], v[208:211], v[100:103]
  v_mfma_f32_16x16x32_bf16 v[104:107], a[124:127], v[212:215], v[104:107]
  v_mfma_f32_16x16x32_bf16 v[108:111], a[124:127], v[216:219], v[108:111]
  s_waitcnt vmcnt(0) lgkmcnt(0)
  s_nop 7
  s_nop 7
  s_add_u32 s38, s38, 16384
  s_cmp_lt_u32 s38, 131072
  s_cbranch_scc1 L_redo2
  v_accvgpr_read_b32 v244, a48
  v_rcp_f32 v247, v244
  v_accvgpr_read_b32 v245, a52
  v_rcp_f32 v248, v245
  v_accvgpr_read_b32 v246, a56
  v_rcp_f32 v249, v246
  v_mul_f32 v16, v247, v16
  v_mul_f32 v17, v247, v17
  v_mul_f32 v18, v247, v18
  v_mul_f32 v19, v247, v19
  v_cvt_pk_bf16_f32 v160, v16, v17
  v_cvt_pk_bf16_f32 v161, v18, v19
  v_mul_f32 v28, v247, v28
  v_mul_f32 v29, v247, v29
  v_mul_f32 v30, v247, v30
  v_mul_f32 v31, v247, v31
  v_cvt_pk_bf16_f32 v162, v28, v29
  v_cvt_pk_bf16_f32 v163, v30, v31
  buffer_store_dwordx4 v[160:163], v1, s[28:31], 0 offen offset:0 sc1
  v_mul_f32 v20, v248, v20
  v_mul_f32 v21, v248, v21
  v_mul_f32 v22, v248, v22
  v_mul_f32 v23, v248, v23
  v_cvt_pk_bf16_f32 v164, v20, v21
  v_cvt_pk_bf16_f32 v165, v22, v23
  v_mul_f32 v32, v248, v32
  v_mul_f32 v33, v248, v33
  v_mul_f32 v34, v248, v34
  v_mul_f32 v35, v248, v35
  v_cvt_pk_bf16_f32 v166, v32, v33
  v_cvt_pk_bf16_f32 v167, v34, v35
  buffer_store_dwordx4 v[164:167], v1, s[28:31], 0 offen offset:1024 sc1
  v_mul_f32 v24, v249, v24
  v_mul_f32 v25, v249, v25
  v_mul_f32 v26, v249, v26
  v_mul_f32 v27, v249, v27
  v_cvt_pk_bf16_f32 v168, v24, v25
  v_cvt_pk_bf16_f32 v169, v26, v27
  v_mul_f32 v36, v249, v36
  v_mul_f32 v37, v249, v37
  v_mul_f32 v38, v249, v38
  v_mul_f32 v39, v249, v39
  v_cvt_pk_bf16_f32 v170, v36, v37
  v_cvt_pk_bf16_f32 v171, v38, v39
  buffer_store_dwordx4 v[168:171], v1, s[28:31], 0 offen offset:2048 sc1
  v_mul_f32 v40, v247, v40
  v_mul_f32 v41, v247, v41
  v_mul_f32 v42, v247, v42
  v_mul_f32 v43, v247, v43
  v_cvt_pk_bf16_f32 v172, v40, v41
  v_cvt_pk_bf16_f32 v173, v42, v43
  v_mul_f32 v52, v247, v52
  v_mul_f32 v53, v247, v53
  v_mul_f32 v54, v247, v54
  v_mul_f32 v55, v247, v55
  v_cvt_pk_bf16_f32 v174, v52, v53
  v_cvt_pk_bf16_f32 v175, v54, v55
  buffer_store_dwordx4 v[172:175], v1, s[28:31], 0 offen offset:3072 sc1
  v_mul_f32 v44, v248, v44
  v_mul_f32 v45, v248, v45
  v_mul_f32 v46, v248, v46
  v_mul_f32 v47, v248, v47
  v_cvt_pk_bf16_f32 v176, v44, v45
  v_cvt_pk_bf16_f32 v177, v46, v47
  v_mul_f32 v56, v248, v56
  v_mul_f32 v57, v248, v57
  v_mul_f32 v58, v248, v58
  v_mul_f32 v59, v248, v59
  v_cvt_pk_bf16_f32 v178, v56, v57
  v_cvt_pk_bf16_f32 v179, v58, v59
  buffer_store_dwordx4 v[176:179], v1, s[28:31], s56 offen offset:0 sc1
  v_mul_f32 v48, v249, v48
  v_mul_f32 v49, v249, v49
  v_mul_f32 v50, v249, v50
  v_mul_f32 v51, v249, v51
  v_cvt_pk_bf16_f32 v180, v48, v49
  v_cvt_pk_bf16_f32 v181, v50, v51
  v_mul_f32 v60, v249, v60
  v_mul_f32 v61, v249, v61
  v_mul_f32 v62, v249, v62
  v_mul_f32 v63, v249, v63
  v_cvt_pk_bf16_f32 v182, v60, v61
  v_cvt_pk_bf16_f32 v183, v62, v63
  buffer_store_dwordx4 v[180:183], v1, s[28:31], s56 offen offset:1024 sc1
  v_mul_f32 v64, v247, v64
  v_mul_f32 v65, v247, v65
  v_mul_f32 v66, v247, v66
  v_mul_f32 v67, v247, v67
  v_cvt_pk_bf16_f32 v184, v64, v65
  v_cvt_pk_bf16_f32 v185, v66, v67
  v_mul_f32 v76, v247, v76
  v_mul_f32 v77, v247, v77
  v_mul_f32 v78, v247, v78
  v_mul_f32 v79, v247, v79
  v_cvt_pk_bf16_f32 v186, v76, v77
  v_cvt_pk_bf16_f32 v187, v78, v79
  buffer_store_dwordx4 v[184:187], v1, s[28:31], s56 offen offset:2048 sc1
  v_mul_f32 v68, v248, v68
  v_mul_f32 v69, v248, v69
  v_mul_f32 v70, v248, v70
  v_mul_f32 v71, v248, v71
  v_cvt_pk_bf16_f32 v188, v68, v69
  v_cvt_pk_bf16_f32 v189, v70, v71
  v_mul_f32 v80, v248, v80
  v_mul_f32 v81, v248, v81
  v_mul_f32 v82, v248, v82
  v_mul_f32 v83, v248, v83
  v_cvt_pk_bf16_f32 v190, v80, v81
  v_cvt_pk_bf16_f32 v191, v82, v83
  buffer_store_dwordx4 v[188:191], v1, s[28:31], s56 offen offset:3072 sc1
  v_mul_f32 v72, v249, v72
  v_mul_f32 v73, v249, v73
  v_mul_f32 v74, v249, v74
  v_mul_f32 v75, v249, v75
  v_cvt_pk_bf16_f32 v192, v72, v73
  v_cvt_pk_bf16_f32 v193, v74, v75
  v_mul_f32 v84, v249, v84
  v_mul_f32 v85, v249, v85
  v_mul_f32 v86, v249, v86
  v_mul_f32 v87, v249, v87
  v_cvt_pk_bf16_f32 v194, v84, v85
  v_cvt_pk_bf16_f32 v195, v86, v87
  buffer_store_dwordx4 v[192:195], v1, s[28:31], s57 offen offset:0 sc1
  v_mul_f32 v88, v247, v88
  v_mul_f32 v89, v247, v89
  v_mul_f32 v90, v247, v90
  v_mul_f32 v91, v247, v91
  v_cvt_pk_bf16_f32 v196, v88, v89
  v_cvt_pk_bf16_f32 v197, v90, v91
  v_mul_f32 v100, v247, v100
  v_mul_f32 v101, v247, v101
  v_mul_f32 v102, v247, v102
  v_mul_f32 v103, v247, v103
  v_cvt_pk_bf16_f32 v198, v100, v101
  v_cvt_pk_bf16_f32 v199, v102, v103
  buffer_store_dwordx4 v[196:199], v1, s[28:31], s57 offen offset:1024 sc1
  v_mul_f32 v92, v248, v92
  v_mul_f32 v93, v248, v93
  v_mul_f32 v94, v248, v94
  v_mul_f32 v95, v248, v95
  v_cvt_pk_bf16_f32 v200, v92, v93
  v_cvt_pk_bf16_f32 v201, v94, v95
  v_mul_f32 v104, v248, v104
  v_mul_f32 v105, v248, v105
  v_mul_f32 v106, v248, v106
  v_mul_f32 v107, v248, v107
  v_cvt_pk_bf16_f32 v202, v104, v105
  v_cvt_pk_bf16_f32 v203, v106, v107
  buffer_store_dwordx4 v[200:203], v1, s[28:31], s57 offen offset:2048 sc1
  v_mul_f32 v96, v249, v96
  v_mul_f32 v97, v249, v97
  v_mul_f32 v98, v249, v98
  v_mul_f32 v99, v249, v99
  v_cvt_pk_bf16_f32 v204, v96, v97
  v_cvt_pk_bf16_f32 v205, v98, v99
  v_mul_f32 v108, v249, v108
  v_mul_f32 v109, v249, v109
  v_mul_f32 v110, v249, v110
  v_mul_f32 v111, v249, v111
  v_cvt_pk_bf16_f32 v206, v108, v109
  v_cvt_pk_bf16_f32 v207, v110, v111
  buffer_store_dwordx4 v[204:207], v1, s[28:31], s57 offen offset:3072 sc1
  s_waitcnt vmcnt(0) lgkmcnt(0)
  s_nop 7
  s_nop 7
  s_branch L_stored
L_chk_slow:
  s_mov_b32 s58, 0
L_chk_loop:
  s_sleep 2
  buffer_load_dword v245, v244, s[68:71], 0 offen sc1
  s_waitcnt vmcnt(0)
  v_cmp_le_u32 vcc, 0x80, v245
  s_add_u32 s58, s58, 1
  s_nop 3
  s_cmp_eq_u32 vcc_lo, 3
  s_cbranch_scc1 L_chk_ret
  s_cmp_lt_u32 s58, 200000
  s_cbranch_scc1 L_chk_loop
  s_branch L_chk_ret
.section .rodata,"a"
.p2align 6
.amdhsa_kernel standalone__mha_block_cached__near_ridge_kernel
  .amdhsa_next_free_vgpr 512
  .amdhsa_next_free_sgpr 102
  .amdhsa_accum_offset 256
  .amdhsa_group_segment_fixed_size 0
  .amdhsa_kernarg_size 64
  .amdhsa_user_sgpr_count 2
  .amdhsa_user_sgpr_kernarg_segment_ptr 1
  .amdhsa_system_sgpr_workgroup_id_x 1
  .amdhsa_float_denorm_mode_32 3
.end_amdhsa_kernel
```
